```python
import torch

def _softmax(x, axis=-1):
    return torch.softmax(x, dim=axis)
def _gelu(x):
    return torch.nn.functional.gelu(x, approximate="tanh")
def _silu(x):
    return torch.nn.functional.silu(x)
def _sigmoid(x):
    return torch.sigmoid(x)
def _layernorm(x, axis=-1, eps=1e-5):
    m = x.mean(dim=axis, keepdim=True)
    v = x.var(dim=axis, keepdim=True, unbiased=False)
    return (x - m) / torch.sqrt(v + eps)
def _scatter_add(tgt, idx, src, axis=0):
    return tgt.clone().index_add_(axis, idx, src)
def _segment_sum(src, seg, n):
    out = torch.zeros((n,) + src.shape[1:], dtype=src.dtype)
    return out.index_add_(0, seg, src)
def _pad(x, pw):
    flat = tuple(v for pair in reversed(pw) for v in pair)
    return torch.nn.functional.pad(x, flat)

kernel_name = 'recurrent_scan__sliding_local_dilated__glu_gated_reglu__prompt'

def setup_inputs():

    _w = (lambda a: (lambda t: t.to(torch.bfloat16) if t.is_floating_point() else t)(torch.as_tensor(a)))
    def _A_setup():
        B, S, D = 1, 2048, 576
        return {
            "x": _w((lambda *s: torch.randn(*s, dtype=torch.bfloat16) * 0.05)(B, S, D)),
            "wqkv": _w((lambda *s: torch.randn(*s, dtype=torch.bfloat16) * 0.2)(D, 3 * D)),
            "wo": _w((lambda *s: torch.randn(*s, dtype=torch.bfloat16) * 0.2)(D, D)),
        }
    _A_in = _A_setup()

    def _B_setup():
        B, S, D, F = 1, 2048, 576, 4608
        return {
            "x": _w((lambda *s: torch.randn(*s, dtype=torch.bfloat16) * 0.05)(B, S, D)),
            "W_gate": _w((lambda *s: torch.randn(*s, dtype=torch.bfloat16) * 0.1)(D, F) * (2.0 / D) ** 0.5),
            "W_up": _w((lambda *s: torch.randn(*s, dtype=torch.bfloat16) * 0.1)(D, F) * (2.0 / D) ** 0.5),
            "W_down": _w((lambda *s: torch.randn(*s, dtype=torch.bfloat16) * 0.1)(F, D) * (1.0 / F) ** 0.5),
        }
    _B_in = _B_setup()

    return {
        "A_x": _A_in["x"],
        "A_wqkv": _A_in["wqkv"],
        "A_wo": _A_in["wo"],
        "B_x": _B_in["x"],
        "B_W_gate": _B_in["W_gate"],
        "B_W_up": _B_in["W_up"],
        "B_W_down": _B_in["W_down"],
    }

def reference(A_x, A_wqkv, A_wo, B_x, B_W_gate, B_W_up, B_W_down):
    def _A_ref(x, wqkv, wo):
        B, S, D = x.shape
        H = 32; Dh = D // H
        W, dil = 8, 2
        qkv = (lambda x, *d: x.permute(*d))((x @ wqkv).reshape(B, S, 3, H, Dh), 2, 0, 3, 1, 4)
        q, k, v = qkv[0], qkv[1], qkv[2]
        scale = Dh ** -0.5
        pos = torch.arange(S)
        off = torch.arange(W) * dil
        idx = pos[:, None] - off[None, :]
        mask = idx >= 0
        idx_c = torch.where(mask, idx, 0).reshape(-1)
        kg = k[:, :, idx_c, :].reshape(B, H, S, W, Dh)
        vg = v[:, :, idx_c, :].reshape(B, H, S, W, Dh)
        logits = torch.einsum("bhsd,bhswd->bhsw", q, kg) * scale
        logits = torch.where(mask[None, None, :, :], logits, -1e9)
        attn = _softmax(logits, axis=-1)
        o = torch.einsum("bhsw,bhswd->bhsd", attn, vg)
        return (lambda x, *d: x.permute(*d))(o, 0, 2, 1, 3).reshape(B, S, D) @ wo

    def _B_ref(x, W_gate, W_up, W_down):
        gate = torch.einsum("bsd,df->bsf", x, W_gate)
        up = torch.einsum("bsd,df->bsf", x, W_up)
        gate = gate * (lambda x, dt: x.to(dt))(gate > 0, gate.dtype)
        h = gate * up
        return torch.einsum("bsf,fd->bsd", h, W_down)

    x = A_x
    xn = _layernorm(x, axis=-1)
    s = _A_ref(xn, A_wqkv, A_wo)
    g = _silu(_B_ref(xn, B_W_gate, B_W_up, B_W_down))
    return x + s * g
```

```asm
; @launch grid=(256,1,1) block=(256,1,1) lds=163840
.amdgcn_target "amdgcn-amd-amdhsa--gfx950"
.text
.globl recurrent_scan__sliding_local_dilated__glu_gated_reglu__prompt_kernel
.p2align 8
.type recurrent_scan__sliding_local_dilated__glu_gated_reglu__prompt_kernel,@function
recurrent_scan__sliding_local_dilated__glu_gated_reglu__prompt_kernel:
 s_cmp_ge_u32 s2, 256
 s_cbranch_scc1 L1_end
 s_load_dwordx4 s[4:7], s[0:1], 0
 s_load_dwordx4 s[36:39], s[0:1], 32
 s_load_dwordx2 s[40:41], s[0:1], 48
 s_load_dwordx4 s[44:47], s[0:1], 64
 s_load_dwordx2 s[42:43], s[0:1], 16
 v_lshrrev_b32 v1, 6, v0
 v_and_b32 v0, 63, v0
 s_lshr_b32 s58, s2, 3
 v_readfirstlane_b32 s48, v1
 s_getpc_b64 s[86:87]
L1_pc:
 s_lshl_b32 s57, s58, 2
 s_add_u32 s57, s57, s48
 s_lshl_b32 s57, s57, 9
 v_and_b32 v20, 3, v0
 v_lshlrev_b32 v20, 7, v20
 v_add_u32 v20, s57, v20
 s_mov_b32 s57, L_codeend-L1_pc-4
 v_min_u32 v20, s57, v20
 global_load_dword v111, v20, s[86:87]
 s_and_b32 s57, s2, 7
 s_and_b32 s59, s57, 3
 s_lshl_b32 s51, s59, 2
 s_and_b32 s59, s58, 3
 s_add_u32 s51, s51, s59
 s_lshr_b32 s57, s57, 2
 s_lshl_b32 s57, s57, 3
 s_lshr_b32 s52, s58, 2
 s_add_u32 s52, s52, s57
 s_lshl_b32 s57, s52, 7
 s_lshl_b32 s58, s48, 5
 s_add_u32 s57, s57, s58
 v_lshrrev_b32 v16, 3, v0
 v_add_u32 v16, s57, v16
 v_mul_u32_u24 v16, 0x480, v16
 v_and_b32 v17, 7, v0
 v_lshl_add_u32 v16, v17, 4, v16
 s_mov_b32 s93, 9216
 s_mov_b32 s94, 18432
 s_mov_b32 s95, 27648
 s_waitcnt lgkmcnt(0)
 s_mov_b32 s8, s4
 s_and_b32 s9, s5, 0xffff
 s_mov_b32 s10, 2359296
 s_mov_b32 s11, 0x20000
 buffer_load_dwordx4 v[112:115], v16, s[8:11], 0 offen offset:0
 buffer_load_dwordx4 v[116:119], v16, s[8:11], s93 offen offset:0
 buffer_load_dwordx4 v[120:123], v16, s[8:11], s94 offen offset:0
 buffer_load_dwordx4 v[124:127], v16, s[8:11], s95 offen offset:0
 buffer_load_dwordx4 v[128:131], v16, s[8:11], 0 offen offset:128
 buffer_load_dwordx4 v[132:135], v16, s[8:11], s93 offen offset:128
 buffer_load_dwordx4 v[136:139], v16, s[8:11], s94 offen offset:128
 s_lshr_b32 s49, s48, 1
 s_and_b32 s50, s48, 1
 s_lshl_b32 s53, s48, 11
 v_and_b32 v109, 15, v0
 v_lshrrev_b32 v110, 4, v0
 s_mov_b32 s12, s6
 s_and_b32 s13, s7, 0xffff
 s_mov_b32 s14, 1990656
 s_mov_b32 s15, 0x20000
 s_mov_b32 s80, 0x3f803f80
 s_mov_b32 s81, 0xffff0000
 s_mul_i32 s57, s51, 72
 s_and_b32 s58, s57, 15
 s_sub_u32 s57, s57, s58
 s_lshl_b32 s59, s50, 3
 v_and_b32 v18, 3, v0
 v_lshrrev_b32 v19, 1, v18
 v_and_b32 v20, 1, v18
 v_cmp_eq_u32 vcc, 1, v110
 v_xor_b32 v21, 1, v20
 s_nop 0
 v_cndmask_b32 v21, v20, v21, vcc
 buffer_load_dwordx4 v[140:143], v16, s[8:11], s95 offen offset:128
 v_add_u32 v21, 2, v21
 v_cmp_eq_u32 vcc, s50, v19
 s_nop 1
 v_cndmask_b32 v21, v21, v20, vcc
 s_lshl_b32 s59, s50, 1
 v_add_u32 v22, s59, v18
 v_and_b32 v22, 3, v22
 v_cmp_eq_u32 vcc, 3, v22
 s_nop 1
 v_cndmask_b32 v22, v22, 0, vcc
 v_cmp_eq_u32 vcc, 3, v110
 s_nop 1
 v_cndmask_b32 v21, v21, 4, vcc
 v_cndmask_b32 v22, v110, v22, vcc
 s_mov_b32 s3, 0x43210
 s_cmp_eq_u32 s58, 0
 s_cselect_b32 s3, s3, 0x01243
 v_lshlrev_b32 v21, 2, v21
 v_lshrrev_b32 v21, v21, s3
 v_and_b32 v21, 7, v21
 v_lshrrev_b32 v20, 2, v0
 v_and_b32 v20, 3, v20
 s_lshl_b32 s59, s48, 3
 v_add_u32 v20, s59, v20
 buffer_load_dwordx4 v[144:147], v16, s[8:11], 0 offen offset:256
 v_mul_u32_u24 v20, 0xd80, v20
 v_mul_u32_u24 v22, 0x480, v22
 v_add_u32 v20, v20, v22
 v_lshl_add_u32 v20, v21, 4, v20
 v_add_u32 v2, s57, v20
 v_add_u32 v3, 12800, v2
 v_lshrrev_b32 v18, 2, v0
 v_and_b32 v18, 3, v18
 v_and_b32 v19, 3, v0
 s_mul_i32 s59, s50, 40
 s_add_u32 s59, s59, s58
 v_lshl_add_u32 v20, v19, 3, s59
 v_lshrrev_b32 v21, 4, v20
 v_lshrrev_b32 v20, 3, v20
 v_and_b32 v20, 1, v20
 s_mov_b32 s3, 0x43210
 s_cmp_eq_u32 s58, 0
 s_cselect_b32 s3, s3, 0x10234
 v_lshlrev_b32 v21, 2, v21
 v_lshrrev_b32 v21, v21, s3
 v_and_b32 v21, 7, v21
 buffer_load_dwordx4 v[148:151], v16, s[8:11], s93 offen offset:256
 v_and_b32 v23, 1, v110
 v_lshlrev_b32 v23, 1, v23
 v_sub_u32 v22, 2, v23
 v_lshlrev_b32 v24, 11, v110
 v_lshl_add_u32 v24, v20, 3, v24
 v_cmp_eq_u32 s[86:87], 4, v21
 v_cmp_gt_u32 s[88:89], 2, v21
 v_and_b32 v25, 1, v21
 v_add_u32 v26, v23, v21
 v_add_u32 v25, v22, v25
 v_cndmask_b32 v25, v25, v26, s[88:89]
 v_lshl_add_u32 v25, v18, 2, v25
 v_add_u32 v25, 0, v25
 v_lshl_add_u32 v26, v18, 2, v23
 v_add_u32 v26, 48, v26
 v_cndmask_b32 v25, v25, v26, s[86:87]
 v_lshl_add_u32 v10, v25, 4, v24
 v_and_b32 v25, 1, v21
 v_add_u32 v26, v23, v21
 v_xor_b32 v25, 1, v25
 v_add_u32 v25, v22, v25
 buffer_load_dwordx4 v[152:155], v16, s[8:11], s94 offen offset:256
 v_cndmask_b32 v25, v25, v26, s[88:89]
 v_lshl_add_u32 v25, v18, 2, v25
 v_add_u32 v25, 16, v25
 v_lshl_add_u32 v26, v18, 2, v23
 v_add_u32 v26, 49, v26
 v_cndmask_b32 v25, v25, v26, s[86:87]
 v_lshl_add_u32 v11, v25, 4, v24
 v_and_b32 v25, 1, v21
 v_add_u32 v26, v23, v21
 v_add_u32 v25, v22, v25
 v_cndmask_b32 v25, v25, v26, s[88:89]
 v_lshl_add_u32 v25, v18, 2, v25
 v_add_u32 v25, 32, v25
 v_lshl_add_u32 v26, v18, 2, v22
 v_add_u32 v26, 48, v26
 v_cndmask_b32 v25, v25, v26, s[86:87]
 v_lshl_add_u32 v12, v25, 4, v24
 v_min_u32 v20, 2, v19
 v_cmp_eq_u32 vcc, 1, v20
 s_nop 1
 v_cndmask_b32 v25, 0, 1, vcc
 v_add_u32 v25, v22, v25
 buffer_load_dwordx4 v[156:159], v16, s[8:11], s95 offen offset:256
 v_lshl_add_u32 v25, v18, 2, v25
 v_lshl_add_u32 v25, v20, 4, v25
 v_lshlrev_b32 v24, 11, v110
 v_add_u32 v24, s58, v24
 v_lshl_add_u32 v13, v25, 4, v24
 s_mov_b32 s16, s36
 s_and_b32 s17, s37, 0xffff
 s_mov_b32 s18, 5308416
 s_mov_b32 s19, 0x20000
 s_sub_u32 s20, s38, 1024
 s_subb_u32 s21, s39, 0
 s_and_b32 s21, s21, 0xffff
 s_mov_b32 s22, 5309440
 s_mov_b32 s23, 0x20000
 s_mov_b32 s24, s40
 s_and_b32 s25, s41, 0xffff
 s_mov_b32 s26, 5308416
 s_mov_b32 s27, 0x20000
 s_mov_b32 s32, s44
 s_and_b32 s33, s45, 0xffff
 s_mov_b32 s34, 256
 buffer_load_dwordx4 v[160:163], v16, s[8:11], 0 offen offset:384
 s_mov_b32 s35, 0x20000
 s_mov_b32 s28, s46
 s_and_b32 s29, s47, 0xffff
 s_mov_b32 s30, 268435456
 s_mov_b32 s31, 0x20000
 v_and_b32 v20, 7, v0
 v_lshrrev_b32 v21, 3, v0
 v_xor_b32 v21, v21, v20
 v_lshl_add_u32 v21, v19, 4, v21
 v_lshlrev_b32 v21, 4, v21
 v_lshrrev_b32 v20, 2, v20
 v_lshl_add_u32 v21, v20, 13, v21
 s_lshl_b32 s57, s48, 11
 s_add_u32 s57, s57, 90112
 v_add_u32 v97, s57, v21
 s_lshl_b32 s57, s49, 12
 s_add_u32 s57, s57, 90112
 v_add_u32 v20, 0, v110
 v_xor_b32 v20, v20, v109
 v_lshl_add_u32 v20, v110, 4, v20
 v_lshlrev_b32 v20, 4, v20
 buffer_load_dwordx4 v[164:167], v16, s[8:11], s93 offen offset:384
 v_add_u32 v6, s57, v20
 v_add_u32 v20, 4, v110
 v_xor_b32 v20, v20, v109
 v_lshl_add_u32 v20, v110, 4, v20
 v_lshlrev_b32 v20, 4, v20
 v_add_u32 v7, s57, v20
 v_lshlrev_b32 v20, 4, v0
 v_add_u32 v98, s57, v20
 v_add_u32 v101, 0x10000, v98
 s_lshl_b32 s58, s50, 13
 v_add_u32 v99, s58, v98
 s_lshl_b32 s58, s50, 3
 v_add_u32 v100, s58, v101
 v_and_b32 v58, 15, v0
 v_lshrrev_b32 v59, 4, v0
 v_lshrrev_b32 v56, 2, v0
 v_and_b32 v56, 3, v56
 v_and_b32 v57, 3, v0
 s_mul_i32 s57, s51, 288
 s_and_b32 s59, s51, 1
 s_lshl_b32 s3, s59, 5
 buffer_load_dwordx4 v[168:171], v16, s[8:11], s94 offen offset:384
 s_add_u32 s55, s57, s3
 s_xor_b32 s59, s59, 1
 s_lshl_b32 s59, s59, 8
 s_add_u32 s56, s57, s59
 v_lshrrev_b32 v52, 3, v0
 v_lshrrev_b32 v53, 1, v52
 v_and_b32 v53, 1, v53
 s_lshl_b32 s57, s50, 1
 v_or_b32 v53, s57, v53
 v_and_b32 v54, 7, v0
 v_lshrrev_b32 v55, 1, v54
 v_xor_b32 v55, v55, v53
 v_lshlrev_b32 v55, 5, v55
 v_and_b32 v54, 1, v54
 v_lshl_add_u32 v55, v54, 4, v55
 s_lshl_b32 s57, s48, 3
 v_add_u32 v52, s57, v52
 v_mul_u32_u24 v52, 0x2400, v52
 v_add_u32 v52, v52, v55
 s_lshl_b32 s57, s55, 1
 v_add_u32 v4, s57, v52
 buffer_load_dwordx4 v[172:175], v16, s[8:11], s95 offen offset:384
 v_lshrrev_b32 v52, 1, v56
 v_and_b32 v53, 1, v59
 v_lshl_or_b32 v52, v53, 1, v52
 v_lshlrev_b32 v53, 11, v59
 v_lshl_add_u32 v53, v56, 7, v53
 v_lshl_add_u32 v53, v57, 3, v53
 s_lshl_b32 s57, s50, 1
 s_add_u32 s57, s57, 0
 v_xor_b32 v54, s57, v52
 v_lshl_add_u32 v14, v54, 5, v53
 s_lshl_b32 s57, s50, 1
 s_add_u32 s57, s57, 1
 v_xor_b32 v54, s57, v52
 v_lshl_add_u32 v15, v54, 5, v53
 v_lshrrev_b32 v52, 2, v0
 v_lshrrev_b32 v53, 3, v52
 v_lshrrev_b32 v54, 1, v57
 v_xor_b32 v54, v54, v53
 v_lshlrev_b32 v54, 5, v54
 v_and_b32 v55, 1, v0
 v_lshl_add_u32 v54, v55, 4, v54
 buffer_load_dwordx4 v[176:179], v16, s[8:11], 0 offen offset:512
 s_lshl_b32 s57, s48, 4
 v_add_u32 v52, s57, v52
 v_mul_u32_u24 v52, 0x2400, v52
 v_add_u32 v52, v52, v54
 s_lshl_b32 s57, s56, 1
 v_add_u32 v5, s57, v52
 v_lshrrev_b32 v52, 1, v59
 v_and_b32 v53, 1, v59
 v_lshlrev_b32 v52, 11, v52
 v_lshl_add_u32 v54, v53, 3, v56
 v_lshl_add_u32 v52, v54, 6, v52
 v_xor_b32 v53, s50, v53
 v_lshl_add_u32 v52, v53, 5, v52
 v_lshl_add_u32 v96, v57, 3, v52
 s_mul_i32 s55, s55, 1152
 s_mul_i32 s56, s56, 1152
 v_lshlrev_b32 v52, 4, v0
 s_lshl_b32 s57, s52, 3
 s_lshl_b32 s58, s49, 2
 s_add_u32 s57, s57, s58
 s_mul_i32 s58, s57, 288
 buffer_load_dwordx4 v[180:183], v16, s[8:11], s93 offen offset:512
 s_add_u32 s58, s58, s51
 s_lshl_b32 s58, s58, 10
 s_lshl_b32 s59, s50, 15
 s_add_u32 s58, s58, s59
 v_add_u32 v102, s58, v52
 s_mul_i32 s58, s57, 18
 s_add_u32 s59, s58, s51
 s_lshl_b32 s59, s59, 10
 s_lshl_b32 s3, s50, 3
 s_add_u32 s59, s59, s3
 s_add_u32 s59, s59, 41943040
 v_add_u32 v103, s59, v52
 s_lshr_b32 s59, s51, 3
 s_add_u32 s58, s58, s59
 s_add_u32 s58, s58, 16
 s_lshl_b32 s58, s58, 10
 s_and_b32 s59, s51, 7
 s_lshr_b32 s59, s59, 1
 s_lshl_b32 s59, s59, 8
 s_add_u32 s58, s58, s59
 s_and_b32 s59, s51, 1
 buffer_load_dwordx4 v[184:187], v16, s[8:11], s94 offen offset:512
 s_lshl_b32 s59, s59, 3
 s_add_u32 s58, s58, s59
 s_lshl_b32 s59, s50, 2
 s_add_u32 s58, s58, s59
 s_add_u32 s58, s58, 41943040
 v_lshlrev_b32 v53, 4, v58
 v_add_u32 v53, s58, v53
 v_mov_b32 v54, 0x7ff00000
 v_cmp_eq_u32 vcc, 0, v59
 s_nop 1
 v_cndmask_b32 v104, v54, v53, vcc
 s_lshl_b32 s57, s52, 4
 s_add_u32 s57, s57, s51
 s_lshl_b32 s58, s57, 1
 s_add_u32 s58, s58, s50
 s_lshl_b32 s58, s58, 11
 s_add_u32 s58, s58, 46137344
 v_add_u32 v53, s58, v52
 v_add_u32 v106, 0xffff0000, v53
 s_cmp_eq_u32 s49, 1
 s_cselect_b64 s[86:87], -1, 0
 v_cndmask_b32 v105, v54, v53, s[86:87]
 buffer_load_dwordx4 v[188:191], v16, s[8:11], s95 offen offset:512
 s_cmp_eq_u32 s52, 0
 s_cselect_b32 s59, 1, 0
 s_or_b32 s59, s59, s49
 s_cmp_eq_u32 s59, 0
 s_cselect_b64 s[86:87], -1, 0
 v_cndmask_b32 v106, v54, v106, s[86:87]
 s_or_b32 s59, s52, s49
 s_cmp_eq_u32 s59, 0
 s_cselect_b32 s84, 1, 0
 s_lshl_b32 s59, s50, 11
 s_add_u32 s59, s59, 49152
 s_lshl_b32 s3, s49, 12
 s_sub_u32 s92, s59, s3
 s_lshl_b32 s59, s52, 2
 s_lshr_b32 s3, s51, 2
 s_add_u32 s59, s59, s3
 s_lshl_b32 s59, s59, 2
 s_and_b32 s3, s51, 3
 s_lshl_b32 s85, 1, s3
 v_mov_b32 v53, s59
 v_cmp_eq_u32 vcc, 0, v0
 buffer_load_dwordx4 v[192:195], v16, s[8:11], 0 offen offset:640
 s_nop 0
 v_cndmask_b32 v53, v54, v53, vcc
 s_cmp_eq_u32 s48, 2
 s_cselect_b64 s[86:87], -1, 0
 v_cndmask_b32 v107, v54, v53, s[86:87]
 s_sub_u32 s59, s59, 16
 v_mov_b32 v53, s59
 s_cmp_eq_u32 s52, 0
 s_cselect_b32 s3, 1, 0
 s_or_b32 s3, s3, s48
 s_cmp_eq_u32 s3, 0
 s_cselect_b32 s91, 0, 1
 s_cselect_b64 s[86:87], -1, 0
 v_cndmask_b32 v108, v54, v53, s[86:87]
 v_lshl_add_u32 v52, v59, 2, 0
 v_xor_b32 v53, v52, v58
 v_and_b32 v53, 1, v53
 v_add_u32 v55, 2, v58
 v_cmp_eq_u32 s[86:87], 0, v53
 v_cmp_ge_u32 s[60:61], v52, v55
 v_cmp_le_u32 s[68:69], v52, v58
 s_and_b64 s[60:61], s[60:61], s[86:87]
 buffer_load_dwordx4 v[196:199], v16, s[8:11], s93 offen offset:640
 s_and_b64 s[68:69], s[68:69], s[86:87]
 v_lshl_add_u32 v52, v59, 2, 1
 v_xor_b32 v53, v52, v58
 v_and_b32 v53, 1, v53
 v_add_u32 v55, 2, v58
 v_cmp_eq_u32 s[86:87], 0, v53
 v_cmp_ge_u32 s[62:63], v52, v55
 v_cmp_le_u32 s[70:71], v52, v58
 s_and_b64 s[62:63], s[62:63], s[86:87]
 s_and_b64 s[70:71], s[70:71], s[86:87]
 v_lshl_add_u32 v52, v59, 2, 2
 v_xor_b32 v53, v52, v58
 v_and_b32 v53, 1, v53
 v_add_u32 v55, 2, v58
 v_cmp_eq_u32 s[86:87], 0, v53
 v_cmp_ge_u32 s[64:65], v52, v55
 v_cmp_le_u32 s[72:73], v52, v58
 s_and_b64 s[64:65], s[64:65], s[86:87]
 s_and_b64 s[72:73], s[72:73], s[86:87]
 v_lshl_add_u32 v52, v59, 2, 3
 v_xor_b32 v53, v52, v58
 buffer_load_dwordx4 v[200:203], v16, s[8:11], s94 offen offset:640
 v_and_b32 v53, 1, v53
 v_add_u32 v55, 2, v58
 v_cmp_eq_u32 s[86:87], 0, v53
 v_cmp_ge_u32 s[66:67], v52, v55
 v_cmp_le_u32 s[74:75], v52, v58
 s_and_b64 s[66:67], s[66:67], s[86:87]
 s_and_b64 s[74:75], s[74:75], s[86:87]
 v_cmp_eq_u32 s[76:77], 1, v59
 s_lshl_b32 s57, s52, 7
 s_lshl_b32 s58, s51, 2
 s_add_u32 s57, s57, s58
 s_add_u32 s57, s57, 52428800
 v_mov_b32 v52, s57
 v_mov_b32 v53, 0x7ff00000
 v_cmp_eq_u32 vcc, 0, v0
 s_nop 1
 v_cndmask_b32 v52, v53, v52, vcc
 s_cmp_eq_u32 s48, 2
 s_cselect_b64 s[86:87], -1, 0
 v_cndmask_b32 v52, v53, v52, s[86:87]
 v_mov_b32 v53, 0
 buffer_store_dword v53, v52, s[28:31], 0 offen sc1
 buffer_load_dwordx4 v[204:207], v16, s[8:11], s95 offen offset:640
 s_cmp_eq_u32 s50, 1
 s_cselect_b64 s[78:79], -1, 0
 s_mov_b32 s82, 0x3eae1a93
 s_mov_b32 s83, 0xff800000
 v_mov_b32 v40, 0
 v_mov_b32 v41, 0
 v_mov_b32 v42, 0
 v_mov_b32 v43, 0
 v_mov_b32 v44, 0
 v_mov_b32 v45, 0
 v_mov_b32 v46, 0
 v_mov_b32 v47, 0
 buffer_load_dwordx4 v[208:211], v16, s[8:11], 0 offen offset:768
 buffer_load_dwordx4 v[212:215], v16, s[8:11], s93 offen offset:768
 buffer_load_dwordx4 v[216:219], v16, s[8:11], s94 offen offset:768
 buffer_load_dwordx4 v[220:223], v16, s[8:11], s95 offen offset:768
 s_waitcnt vmcnt(28)
 v_dot2c_f32_bf16 v40, s80, v112
 v_dot2c_f32_bf16 v44, v112, v112
 s_waitcnt vmcnt(27)
 v_dot2c_f32_bf16 v41, s80, v116
 v_dot2c_f32_bf16 v45, v116, v116
 s_waitcnt vmcnt(26)
 v_dot2c_f32_bf16 v42, s80, v120
 v_dot2c_f32_bf16 v46, v120, v120
 s_waitcnt vmcnt(25)
 v_dot2c_f32_bf16 v43, s80, v124
 v_dot2c_f32_bf16 v47, v124, v124
 v_dot2c_f32_bf16 v40, s80, v113
 v_dot2c_f32_bf16 v44, v113, v113
 v_dot2c_f32_bf16 v41, s80, v117
 v_dot2c_f32_bf16 v45, v117, v117
 v_dot2c_f32_bf16 v42, s80, v121
 v_dot2c_f32_bf16 v46, v121, v121
 v_dot2c_f32_bf16 v43, s80, v125
 v_dot2c_f32_bf16 v47, v125, v125
 v_dot2c_f32_bf16 v40, s80, v114
 v_dot2c_f32_bf16 v44, v114, v114
 v_dot2c_f32_bf16 v41, s80, v118
 v_dot2c_f32_bf16 v45, v118, v118
 v_dot2c_f32_bf16 v42, s80, v122
 v_dot2c_f32_bf16 v46, v122, v122
 v_dot2c_f32_bf16 v43, s80, v126
 v_dot2c_f32_bf16 v47, v126, v126
 v_dot2c_f32_bf16 v40, s80, v115
 v_dot2c_f32_bf16 v44, v115, v115
 v_dot2c_f32_bf16 v41, s80, v119
 v_dot2c_f32_bf16 v45, v119, v119
 v_dot2c_f32_bf16 v42, s80, v123
 v_dot2c_f32_bf16 v46, v123, v123
 v_dot2c_f32_bf16 v43, s80, v127
 v_dot2c_f32_bf16 v47, v127, v127
 buffer_load_dwordx4 v[224:227], v16, s[8:11], 0 offen offset:896
 buffer_load_dwordx4 v[228:231], v16, s[8:11], s93 offen offset:896
 buffer_load_dwordx4 v[232:235], v16, s[8:11], s94 offen offset:896
 buffer_load_dwordx4 v[236:239], v16, s[8:11], s95 offen offset:896
 s_waitcnt vmcnt(28)
 v_dot2c_f32_bf16 v40, s80, v128
 v_dot2c_f32_bf16 v44, v128, v128
 s_waitcnt vmcnt(27)
 v_dot2c_f32_bf16 v41, s80, v132
 v_dot2c_f32_bf16 v45, v132, v132
 s_waitcnt vmcnt(26)
 v_dot2c_f32_bf16 v42, s80, v136
 v_dot2c_f32_bf16 v46, v136, v136
 s_waitcnt vmcnt(25)
 v_dot2c_f32_bf16 v43, s80, v140
 v_dot2c_f32_bf16 v47, v140, v140
 v_dot2c_f32_bf16 v40, s80, v129
 v_dot2c_f32_bf16 v44, v129, v129
 v_dot2c_f32_bf16 v41, s80, v133
 v_dot2c_f32_bf16 v45, v133, v133
 v_dot2c_f32_bf16 v42, s80, v137
 v_dot2c_f32_bf16 v46, v137, v137
 v_dot2c_f32_bf16 v43, s80, v141
 v_dot2c_f32_bf16 v47, v141, v141
 v_dot2c_f32_bf16 v40, s80, v130
 v_dot2c_f32_bf16 v44, v130, v130
 v_dot2c_f32_bf16 v41, s80, v134
 v_dot2c_f32_bf16 v45, v134, v134
 v_dot2c_f32_bf16 v42, s80, v138
 v_dot2c_f32_bf16 v46, v138, v138
 v_dot2c_f32_bf16 v43, s80, v142
 v_dot2c_f32_bf16 v47, v142, v142
 v_dot2c_f32_bf16 v40, s80, v131
 v_dot2c_f32_bf16 v44, v131, v131
 v_dot2c_f32_bf16 v41, s80, v135
 v_dot2c_f32_bf16 v45, v135, v135
 v_dot2c_f32_bf16 v42, s80, v139
 v_dot2c_f32_bf16 v46, v139, v139
 v_dot2c_f32_bf16 v43, s80, v143
 v_dot2c_f32_bf16 v47, v143, v143
 buffer_load_dwordx4 v[240:243], v16, s[8:11], 0 offen offset:1024
 buffer_load_dwordx4 v[244:247], v16, s[8:11], s93 offen offset:1024
 buffer_load_dwordx4 v[248:251], v16, s[8:11], s94 offen offset:1024
 buffer_load_dwordx4 v[252:255], v16, s[8:11], s95 offen offset:1024
 s_waitcnt vmcnt(28)
 v_dot2c_f32_bf16 v40, s80, v144
 v_dot2c_f32_bf16 v44, v144, v144
 s_waitcnt vmcnt(27)
 v_dot2c_f32_bf16 v41, s80, v148
 v_dot2c_f32_bf16 v45, v148, v148
 s_waitcnt vmcnt(26)
 v_dot2c_f32_bf16 v42, s80, v152
 v_dot2c_f32_bf16 v46, v152, v152
 s_waitcnt vmcnt(25)
 v_dot2c_f32_bf16 v43, s80, v156
 v_dot2c_f32_bf16 v47, v156, v156
 v_dot2c_f32_bf16 v40, s80, v145
 v_dot2c_f32_bf16 v44, v145, v145
 v_dot2c_f32_bf16 v41, s80, v149
 v_dot2c_f32_bf16 v45, v149, v149
 v_dot2c_f32_bf16 v42, s80, v153
 v_dot2c_f32_bf16 v46, v153, v153
 v_dot2c_f32_bf16 v43, s80, v157
 v_dot2c_f32_bf16 v47, v157, v157
 v_dot2c_f32_bf16 v40, s80, v146
 v_dot2c_f32_bf16 v44, v146, v146
 v_dot2c_f32_bf16 v41, s80, v150
 v_dot2c_f32_bf16 v45, v150, v150
 v_dot2c_f32_bf16 v42, s80, v154
 v_dot2c_f32_bf16 v46, v154, v154
 v_dot2c_f32_bf16 v43, s80, v158
 v_dot2c_f32_bf16 v47, v158, v158
 v_dot2c_f32_bf16 v40, s80, v147
 v_dot2c_f32_bf16 v44, v147, v147
 v_dot2c_f32_bf16 v41, s80, v151
 v_dot2c_f32_bf16 v45, v151, v151
 v_dot2c_f32_bf16 v42, s80, v155
 v_dot2c_f32_bf16 v46, v155, v155
 v_dot2c_f32_bf16 v43, s80, v159
 v_dot2c_f32_bf16 v47, v159, v159
 s_add_u32 m0, s53, 139264
 s_mov_b32 s54, 0
 buffer_load_dwordx4 v2, s[12:15], s54 offen lds
 buffer_load_dwordx4 v3, s[12:15], s54 offen offset:1024 lds
 s_add_u32 m0, s53, 122880
 s_mov_b32 s54, 110592
 buffer_load_dwordx4 v2, s[12:15], s54 offen lds
 buffer_load_dwordx4 v3, s[12:15], s54 offen offset:1024 lds
 s_waitcnt vmcnt(28)
 v_dot2c_f32_bf16 v40, s80, v160
 v_dot2c_f32_bf16 v44, v160, v160
 s_waitcnt vmcnt(27)
 v_dot2c_f32_bf16 v41, s80, v164
 v_dot2c_f32_bf16 v45, v164, v164
 s_waitcnt vmcnt(26)
 v_dot2c_f32_bf16 v42, s80, v168
 v_dot2c_f32_bf16 v46, v168, v168
 s_waitcnt vmcnt(25)
 v_dot2c_f32_bf16 v43, s80, v172
 v_dot2c_f32_bf16 v47, v172, v172
 v_dot2c_f32_bf16 v40, s80, v161
 v_dot2c_f32_bf16 v44, v161, v161
 v_dot2c_f32_bf16 v41, s80, v165
 v_dot2c_f32_bf16 v45, v165, v165
 v_dot2c_f32_bf16 v42, s80, v169
 v_dot2c_f32_bf16 v46, v169, v169
 v_dot2c_f32_bf16 v43, s80, v173
 v_dot2c_f32_bf16 v47, v173, v173
 v_dot2c_f32_bf16 v40, s80, v162
 v_dot2c_f32_bf16 v44, v162, v162
 v_dot2c_f32_bf16 v41, s80, v166
 v_dot2c_f32_bf16 v45, v166, v166
 v_dot2c_f32_bf16 v42, s80, v170
 v_dot2c_f32_bf16 v46, v170, v170
 v_dot2c_f32_bf16 v43, s80, v174
 v_dot2c_f32_bf16 v47, v174, v174
 v_dot2c_f32_bf16 v40, s80, v163
 v_dot2c_f32_bf16 v44, v163, v163
 v_dot2c_f32_bf16 v41, s80, v167
 v_dot2c_f32_bf16 v45, v167, v167
 v_dot2c_f32_bf16 v42, s80, v171
 v_dot2c_f32_bf16 v46, v171, v171
 v_dot2c_f32_bf16 v43, s80, v175
 v_dot2c_f32_bf16 v47, v175, v175
 s_waitcnt vmcnt(24)
 v_dot2c_f32_bf16 v40, s80, v176
 v_dot2c_f32_bf16 v44, v176, v176
 s_waitcnt vmcnt(23)
 v_dot2c_f32_bf16 v41, s80, v180
 v_dot2c_f32_bf16 v45, v180, v180
 s_waitcnt vmcnt(22)
 v_dot2c_f32_bf16 v42, s80, v184
 v_dot2c_f32_bf16 v46, v184, v184
 s_waitcnt vmcnt(21)
 v_dot2c_f32_bf16 v43, s80, v188
 v_dot2c_f32_bf16 v47, v188, v188
 v_dot2c_f32_bf16 v40, s80, v177
 v_dot2c_f32_bf16 v44, v177, v177
 v_dot2c_f32_bf16 v41, s80, v181
 v_dot2c_f32_bf16 v45, v181, v181
 v_dot2c_f32_bf16 v42, s80, v185
 v_dot2c_f32_bf16 v46, v185, v185
 v_dot2c_f32_bf16 v43, s80, v189
 v_dot2c_f32_bf16 v47, v189, v189
 v_dot2c_f32_bf16 v40, s80, v178
 v_dot2c_f32_bf16 v44, v178, v178
 v_dot2c_f32_bf16 v41, s80, v182
 v_dot2c_f32_bf16 v45, v182, v182
 v_dot2c_f32_bf16 v42, s80, v186
 v_dot2c_f32_bf16 v46, v186, v186
 v_dot2c_f32_bf16 v43, s80, v190
 v_dot2c_f32_bf16 v47, v190, v190
 v_dot2c_f32_bf16 v40, s80, v179
 v_dot2c_f32_bf16 v44, v179, v179
 v_dot2c_f32_bf16 v41, s80, v183
 v_dot2c_f32_bf16 v45, v183, v183
 v_dot2c_f32_bf16 v42, s80, v187
 v_dot2c_f32_bf16 v46, v187, v187
 v_dot2c_f32_bf16 v43, s80, v191
 v_dot2c_f32_bf16 v47, v191, v191
 s_waitcnt vmcnt(20)
 v_dot2c_f32_bf16 v40, s80, v192
 v_dot2c_f32_bf16 v44, v192, v192
 s_waitcnt vmcnt(19)
 v_dot2c_f32_bf16 v41, s80, v196
 v_dot2c_f32_bf16 v45, v196, v196
 s_waitcnt vmcnt(18)
 v_dot2c_f32_bf16 v42, s80, v200
 v_dot2c_f32_bf16 v46, v200, v200
 s_waitcnt vmcnt(16)
 v_dot2c_f32_bf16 v43, s80, v204
 v_dot2c_f32_bf16 v47, v204, v204
 v_dot2c_f32_bf16 v40, s80, v193
 v_dot2c_f32_bf16 v44, v193, v193
 v_dot2c_f32_bf16 v41, s80, v197
 v_dot2c_f32_bf16 v45, v197, v197
 v_dot2c_f32_bf16 v42, s80, v201
 v_dot2c_f32_bf16 v46, v201, v201
 v_dot2c_f32_bf16 v43, s80, v205
 v_dot2c_f32_bf16 v47, v205, v205
 v_dot2c_f32_bf16 v40, s80, v194
 v_dot2c_f32_bf16 v44, v194, v194
 v_dot2c_f32_bf16 v41, s80, v198
 v_dot2c_f32_bf16 v45, v198, v198
 v_dot2c_f32_bf16 v42, s80, v202
 v_dot2c_f32_bf16 v46, v202, v202
 v_dot2c_f32_bf16 v43, s80, v206
 v_dot2c_f32_bf16 v47, v206, v206
 v_dot2c_f32_bf16 v40, s80, v195
 v_dot2c_f32_bf16 v44, v195, v195
 v_dot2c_f32_bf16 v41, s80, v199
 v_dot2c_f32_bf16 v45, v199, v199
 v_dot2c_f32_bf16 v42, s80, v203
 v_dot2c_f32_bf16 v46, v203, v203
 v_dot2c_f32_bf16 v43, s80, v207
 v_dot2c_f32_bf16 v47, v207, v207
 s_waitcnt vmcnt(15)
 v_dot2c_f32_bf16 v40, s80, v208
 v_dot2c_f32_bf16 v44, v208, v208
 s_waitcnt vmcnt(14)
 v_dot2c_f32_bf16 v41, s80, v212
 v_dot2c_f32_bf16 v45, v212, v212
 s_waitcnt vmcnt(13)
 v_dot2c_f32_bf16 v42, s80, v216
 v_dot2c_f32_bf16 v46, v216, v216
 s_waitcnt vmcnt(12)
 v_dot2c_f32_bf16 v43, s80, v220
 v_dot2c_f32_bf16 v47, v220, v220
 v_dot2c_f32_bf16 v40, s80, v209
 v_dot2c_f32_bf16 v44, v209, v209
 v_dot2c_f32_bf16 v41, s80, v213
 v_dot2c_f32_bf16 v45, v213, v213
 v_dot2c_f32_bf16 v42, s80, v217
 v_dot2c_f32_bf16 v46, v217, v217
 v_dot2c_f32_bf16 v43, s80, v221
 v_dot2c_f32_bf16 v47, v221, v221
 v_dot2c_f32_bf16 v40, s80, v210
 v_dot2c_f32_bf16 v44, v210, v210
 v_dot2c_f32_bf16 v41, s80, v214
 v_dot2c_f32_bf16 v45, v214, v214
 v_dot2c_f32_bf16 v42, s80, v218
 v_dot2c_f32_bf16 v46, v218, v218
 v_dot2c_f32_bf16 v43, s80, v222
 v_dot2c_f32_bf16 v47, v222, v222
 v_dot2c_f32_bf16 v40, s80, v211
 v_dot2c_f32_bf16 v44, v211, v211
 v_dot2c_f32_bf16 v41, s80, v215
 v_dot2c_f32_bf16 v45, v215, v215
 v_dot2c_f32_bf16 v42, s80, v219
 v_dot2c_f32_bf16 v46, v219, v219
 v_dot2c_f32_bf16 v43, s80, v223
 v_dot2c_f32_bf16 v47, v223, v223
 s_waitcnt vmcnt(11)
 v_dot2c_f32_bf16 v40, s80, v224
 v_dot2c_f32_bf16 v44, v224, v224
 s_waitcnt vmcnt(10)
 v_dot2c_f32_bf16 v41, s80, v228
 v_dot2c_f32_bf16 v45, v228, v228
 s_waitcnt vmcnt(9)
 v_dot2c_f32_bf16 v42, s80, v232
 v_dot2c_f32_bf16 v46, v232, v232
 s_waitcnt vmcnt(8)
 v_dot2c_f32_bf16 v43, s80, v236
 v_dot2c_f32_bf16 v47, v236, v236
 v_dot2c_f32_bf16 v40, s80, v225
 v_dot2c_f32_bf16 v44, v225, v225
 v_dot2c_f32_bf16 v41, s80, v229
 v_dot2c_f32_bf16 v45, v229, v229
 v_dot2c_f32_bf16 v42, s80, v233
 v_dot2c_f32_bf16 v46, v233, v233
 v_dot2c_f32_bf16 v43, s80, v237
 v_dot2c_f32_bf16 v47, v237, v237
 v_dot2c_f32_bf16 v40, s80, v226
 v_dot2c_f32_bf16 v44, v226, v226
 v_dot2c_f32_bf16 v41, s80, v230
 v_dot2c_f32_bf16 v45, v230, v230
 v_dot2c_f32_bf16 v42, s80, v234
 v_dot2c_f32_bf16 v46, v234, v234
 v_dot2c_f32_bf16 v43, s80, v238
 v_dot2c_f32_bf16 v47, v238, v238
 v_dot2c_f32_bf16 v40, s80, v227
 v_dot2c_f32_bf16 v44, v227, v227
 v_dot2c_f32_bf16 v41, s80, v231
 v_dot2c_f32_bf16 v45, v231, v231
 v_dot2c_f32_bf16 v42, s80, v235
 v_dot2c_f32_bf16 v46, v235, v235
 v_dot2c_f32_bf16 v43, s80, v239
 v_dot2c_f32_bf16 v47, v239, v239
 s_waitcnt vmcnt(7)
 v_dot2c_f32_bf16 v40, s80, v240
 v_dot2c_f32_bf16 v44, v240, v240
 s_waitcnt vmcnt(6)
 v_dot2c_f32_bf16 v41, s80, v244
 v_dot2c_f32_bf16 v45, v244, v244
 s_waitcnt vmcnt(5)
 v_dot2c_f32_bf16 v42, s80, v248
 v_dot2c_f32_bf16 v46, v248, v248
 s_waitcnt vmcnt(4)
 v_dot2c_f32_bf16 v43, s80, v252
 v_dot2c_f32_bf16 v47, v252, v252
 v_dot2c_f32_bf16 v40, s80, v241
 v_dot2c_f32_bf16 v44, v241, v241
 v_dot2c_f32_bf16 v41, s80, v245
 v_dot2c_f32_bf16 v45, v245, v245
 v_dot2c_f32_bf16 v42, s80, v249
 v_dot2c_f32_bf16 v46, v249, v249
 v_dot2c_f32_bf16 v43, s80, v253
 v_dot2c_f32_bf16 v47, v253, v253
 v_dot2c_f32_bf16 v40, s80, v242
 v_dot2c_f32_bf16 v44, v242, v242
 v_dot2c_f32_bf16 v41, s80, v246
 v_dot2c_f32_bf16 v45, v246, v246
 v_dot2c_f32_bf16 v42, s80, v250
 v_dot2c_f32_bf16 v46, v250, v250
 v_dot2c_f32_bf16 v43, s80, v254
 v_dot2c_f32_bf16 v47, v254, v254
 v_dot2c_f32_bf16 v40, s80, v243
 v_dot2c_f32_bf16 v44, v243, v243
 v_dot2c_f32_bf16 v41, s80, v247
 v_dot2c_f32_bf16 v45, v247, v247
 v_dot2c_f32_bf16 v42, s80, v251
 v_dot2c_f32_bf16 v46, v251, v251
 v_dot2c_f32_bf16 v43, s80, v255
 v_dot2c_f32_bf16 v47, v255, v255
 v_add_f32_dpp v40, v40, v40 quad_perm:[1,0,3,2] row_mask:0xf bank_mask:0xf
 v_add_f32_dpp v41, v41, v41 quad_perm:[1,0,3,2] row_mask:0xf bank_mask:0xf
 v_add_f32_dpp v42, v42, v42 quad_perm:[1,0,3,2] row_mask:0xf bank_mask:0xf
 v_add_f32_dpp v43, v43, v43 quad_perm:[1,0,3,2] row_mask:0xf bank_mask:0xf
 v_add_f32_dpp v44, v44, v44 quad_perm:[1,0,3,2] row_mask:0xf bank_mask:0xf
 v_add_f32_dpp v45, v45, v45 quad_perm:[1,0,3,2] row_mask:0xf bank_mask:0xf
 v_add_f32_dpp v46, v46, v46 quad_perm:[1,0,3,2] row_mask:0xf bank_mask:0xf
 v_add_f32_dpp v47, v47, v47 quad_perm:[1,0,3,2] row_mask:0xf bank_mask:0xf
 v_add_f32_dpp v40, v40, v40 quad_perm:[2,3,0,1] row_mask:0xf bank_mask:0xf
 v_add_f32_dpp v41, v41, v41 quad_perm:[2,3,0,1] row_mask:0xf bank_mask:0xf
 v_add_f32_dpp v42, v42, v42 quad_perm:[2,3,0,1] row_mask:0xf bank_mask:0xf
 v_add_f32_dpp v43, v43, v43 quad_perm:[2,3,0,1] row_mask:0xf bank_mask:0xf
 v_add_f32_dpp v44, v44, v44 quad_perm:[2,3,0,1] row_mask:0xf bank_mask:0xf
 v_add_f32_dpp v45, v45, v45 quad_perm:[2,3,0,1] row_mask:0xf bank_mask:0xf
 v_add_f32_dpp v46, v46, v46 quad_perm:[2,3,0,1] row_mask:0xf bank_mask:0xf
 v_add_f32_dpp v47, v47, v47 quad_perm:[2,3,0,1] row_mask:0xf bank_mask:0xf
 v_add_f32_dpp v40, v40, v40 row_half_mirror row_mask:0xf bank_mask:0xf
 v_add_f32_dpp v41, v41, v41 row_half_mirror row_mask:0xf bank_mask:0xf
 v_add_f32_dpp v42, v42, v42 row_half_mirror row_mask:0xf bank_mask:0xf
 v_add_f32_dpp v43, v43, v43 row_half_mirror row_mask:0xf bank_mask:0xf
 v_add_f32_dpp v44, v44, v44 row_half_mirror row_mask:0xf bank_mask:0xf
 v_add_f32_dpp v45, v45, v45 row_half_mirror row_mask:0xf bank_mask:0xf
 v_add_f32_dpp v46, v46, v46 row_half_mirror row_mask:0xf bank_mask:0xf
 v_add_f32_dpp v47, v47, v47 row_half_mirror row_mask:0xf bank_mask:0xf
 s_mov_b32 s57, 0x3ae38e39
 s_mov_b32 s58, 0x3727c5ac
 v_mul_f32 v40, s57, v40
 v_mul_f32 v44, s57, v44
 v_mul_f32 v41, s57, v41
 v_mul_f32 v45, s57, v45
 v_mul_f32 v42, s57, v42
 v_mul_f32 v46, s57, v46
 v_mul_f32 v43, s57, v43
 v_mul_f32 v47, s57, v47
 v_fma_f32 v44, -v40, v40, v44
 v_fma_f32 v45, -v41, v41, v45
 v_fma_f32 v46, -v42, v42, v46
 v_fma_f32 v47, -v43, v43, v47
 v_max_f32 v44, 0, v44
 v_max_f32 v45, 0, v45
 v_max_f32 v46, 0, v46
 v_max_f32 v47, 0, v47
 v_add_f32 v44, s58, v44
 v_add_f32 v45, s58, v45
 v_add_f32 v46, s58, v46
 v_add_f32 v47, s58, v47
 v_rsq_f32 v24, v44
 v_rsq_f32 v26, v45
 v_rsq_f32 v28, v46
 v_rsq_f32 v30, v47
 v_mul_f32 v32, v40, v24
 v_mul_f32 v34, v41, v26
 v_mul_f32 v36, v42, v28
 v_mul_f32 v38, v43, v30
 v_sub_f32 v32, 0, v32
 v_sub_f32 v34, 0, v34
 v_sub_f32 v36, 0, v36
 v_sub_f32 v38, 0, v38
 v_lshlrev_b32 v16, 16, v112
 v_lshlrev_b32 v18, 16, v113
 v_lshlrev_b32 v20, 16, v114
 v_lshlrev_b32 v22, 16, v115
 v_and_b32 v17, s81, v112
 v_and_b32 v19, s81, v113
 v_and_b32 v21, s81, v114
 v_and_b32 v23, s81, v115
 v_pk_fma_f32 v[16:17], v[16:17], v[24:25], v[32:33] op_sel_hi:[1,0,0]
 v_pk_fma_f32 v[18:19], v[18:19], v[24:25], v[32:33] op_sel_hi:[1,0,0]
 v_pk_fma_f32 v[20:21], v[20:21], v[24:25], v[32:33] op_sel_hi:[1,0,0]
 v_pk_fma_f32 v[22:23], v[22:23], v[24:25], v[32:33] op_sel_hi:[1,0,0]
 v_cvt_pk_bf16_f32 v112, v16, v17
 v_cvt_pk_bf16_f32 v113, v18, v19
 v_cvt_pk_bf16_f32 v114, v20, v21
 v_cvt_pk_bf16_f32 v115, v22, v23
 v_lshlrev_b32 v16, 16, v116
 v_lshlrev_b32 v18, 16, v117
 v_lshlrev_b32 v20, 16, v118
 v_lshlrev_b32 v22, 16, v119
 v_and_b32 v17, s81, v116
 v_and_b32 v19, s81, v117
 v_and_b32 v21, s81, v118
 v_and_b32 v23, s81, v119
 v_pk_fma_f32 v[16:17], v[16:17], v[26:27], v[34:35] op_sel_hi:[1,0,0]
 v_pk_fma_f32 v[18:19], v[18:19], v[26:27], v[34:35] op_sel_hi:[1,0,0]
 v_pk_fma_f32 v[20:21], v[20:21], v[26:27], v[34:35] op_sel_hi:[1,0,0]
 v_pk_fma_f32 v[22:23], v[22:23], v[26:27], v[34:35] op_sel_hi:[1,0,0]
 v_cvt_pk_bf16_f32 v116, v16, v17
 v_cvt_pk_bf16_f32 v117, v18, v19
 v_cvt_pk_bf16_f32 v118, v20, v21
 v_cvt_pk_bf16_f32 v119, v22, v23
 v_lshlrev_b32 v16, 16, v120
 v_lshlrev_b32 v18, 16, v121
 v_lshlrev_b32 v20, 16, v122
 v_lshlrev_b32 v22, 16, v123
 v_and_b32 v17, s81, v120
 v_and_b32 v19, s81, v121
 v_and_b32 v21, s81, v122
 v_and_b32 v23, s81, v123
 v_pk_fma_f32 v[16:17], v[16:17], v[28:29], v[36:37] op_sel_hi:[1,0,0]
 v_pk_fma_f32 v[18:19], v[18:19], v[28:29], v[36:37] op_sel_hi:[1,0,0]
 v_pk_fma_f32 v[20:21], v[20:21], v[28:29], v[36:37] op_sel_hi:[1,0,0]
 v_pk_fma_f32 v[22:23], v[22:23], v[28:29], v[36:37] op_sel_hi:[1,0,0]
 v_cvt_pk_bf16_f32 v120, v16, v17
 v_cvt_pk_bf16_f32 v121, v18, v19
 v_cvt_pk_bf16_f32 v122, v20, v21
 v_cvt_pk_bf16_f32 v123, v22, v23
 v_lshlrev_b32 v16, 16, v124
 v_lshlrev_b32 v18, 16, v125
 v_lshlrev_b32 v20, 16, v126
 v_lshlrev_b32 v22, 16, v127
 v_and_b32 v17, s81, v124
 v_and_b32 v19, s81, v125
 v_and_b32 v21, s81, v126
 v_and_b32 v23, s81, v127
 v_pk_fma_f32 v[16:17], v[16:17], v[30:31], v[38:39] op_sel_hi:[1,0,0]
 v_pk_fma_f32 v[18:19], v[18:19], v[30:31], v[38:39] op_sel_hi:[1,0,0]
 v_pk_fma_f32 v[20:21], v[20:21], v[30:31], v[38:39] op_sel_hi:[1,0,0]
 v_pk_fma_f32 v[22:23], v[22:23], v[30:31], v[38:39] op_sel_hi:[1,0,0]
 v_cvt_pk_bf16_f32 v124, v16, v17
 v_cvt_pk_bf16_f32 v125, v18, v19
 v_cvt_pk_bf16_f32 v126, v20, v21
 v_cvt_pk_bf16_f32 v127, v22, v23
 ds_write_b128 v97, v[112:115] offset:0
 ds_write_b128 v97, v[116:119] offset:128
 ds_write_b128 v97, v[120:123] offset:1024
 ds_write_b128 v97, v[124:127] offset:1152
 s_waitcnt vmcnt(0)
 s_waitcnt lgkmcnt(0)
 s_barrier
 ds_read_b128 a[0:3], v6 offset:0
 ds_read_b128 a[4:7], v6 offset:1024
 ds_read_b128 a[8:11], v6 offset:2048
 ds_read_b128 a[12:15], v6 offset:3072
 v_add_u32 v10, 0x20000, v10
 ds_read_b64_tr_b16 v[80:81], v10 offset:8192
 ds_read_b64_tr_b16 v[82:83], v10 offset:9216
 v_add_u32 v11, 0x20000, v11
 ds_read_b64_tr_b16 v[84:85], v11 offset:8192
 ds_read_b64_tr_b16 v[86:87], v11 offset:9216
 v_add_u32 v13, 0x20000, v13
 ds_read_b64_tr_b16 v[88:89], v13 offset:8192
 ds_read_b64_tr_b16 v[90:91], v13 offset:9216
 v_lshlrev_b32 v16, 16, v128
 v_lshlrev_b32 v18, 16, v129
 v_lshlrev_b32 v20, 16, v130
 v_lshlrev_b32 v22, 16, v131
 s_add_u32 m0, s53, 131072
 v_and_b32 v17, s81, v128
 v_and_b32 v19, s81, v129
 v_and_b32 v21, s81, v130
 v_and_b32 v23, s81, v131
 s_mov_b32 s54, 221184
 v_pk_fma_f32 v[16:17], v[16:17], v[24:25], v[32:33] op_sel_hi:[1,0,0]
 v_pk_fma_f32 v[18:19], v[18:19], v[24:25], v[32:33] op_sel_hi:[1,0,0]
 v_pk_fma_f32 v[20:21], v[20:21], v[24:25], v[32:33] op_sel_hi:[1,0,0]
 v_pk_fma_f32 v[22:23], v[22:23], v[24:25], v[32:33] op_sel_hi:[1,0,0]
 buffer_load_dwordx4 v2, s[12:15], s54 offen lds
 v_cvt_pk_bf16_f32 v128, v16, v17
 v_cvt_pk_bf16_f32 v129, v18, v19
 v_cvt_pk_bf16_f32 v130, v20, v21
 v_cvt_pk_bf16_f32 v131, v22, v23
 buffer_load_dwordx4 v3, s[12:15], s54 offen offset:1024 lds
 v_lshlrev_b32 v16, 16, v132
 v_lshlrev_b32 v18, 16, v133
 v_lshlrev_b32 v20, 16, v134
 v_lshlrev_b32 v22, 16, v135
 s_add_u32 m0, s53, 147456
 v_and_b32 v17, s81, v132
 v_and_b32 v19, s81, v133
 v_and_b32 v21, s81, v134
 v_and_b32 v23, s81, v135
 s_mov_b32 s54, 331776
 v_pk_fma_f32 v[16:17], v[16:17], v[26:27], v[34:35] op_sel_hi:[1,0,0]
 v_pk_fma_f32 v[18:19], v[18:19], v[26:27], v[34:35] op_sel_hi:[1,0,0]
 v_pk_fma_f32 v[20:21], v[20:21], v[26:27], v[34:35] op_sel_hi:[1,0,0]
 v_pk_fma_f32 v[22:23], v[22:23], v[26:27], v[34:35] op_sel_hi:[1,0,0]
 buffer_load_dwordx4 v2, s[12:15], s54 offen lds
 v_cvt_pk_bf16_f32 v132, v16, v17
 v_cvt_pk_bf16_f32 v133, v18, v19
 v_cvt_pk_bf16_f32 v134, v20, v21
 v_cvt_pk_bf16_f32 v135, v22, v23
 buffer_load_dwordx4 v3, s[12:15], s54 offen offset:1024 lds
 v_lshlrev_b32 v16, 16, v136
 v_lshlrev_b32 v18, 16, v137
 v_lshlrev_b32 v20, 16, v138
 v_lshlrev_b32 v22, 16, v139
 s_add_u32 m0, s53, 155648
 v_and_b32 v17, s81, v136
 v_and_b32 v19, s81, v137
 v_and_b32 v21, s81, v138
 v_and_b32 v23, s81, v139
 s_mov_b32 s54, 442368
 v_pk_fma_f32 v[16:17], v[16:17], v[28:29], v[36:37] op_sel_hi:[1,0,0]
 v_pk_fma_f32 v[18:19], v[18:19], v[28:29], v[36:37] op_sel_hi:[1,0,0]
 v_pk_fma_f32 v[20:21], v[20:21], v[28:29], v[36:37] op_sel_hi:[1,0,0]
 v_pk_fma_f32 v[22:23], v[22:23], v[28:29], v[36:37] op_sel_hi:[1,0,0]
 buffer_load_dwordx4 v2, s[12:15], s54 offen lds
 v_cvt_pk_bf16_f32 v136, v16, v17
 v_cvt_pk_bf16_f32 v137, v18, v19
 v_cvt_pk_bf16_f32 v138, v20, v21
 v_cvt_pk_bf16_f32 v139, v22, v23
 buffer_load_dwordx4 v3, s[12:15], s54 offen offset:1024 lds
 v_lshlrev_b32 v16, 16, v140
 v_lshlrev_b32 v18, 16, v141
 v_lshlrev_b32 v20, 16, v142
 v_lshlrev_b32 v22, 16, v143
 s_add_u32 m0, s53, 0
 v_and_b32 v17, s81, v140
 v_and_b32 v19, s81, v141
 v_and_b32 v21, s81, v142
 v_and_b32 v23, s81, v143
 s_mov_b32 s54, 552960
 v_pk_fma_f32 v[16:17], v[16:17], v[30:31], v[38:39] op_sel_hi:[1,0,0]
 v_pk_fma_f32 v[18:19], v[18:19], v[30:31], v[38:39] op_sel_hi:[1,0,0]
 v_pk_fma_f32 v[20:21], v[20:21], v[30:31], v[38:39] op_sel_hi:[1,0,0]
 v_pk_fma_f32 v[22:23], v[22:23], v[30:31], v[38:39] op_sel_hi:[1,0,0]
 buffer_load_dwordx4 v2, s[12:15], s54 offen lds
 v_cvt_pk_bf16_f32 v140, v16, v17
 v_cvt_pk_bf16_f32 v141, v18, v19
 v_cvt_pk_bf16_f32 v142, v20, v21
 v_cvt_pk_bf16_f32 v143, v22, v23
 buffer_load_dwordx4 v3, s[12:15], s54 offen offset:1024 lds
 v_lshlrev_b32 v16, 16, v144
 v_lshlrev_b32 v18, 16, v145
 v_lshlrev_b32 v20, 16, v146
 v_lshlrev_b32 v22, 16, v147
 s_add_u32 m0, s53, 8192
 v_and_b32 v17, s81, v144
 v_and_b32 v19, s81, v145
 v_and_b32 v21, s81, v146
 v_and_b32 v23, s81, v147
 s_mov_b32 s54, 663552
 v_pk_fma_f32 v[16:17], v[16:17], v[24:25], v[32:33] op_sel_hi:[1,0,0]
 v_pk_fma_f32 v[18:19], v[18:19], v[24:25], v[32:33] op_sel_hi:[1,0,0]
 v_pk_fma_f32 v[20:21], v[20:21], v[24:25], v[32:33] op_sel_hi:[1,0,0]
 v_pk_fma_f32 v[22:23], v[22:23], v[24:25], v[32:33] op_sel_hi:[1,0,0]
 buffer_load_dwordx4 v2, s[12:15], s54 offen lds
 v_cvt_pk_bf16_f32 v144, v16, v17
 v_cvt_pk_bf16_f32 v145, v18, v19
 v_cvt_pk_bf16_f32 v146, v20, v21
 v_cvt_pk_bf16_f32 v147, v22, v23
 buffer_load_dwordx4 v3, s[12:15], s54 offen offset:1024 lds
 v_lshlrev_b32 v16, 16, v148
 v_lshlrev_b32 v18, 16, v149
 v_lshlrev_b32 v20, 16, v150
 v_lshlrev_b32 v22, 16, v151
 s_add_u32 m0, s53, 16384
 v_and_b32 v17, s81, v148
 v_and_b32 v19, s81, v149
 v_and_b32 v21, s81, v150
 v_and_b32 v23, s81, v151
 s_mov_b32 s54, 774144
 v_pk_fma_f32 v[16:17], v[16:17], v[26:27], v[34:35] op_sel_hi:[1,0,0]
 v_pk_fma_f32 v[18:19], v[18:19], v[26:27], v[34:35] op_sel_hi:[1,0,0]
 v_pk_fma_f32 v[20:21], v[20:21], v[26:27], v[34:35] op_sel_hi:[1,0,0]
 v_pk_fma_f32 v[22:23], v[22:23], v[26:27], v[34:35] op_sel_hi:[1,0,0]
 buffer_load_dwordx4 v2, s[12:15], s54 offen lds
 v_cvt_pk_bf16_f32 v148, v16, v17
 v_cvt_pk_bf16_f32 v149, v18, v19
 v_cvt_pk_bf16_f32 v150, v20, v21
 v_cvt_pk_bf16_f32 v151, v22, v23
 buffer_load_dwordx4 v3, s[12:15], s54 offen offset:1024 lds
 v_lshlrev_b32 v16, 16, v152
 v_lshlrev_b32 v18, 16, v153
 v_lshlrev_b32 v20, 16, v154
 v_lshlrev_b32 v22, 16, v155
 s_mul_i32 s57, s48, 81
 v_and_b32 v17, s81, v152
 v_and_b32 v19, s81, v153
 v_and_b32 v21, s81, v154
 v_and_b32 v23, s81, v155
 s_add_u32 s57, s57, 0
 v_pk_fma_f32 v[16:17], v[16:17], v[28:29], v[36:37] op_sel_hi:[1,0,0]
 v_pk_fma_f32 v[18:19], v[18:19], v[28:29], v[36:37] op_sel_hi:[1,0,0]
 v_pk_fma_f32 v[20:21], v[20:21], v[28:29], v[36:37] op_sel_hi:[1,0,0]
 v_pk_fma_f32 v[22:23], v[22:23], v[28:29], v[36:37] op_sel_hi:[1,0,0]
 v_add_u32 v60, s57, v0
 v_cvt_pk_bf16_f32 v152, v16, v17
 v_cvt_pk_bf16_f32 v153, v18, v19
 v_cvt_pk_bf16_f32 v154, v20, v21
 v_cvt_pk_bf16_f32 v155, v22, v23
 s_mul_i32 s57, s51, 288
 v_lshlrev_b32 v16, 16, v156
 v_lshlrev_b32 v18, 16, v157
 v_lshlrev_b32 v20, 16, v158
 v_lshlrev_b32 v22, 16, v159
 s_mul_i32 s58, s52, 18
 v_and_b32 v17, s81, v156
 v_and_b32 v19, s81, v157
 v_and_b32 v21, s81, v158
 v_and_b32 v23, s81, v159
 s_add_u32 s57, s57, s58
 v_pk_fma_f32 v[16:17], v[16:17], v[30:31], v[38:39] op_sel_hi:[1,0,0]
 v_pk_fma_f32 v[18:19], v[18:19], v[30:31], v[38:39] op_sel_hi:[1,0,0]
 v_pk_fma_f32 v[20:21], v[20:21], v[30:31], v[38:39] op_sel_hi:[1,0,0]
 v_pk_fma_f32 v[22:23], v[22:23], v[30:31], v[38:39] op_sel_hi:[1,0,0]
 s_mul_i32 s57, s57, 1152
 v_cvt_pk_bf16_f32 v156, v16, v17
 v_cvt_pk_bf16_f32 v157, v18, v19
 v_cvt_pk_bf16_f32 v158, v20, v21
 v_cvt_pk_bf16_f32 v159, v22, v23
 v_lshlrev_b32 v61, 6, v60
 v_lshlrev_b32 v16, 16, v160
 v_lshlrev_b32 v18, 16, v161
 v_lshlrev_b32 v20, 16, v162
 v_lshlrev_b32 v22, 16, v163
 v_add_u32 v61, s57, v61
 v_and_b32 v17, s81, v160
 v_and_b32 v19, s81, v161
 v_and_b32 v21, s81, v162
 v_and_b32 v23, s81, v163
 buffer_load_dword v111, v61, s[24:27], 0 offen
 v_pk_fma_f32 v[16:17], v[16:17], v[24:25], v[32:33] op_sel_hi:[1,0,0]
 v_pk_fma_f32 v[18:19], v[18:19], v[24:25], v[32:33] op_sel_hi:[1,0,0]
 v_pk_fma_f32 v[20:21], v[20:21], v[24:25], v[32:33] op_sel_hi:[1,0,0]
 v_pk_fma_f32 v[22:23], v[22:23], v[24:25], v[32:33] op_sel_hi:[1,0,0]
 s_mul_i32 s57, s48, 81
 v_cvt_pk_bf16_f32 v160, v16, v17
 v_cvt_pk_bf16_f32 v161, v18, v19
 v_cvt_pk_bf16_f32 v162, v20, v21
 v_cvt_pk_bf16_f32 v163, v22, v23
 s_add_u32 s57, s57, 64
 v_lshlrev_b32 v16, 16, v164
 v_lshlrev_b32 v18, 16, v165
 v_lshlrev_b32 v20, 16, v166
 v_lshlrev_b32 v22, 16, v167
 v_add_u32 v60, s57, v0
 v_and_b32 v17, s81, v164
 v_and_b32 v19, s81, v165
 v_and_b32 v21, s81, v166
 v_and_b32 v23, s81, v167
 s_mul_i32 s57, s51, 288
 v_pk_fma_f32 v[16:17], v[16:17], v[26:27], v[34:35] op_sel_hi:[1,0,0]
 v_pk_fma_f32 v[18:19], v[18:19], v[26:27], v[34:35] op_sel_hi:[1,0,0]
 v_pk_fma_f32 v[20:21], v[20:21], v[26:27], v[34:35] op_sel_hi:[1,0,0]
 v_pk_fma_f32 v[22:23], v[22:23], v[26:27], v[34:35] op_sel_hi:[1,0,0]
 s_mul_i32 s58, s52, 18
 v_cvt_pk_bf16_f32 v164, v16, v17
 v_cvt_pk_bf16_f32 v165, v18, v19
 v_cvt_pk_bf16_f32 v166, v20, v21
 v_cvt_pk_bf16_f32 v167, v22, v23
 s_add_u32 s57, s57, s58
 v_lshlrev_b32 v16, 16, v168
 v_lshlrev_b32 v18, 16, v169
 v_lshlrev_b32 v20, 16, v170
 v_lshlrev_b32 v22, 16, v171
 s_mul_i32 s57, s57, 1152
 v_and_b32 v17, s81, v168
 v_and_b32 v19, s81, v169
 v_and_b32 v21, s81, v170
 v_and_b32 v23, s81, v171
 v_lshlrev_b32 v61, 6, v60
 v_pk_fma_f32 v[16:17], v[16:17], v[28:29], v[36:37] op_sel_hi:[1,0,0]
 v_pk_fma_f32 v[18:19], v[18:19], v[28:29], v[36:37] op_sel_hi:[1,0,0]
 v_pk_fma_f32 v[20:21], v[20:21], v[28:29], v[36:37] op_sel_hi:[1,0,0]
 v_pk_fma_f32 v[22:23], v[22:23], v[28:29], v[36:37] op_sel_hi:[1,0,0]
 v_add_u32 v61, s57, v61
 v_cvt_pk_bf16_f32 v168, v16, v17
 v_cvt_pk_bf16_f32 v169, v18, v19
 v_cvt_pk_bf16_f32 v170, v20, v21
 v_cvt_pk_bf16_f32 v171, v22, v23
 v_mov_b32 v62, 0x7ff00000
 v_lshlrev_b32 v16, 16, v172
 v_lshlrev_b32 v18, 16, v173
 v_lshlrev_b32 v20, 16, v174
 v_lshlrev_b32 v22, 16, v175
 v_cmp_gt_u32 vcc, 17, v0
 v_and_b32 v17, s81, v172
 v_and_b32 v19, s81, v173
 v_and_b32 v21, s81, v174
 v_and_b32 v23, s81, v175
 v_cndmask_b32 v61, v62, v61, vcc
 v_pk_fma_f32 v[16:17], v[16:17], v[30:31], v[38:39] op_sel_hi:[1,0,0]
 v_pk_fma_f32 v[18:19], v[18:19], v[30:31], v[38:39] op_sel_hi:[1,0,0]
 v_pk_fma_f32 v[20:21], v[20:21], v[30:31], v[38:39] op_sel_hi:[1,0,0]
 v_pk_fma_f32 v[22:23], v[22:23], v[30:31], v[38:39] op_sel_hi:[1,0,0]
 buffer_load_dword v111, v61, s[24:27], 0 offen
 v_cvt_pk_bf16_f32 v172, v16, v17
 v_cvt_pk_bf16_f32 v173, v18, v19
 v_cvt_pk_bf16_f32 v174, v20, v21
 v_cvt_pk_bf16_f32 v175, v22, v23
 s_mov_b32 s4, s42
 v_lshlrev_b32 v16, 16, v176
 v_lshlrev_b32 v18, 16, v177
 v_lshlrev_b32 v20, 16, v178
 v_lshlrev_b32 v22, 16, v179
 s_and_b32 s5, s43, 0xffff
 v_and_b32 v17, s81, v176
 v_and_b32 v19, s81, v177
 v_and_b32 v21, s81, v178
 v_and_b32 v23, s81, v179
 s_mov_b32 s6, 663552
 v_pk_fma_f32 v[16:17], v[16:17], v[24:25], v[32:33] op_sel_hi:[1,0,0]
 v_pk_fma_f32 v[18:19], v[18:19], v[24:25], v[32:33] op_sel_hi:[1,0,0]
 v_pk_fma_f32 v[20:21], v[20:21], v[24:25], v[32:33] op_sel_hi:[1,0,0]
 v_pk_fma_f32 v[22:23], v[22:23], v[24:25], v[32:33] op_sel_hi:[1,0,0]
 s_mov_b32 s7, 0x20000
 v_cvt_pk_bf16_f32 v176, v16, v17
 v_cvt_pk_bf16_f32 v177, v18, v19
 v_cvt_pk_bf16_f32 v178, v20, v21
 v_cvt_pk_bf16_f32 v179, v22, v23
 s_lshl_b32 s57, s2, 2
 v_lshlrev_b32 v16, 16, v180
 v_lshlrev_b32 v18, 16, v181
 v_lshlrev_b32 v20, 16, v182
 v_lshlrev_b32 v22, 16, v183
 s_add_u32 s57, s57, s48
 v_and_b32 v17, s81, v180
 v_and_b32 v19, s81, v181
 v_and_b32 v21, s81, v182
 v_and_b32 v23, s81, v183
 s_mul_i32 s57, s57, 648
 v_pk_fma_f32 v[16:17], v[16:17], v[26:27], v[34:35] op_sel_hi:[1,0,0]
 v_pk_fma_f32 v[18:19], v[18:19], v[26:27], v[34:35] op_sel_hi:[1,0,0]
 v_pk_fma_f32 v[20:21], v[20:21], v[26:27], v[34:35] op_sel_hi:[1,0,0]
 v_pk_fma_f32 v[22:23], v[22:23], v[26:27], v[34:35] op_sel_hi:[1,0,0]
 v_lshlrev_b32 v61, 6, v0
 v_cvt_pk_bf16_f32 v180, v16, v17
 v_cvt_pk_bf16_f32 v181, v18, v19
 v_cvt_pk_bf16_f32 v182, v20, v21
 v_cvt_pk_bf16_f32 v183, v22, v23
 v_add_u32 v61, s57, v61
 v_lshlrev_b32 v16, 16, v184
 v_lshlrev_b32 v18, 16, v185
 v_lshlrev_b32 v20, 16, v186
 v_lshlrev_b32 v22, 16, v187
 v_mov_b32 v62, 0x7ff00000
 v_and_b32 v17, s81, v184
 v_and_b32 v19, s81, v185
 v_and_b32 v21, s81, v186
 v_and_b32 v23, s81, v187
 v_cmp_gt_u32 vcc, 11, v0
 v_pk_fma_f32 v[16:17], v[16:17], v[28:29], v[36:37] op_sel_hi:[1,0,0]
 v_pk_fma_f32 v[18:19], v[18:19], v[28:29], v[36:37] op_sel_hi:[1,0,0]
 v_pk_fma_f32 v[20:21], v[20:21], v[28:29], v[36:37] op_sel_hi:[1,0,0]
 v_pk_fma_f32 v[22:23], v[22:23], v[28:29], v[36:37] op_sel_hi:[1,0,0]
 v_cndmask_b32 v61, v62, v61, vcc
 v_cvt_pk_bf16_f32 v184, v16, v17
 v_cvt_pk_bf16_f32 v185, v18, v19
 v_cvt_pk_bf16_f32 v186, v20, v21
 v_cvt_pk_bf16_f32 v187, v22, v23
 buffer_load_dword v111, v61, s[4:7], 0 offen
 v_lshlrev_b32 v16, 16, v188
 v_lshlrev_b32 v18, 16, v189
 v_lshlrev_b32 v20, 16, v190
 v_lshlrev_b32 v22, 16, v191
 v_and_b32 v17, s81, v188
 v_and_b32 v19, s81, v189
 v_and_b32 v21, s81, v190
 v_and_b32 v23, s81, v191
 v_pk_fma_f32 v[16:17], v[16:17], v[30:31], v[38:39] op_sel_hi:[1,0,0]
 v_pk_fma_f32 v[18:19], v[18:19], v[30:31], v[38:39] op_sel_hi:[1,0,0]
 v_pk_fma_f32 v[20:21], v[20:21], v[30:31], v[38:39] op_sel_hi:[1,0,0]
 v_pk_fma_f32 v[22:23], v[22:23], v[30:31], v[38:39] op_sel_hi:[1,0,0]
 v_cvt_pk_bf16_f32 v188, v16, v17
 v_cvt_pk_bf16_f32 v189, v18, v19
 v_cvt_pk_bf16_f32 v190, v20, v21
 v_cvt_pk_bf16_f32 v191, v22, v23
 v_lshlrev_b32 v16, 16, v192
 v_lshlrev_b32 v18, 16, v193
 v_lshlrev_b32 v20, 16, v194
 v_lshlrev_b32 v22, 16, v195
 v_and_b32 v17, s81, v192
 v_and_b32 v19, s81, v193
 v_and_b32 v21, s81, v194
 v_and_b32 v23, s81, v195
 v_pk_fma_f32 v[16:17], v[16:17], v[24:25], v[32:33] op_sel_hi:[1,0,0]
 v_pk_fma_f32 v[18:19], v[18:19], v[24:25], v[32:33] op_sel_hi:[1,0,0]
 v_pk_fma_f32 v[20:21], v[20:21], v[24:25], v[32:33] op_sel_hi:[1,0,0]
 v_pk_fma_f32 v[22:23], v[22:23], v[24:25], v[32:33] op_sel_hi:[1,0,0]
 v_cvt_pk_bf16_f32 v192, v16, v17
 v_cvt_pk_bf16_f32 v193, v18, v19
 v_cvt_pk_bf16_f32 v194, v20, v21
 v_cvt_pk_bf16_f32 v195, v22, v23
 v_lshlrev_b32 v16, 16, v196
 v_lshlrev_b32 v18, 16, v197
 v_lshlrev_b32 v20, 16, v198
 v_lshlrev_b32 v22, 16, v199
 v_and_b32 v17, s81, v196
 v_and_b32 v19, s81, v197
 v_and_b32 v21, s81, v198
 v_and_b32 v23, s81, v199
 v_pk_fma_f32 v[16:17], v[16:17], v[26:27], v[34:35] op_sel_hi:[1,0,0]
 v_pk_fma_f32 v[18:19], v[18:19], v[26:27], v[34:35] op_sel_hi:[1,0,0]
 v_pk_fma_f32 v[20:21], v[20:21], v[26:27], v[34:35] op_sel_hi:[1,0,0]
 v_pk_fma_f32 v[22:23], v[22:23], v[26:27], v[34:35] op_sel_hi:[1,0,0]
 v_cvt_pk_bf16_f32 v196, v16, v17
 v_cvt_pk_bf16_f32 v197, v18, v19
 v_cvt_pk_bf16_f32 v198, v20, v21
 v_cvt_pk_bf16_f32 v199, v22, v23
 v_lshlrev_b32 v16, 16, v200
 v_lshlrev_b32 v18, 16, v201
 v_lshlrev_b32 v20, 16, v202
 v_lshlrev_b32 v22, 16, v203
 v_and_b32 v17, s81, v200
 v_and_b32 v19, s81, v201
 v_and_b32 v21, s81, v202
 v_and_b32 v23, s81, v203
 v_pk_fma_f32 v[16:17], v[16:17], v[28:29], v[36:37] op_sel_hi:[1,0,0]
 v_pk_fma_f32 v[18:19], v[18:19], v[28:29], v[36:37] op_sel_hi:[1,0,0]
 v_pk_fma_f32 v[20:21], v[20:21], v[28:29], v[36:37] op_sel_hi:[1,0,0]
 v_pk_fma_f32 v[22:23], v[22:23], v[28:29], v[36:37] op_sel_hi:[1,0,0]
 v_cvt_pk_bf16_f32 v200, v16, v17
 v_cvt_pk_bf16_f32 v201, v18, v19
 v_cvt_pk_bf16_f32 v202, v20, v21
 v_cvt_pk_bf16_f32 v203, v22, v23
 v_lshlrev_b32 v16, 16, v204
 v_lshlrev_b32 v18, 16, v205
 v_lshlrev_b32 v20, 16, v206
 v_lshlrev_b32 v22, 16, v207
 v_and_b32 v17, s81, v204
 v_and_b32 v19, s81, v205
 v_and_b32 v21, s81, v206
 v_and_b32 v23, s81, v207
 v_pk_fma_f32 v[16:17], v[16:17], v[30:31], v[38:39] op_sel_hi:[1,0,0]
 v_pk_fma_f32 v[18:19], v[18:19], v[30:31], v[38:39] op_sel_hi:[1,0,0]
 v_pk_fma_f32 v[20:21], v[20:21], v[30:31], v[38:39] op_sel_hi:[1,0,0]
 v_pk_fma_f32 v[22:23], v[22:23], v[30:31], v[38:39] op_sel_hi:[1,0,0]
 v_cvt_pk_bf16_f32 v204, v16, v17
 v_cvt_pk_bf16_f32 v205, v18, v19
 v_cvt_pk_bf16_f32 v206, v20, v21
 v_cvt_pk_bf16_f32 v207, v22, v23
 v_lshlrev_b32 v16, 16, v208
 v_lshlrev_b32 v18, 16, v209
 v_lshlrev_b32 v20, 16, v210
 v_lshlrev_b32 v22, 16, v211
 v_and_b32 v17, s81, v208
 v_and_b32 v19, s81, v209
 v_and_b32 v21, s81, v210
 v_and_b32 v23, s81, v211
 v_pk_fma_f32 v[16:17], v[16:17], v[24:25], v[32:33] op_sel_hi:[1,0,0]
 v_pk_fma_f32 v[18:19], v[18:19], v[24:25], v[32:33] op_sel_hi:[1,0,0]
 v_pk_fma_f32 v[20:21], v[20:21], v[24:25], v[32:33] op_sel_hi:[1,0,0]
 v_pk_fma_f32 v[22:23], v[22:23], v[24:25], v[32:33] op_sel_hi:[1,0,0]
 v_cvt_pk_bf16_f32 v208, v16, v17
 v_cvt_pk_bf16_f32 v209, v18, v19
 v_cvt_pk_bf16_f32 v210, v20, v21
 v_cvt_pk_bf16_f32 v211, v22, v23
 v_lshlrev_b32 v16, 16, v212
 v_lshlrev_b32 v18, 16, v213
 v_lshlrev_b32 v20, 16, v214
 v_lshlrev_b32 v22, 16, v215
 v_and_b32 v17, s81, v212
 v_and_b32 v19, s81, v213
 v_and_b32 v21, s81, v214
 v_and_b32 v23, s81, v215
 v_pk_fma_f32 v[16:17], v[16:17], v[26:27], v[34:35] op_sel_hi:[1,0,0]
 v_pk_fma_f32 v[18:19], v[18:19], v[26:27], v[34:35] op_sel_hi:[1,0,0]
 v_pk_fma_f32 v[20:21], v[20:21], v[26:27], v[34:35] op_sel_hi:[1,0,0]
 v_pk_fma_f32 v[22:23], v[22:23], v[26:27], v[34:35] op_sel_hi:[1,0,0]
 v_cvt_pk_bf16_f32 v212, v16, v17
 v_cvt_pk_bf16_f32 v213, v18, v19
 v_cvt_pk_bf16_f32 v214, v20, v21
 v_cvt_pk_bf16_f32 v215, v22, v23
 v_lshlrev_b32 v16, 16, v216
 v_lshlrev_b32 v18, 16, v217
 v_lshlrev_b32 v20, 16, v218
 v_lshlrev_b32 v22, 16, v219
 v_and_b32 v17, s81, v216
 v_and_b32 v19, s81, v217
 v_and_b32 v21, s81, v218
 v_and_b32 v23, s81, v219
 v_pk_fma_f32 v[16:17], v[16:17], v[28:29], v[36:37] op_sel_hi:[1,0,0]
 v_pk_fma_f32 v[18:19], v[18:19], v[28:29], v[36:37] op_sel_hi:[1,0,0]
 v_pk_fma_f32 v[20:21], v[20:21], v[28:29], v[36:37] op_sel_hi:[1,0,0]
 v_pk_fma_f32 v[22:23], v[22:23], v[28:29], v[36:37] op_sel_hi:[1,0,0]
 v_cvt_pk_bf16_f32 v216, v16, v17
 v_cvt_pk_bf16_f32 v217, v18, v19
 v_cvt_pk_bf16_f32 v218, v20, v21
 v_cvt_pk_bf16_f32 v219, v22, v23
 v_lshlrev_b32 v16, 16, v220
 v_lshlrev_b32 v18, 16, v221
 v_lshlrev_b32 v20, 16, v222
 v_lshlrev_b32 v22, 16, v223
 v_and_b32 v17, s81, v220
 v_and_b32 v19, s81, v221
 v_and_b32 v21, s81, v222
 v_and_b32 v23, s81, v223
 v_pk_fma_f32 v[16:17], v[16:17], v[30:31], v[38:39] op_sel_hi:[1,0,0]
 v_pk_fma_f32 v[18:19], v[18:19], v[30:31], v[38:39] op_sel_hi:[1,0,0]
 v_pk_fma_f32 v[20:21], v[20:21], v[30:31], v[38:39] op_sel_hi:[1,0,0]
 v_pk_fma_f32 v[22:23], v[22:23], v[30:31], v[38:39] op_sel_hi:[1,0,0]
 v_cvt_pk_bf16_f32 v220, v16, v17
 v_cvt_pk_bf16_f32 v221, v18, v19
 v_cvt_pk_bf16_f32 v222, v20, v21
 v_cvt_pk_bf16_f32 v223, v22, v23
 v_lshlrev_b32 v16, 16, v224
 v_lshlrev_b32 v18, 16, v225
 v_lshlrev_b32 v20, 16, v226
 v_lshlrev_b32 v22, 16, v227
 v_and_b32 v17, s81, v224
 v_and_b32 v19, s81, v225
 v_and_b32 v21, s81, v226
 v_and_b32 v23, s81, v227
 v_pk_fma_f32 v[16:17], v[16:17], v[24:25], v[32:33] op_sel_hi:[1,0,0]
 v_pk_fma_f32 v[18:19], v[18:19], v[24:25], v[32:33] op_sel_hi:[1,0,0]
 v_pk_fma_f32 v[20:21], v[20:21], v[24:25], v[32:33] op_sel_hi:[1,0,0]
 v_pk_fma_f32 v[22:23], v[22:23], v[24:25], v[32:33] op_sel_hi:[1,0,0]
 v_cvt_pk_bf16_f32 v224, v16, v17
 v_cvt_pk_bf16_f32 v225, v18, v19
 v_cvt_pk_bf16_f32 v226, v20, v21
 v_cvt_pk_bf16_f32 v227, v22, v23
 v_lshlrev_b32 v16, 16, v228
 v_lshlrev_b32 v18, 16, v229
 v_lshlrev_b32 v20, 16, v230
 v_lshlrev_b32 v22, 16, v231
 v_and_b32 v17, s81, v228
 v_and_b32 v19, s81, v229
 v_and_b32 v21, s81, v230
 v_and_b32 v23, s81, v231
 v_pk_fma_f32 v[16:17], v[16:17], v[26:27], v[34:35] op_sel_hi:[1,0,0]
 v_pk_fma_f32 v[18:19], v[18:19], v[26:27], v[34:35] op_sel_hi:[1,0,0]
 v_pk_fma_f32 v[20:21], v[20:21], v[26:27], v[34:35] op_sel_hi:[1,0,0]
 v_pk_fma_f32 v[22:23], v[22:23], v[26:27], v[34:35] op_sel_hi:[1,0,0]
 v_cvt_pk_bf16_f32 v228, v16, v17
 v_cvt_pk_bf16_f32 v229, v18, v19
 v_cvt_pk_bf16_f32 v230, v20, v21
 v_cvt_pk_bf16_f32 v231, v22, v23
 v_lshlrev_b32 v16, 16, v232
 v_lshlrev_b32 v18, 16, v233
 v_lshlrev_b32 v20, 16, v234
 v_lshlrev_b32 v22, 16, v235
 v_and_b32 v17, s81, v232
 v_and_b32 v19, s81, v233
 v_and_b32 v21, s81, v234
 v_and_b32 v23, s81, v235
 v_pk_fma_f32 v[16:17], v[16:17], v[28:29], v[36:37] op_sel_hi:[1,0,0]
 v_pk_fma_f32 v[18:19], v[18:19], v[28:29], v[36:37] op_sel_hi:[1,0,0]
 v_pk_fma_f32 v[20:21], v[20:21], v[28:29], v[36:37] op_sel_hi:[1,0,0]
 v_pk_fma_f32 v[22:23], v[22:23], v[28:29], v[36:37] op_sel_hi:[1,0,0]
 v_cvt_pk_bf16_f32 v232, v16, v17
 v_cvt_pk_bf16_f32 v233, v18, v19
 v_cvt_pk_bf16_f32 v234, v20, v21
 v_cvt_pk_bf16_f32 v235, v22, v23
 v_lshlrev_b32 v16, 16, v236
 v_lshlrev_b32 v18, 16, v237
 v_lshlrev_b32 v20, 16, v238
 v_lshlrev_b32 v22, 16, v239
 v_and_b32 v17, s81, v236
 v_and_b32 v19, s81, v237
 v_and_b32 v21, s81, v238
 v_and_b32 v23, s81, v239
 v_pk_fma_f32 v[16:17], v[16:17], v[30:31], v[38:39] op_sel_hi:[1,0,0]
 v_pk_fma_f32 v[18:19], v[18:19], v[30:31], v[38:39] op_sel_hi:[1,0,0]
 v_pk_fma_f32 v[20:21], v[20:21], v[30:31], v[38:39] op_sel_hi:[1,0,0]
 v_pk_fma_f32 v[22:23], v[22:23], v[30:31], v[38:39] op_sel_hi:[1,0,0]
 v_cvt_pk_bf16_f32 v236, v16, v17
 v_cvt_pk_bf16_f32 v237, v18, v19
 v_cvt_pk_bf16_f32 v238, v20, v21
 v_cvt_pk_bf16_f32 v239, v22, v23
 v_lshlrev_b32 v16, 16, v240
 v_lshlrev_b32 v18, 16, v241
 v_lshlrev_b32 v20, 16, v242
 v_lshlrev_b32 v22, 16, v243
 v_and_b32 v17, s81, v240
 v_and_b32 v19, s81, v241
 v_and_b32 v21, s81, v242
 v_and_b32 v23, s81, v243
 v_pk_fma_f32 v[16:17], v[16:17], v[24:25], v[32:33] op_sel_hi:[1,0,0]
 v_pk_fma_f32 v[18:19], v[18:19], v[24:25], v[32:33] op_sel_hi:[1,0,0]
 v_pk_fma_f32 v[20:21], v[20:21], v[24:25], v[32:33] op_sel_hi:[1,0,0]
 v_pk_fma_f32 v[22:23], v[22:23], v[24:25], v[32:33] op_sel_hi:[1,0,0]
 v_cvt_pk_bf16_f32 v240, v16, v17
 v_cvt_pk_bf16_f32 v241, v18, v19
 v_cvt_pk_bf16_f32 v242, v20, v21
 v_cvt_pk_bf16_f32 v243, v22, v23
 v_lshlrev_b32 v16, 16, v244
 v_lshlrev_b32 v18, 16, v245
 v_lshlrev_b32 v20, 16, v246
 v_lshlrev_b32 v22, 16, v247
 v_and_b32 v17, s81, v244
 v_and_b32 v19, s81, v245
 v_and_b32 v21, s81, v246
 v_and_b32 v23, s81, v247
 v_pk_fma_f32 v[16:17], v[16:17], v[26:27], v[34:35] op_sel_hi:[1,0,0]
 v_pk_fma_f32 v[18:19], v[18:19], v[26:27], v[34:35] op_sel_hi:[1,0,0]
 v_pk_fma_f32 v[20:21], v[20:21], v[26:27], v[34:35] op_sel_hi:[1,0,0]
 v_pk_fma_f32 v[22:23], v[22:23], v[26:27], v[34:35] op_sel_hi:[1,0,0]
 v_cvt_pk_bf16_f32 v244, v16, v17
 v_cvt_pk_bf16_f32 v245, v18, v19
 v_cvt_pk_bf16_f32 v246, v20, v21
 v_cvt_pk_bf16_f32 v247, v22, v23
 v_lshlrev_b32 v16, 16, v248
 v_lshlrev_b32 v18, 16, v249
 v_lshlrev_b32 v20, 16, v250
 v_lshlrev_b32 v22, 16, v251
 v_and_b32 v17, s81, v248
 v_and_b32 v19, s81, v249
 v_and_b32 v21, s81, v250
 v_and_b32 v23, s81, v251
 v_pk_fma_f32 v[16:17], v[16:17], v[28:29], v[36:37] op_sel_hi:[1,0,0]
 v_pk_fma_f32 v[18:19], v[18:19], v[28:29], v[36:37] op_sel_hi:[1,0,0]
 v_pk_fma_f32 v[20:21], v[20:21], v[28:29], v[36:37] op_sel_hi:[1,0,0]
 v_pk_fma_f32 v[22:23], v[22:23], v[28:29], v[36:37] op_sel_hi:[1,0,0]
 v_cvt_pk_bf16_f32 v248, v16, v17
 v_cvt_pk_bf16_f32 v249, v18, v19
 v_cvt_pk_bf16_f32 v250, v20, v21
 v_cvt_pk_bf16_f32 v251, v22, v23
 v_lshlrev_b32 v16, 16, v252
 v_lshlrev_b32 v18, 16, v253
 v_lshlrev_b32 v20, 16, v254
 v_lshlrev_b32 v22, 16, v255
 v_and_b32 v17, s81, v252
 v_and_b32 v19, s81, v253
 v_and_b32 v21, s81, v254
 v_and_b32 v23, s81, v255
 v_pk_fma_f32 v[16:17], v[16:17], v[30:31], v[38:39] op_sel_hi:[1,0,0]
 v_pk_fma_f32 v[18:19], v[18:19], v[30:31], v[38:39] op_sel_hi:[1,0,0]
 v_pk_fma_f32 v[20:21], v[20:21], v[30:31], v[38:39] op_sel_hi:[1,0,0]
 v_pk_fma_f32 v[22:23], v[22:23], v[30:31], v[38:39] op_sel_hi:[1,0,0]
 v_cvt_pk_bf16_f32 v252, v16, v17
 v_cvt_pk_bf16_f32 v253, v18, v19
 v_cvt_pk_bf16_f32 v254, v20, v21
 v_cvt_pk_bf16_f32 v255, v22, v23
 s_waitcnt lgkmcnt(6)
 s_waitcnt lgkmcnt(4)
 v_mfma_f32_16x16x32_bf16 v[16:19], v[80:83], a[0:3], 0
 v_add_u32 v12, 0x20000, v12
 ds_read_b64_tr_b16 v[92:93], v12 offset:8192
 v_mfma_f32_16x16x32_bf16 v[20:23], v[80:83], a[4:7], 0
 ds_read_b64_tr_b16 v[94:95], v12 offset:9216
 v_mfma_f32_16x16x32_bf16 v[24:27], v[80:83], a[8:11], 0
 s_add_u32 m0, s53, 24576
 ds_read_b128 a[16:19], v7 offset:8192
 v_mfma_f32_16x16x32_bf16 v[28:31], v[80:83], a[12:15], 0
 ds_read_b128 a[20:23], v7 offset:9216
 s_waitcnt lgkmcnt(6)
 v_mfma_f32_16x16x32_bf16 v[32:35], v[84:87], a[0:3], 0
 v_add_u32 v10, 0xffff0000, v10
 ds_read_b64_tr_b16 v[80:81], v10 offset:57344
 v_mfma_f32_16x16x32_bf16 v[36:39], v[84:87], a[4:7], 0
 ds_read_b64_tr_b16 v[82:83], v10 offset:58368
 v_mfma_f32_16x16x32_bf16 v[40:43], v[84:87], a[8:11], 0
 s_mov_b32 s54, 884736
 ds_read_b128 a[24:27], v7 offset:10240
 v_mfma_f32_16x16x32_bf16 v[44:47], v[84:87], a[12:15], 0
 ds_read_b128 a[28:31], v7 offset:11264
 s_waitcnt lgkmcnt(8)
 v_mfma_f32_16x16x32_bf16 v[48:51], v[88:91], a[0:3], 0
 v_add_u32 v11, 0xffff0000, v11
 ds_read_b64_tr_b16 v[84:85], v11 offset:57344
 v_mfma_f32_16x16x32_bf16 v[52:55], v[88:91], a[4:7], 0
 ds_read_b64_tr_b16 v[86:87], v11 offset:58368
 v_mfma_f32_16x16x32_bf16 v[56:59], v[88:91], a[8:11], 0
 buffer_load_dwordx4 v2, s[12:15], s54 offen lds
 ds_write_b128 v97, v[128:131] offset:16384
 v_mfma_f32_16x16x32_bf16 v[60:63], v[88:91], a[12:15], 0
 ds_write_b128 v97, v[132:135] offset:16512
 s_waitcnt lgkmcnt(10)
 v_mfma_f32_16x16x32_bf16 v[64:67], a[0:3], v[92:95], 0
 v_add_u32 v13, 0xffff0000, v13
 ds_read_b64_tr_b16 v[88:89], v13 offset:57344
 v_mfma_f32_16x16x32_bf16 v[68:71], a[4:7], v[92:95], 0
 ds_read_b64_tr_b16 v[90:91], v13 offset:58368
 v_mfma_f32_16x16x32_bf16 v[72:75], a[8:11], v[92:95], 0
 buffer_load_dwordx4 v3, s[12:15], s54 offen offset:1024 lds
 ds_write_b128 v97, v[136:139] offset:17408
 v_mfma_f32_16x16x32_bf16 v[76:79], a[12:15], v[92:95], 0
 s_waitcnt lgkmcnt(7)
 v_mfma_f32_16x16x32_bf16 v[16:19], v[80:83], a[16:19], v[16:19]
 v_add_u32 v12, 0xffff0000, v12
 ds_read_b64_tr_b16 v[92:93], v12 offset:57344
 v_mfma_f32_16x16x32_bf16 v[20:23], v[80:83], a[20:23], v[20:23]
 ds_read_b64_tr_b16 v[94:95], v12 offset:58368
 v_mfma_f32_16x16x32_bf16 v[24:27], v[80:83], a[24:27], v[24:27]
 s_add_u32 m0, s53, 32768
 ds_write_b128 v97, v[140:143] offset:17536
 v_mfma_f32_16x16x32_bf16 v[28:31], v[80:83], a[28:31], v[28:31]
 s_waitcnt vmcnt(13)
 s_waitcnt lgkmcnt(0)
 s_barrier
 ds_read_b128 a[32:35], v6 offset:16384
 ds_read_b128 a[36:39], v6 offset:17408
 ds_read_b128 a[40:43], v6 offset:18432
 ds_read_b128 a[44:47], v6 offset:19456
 v_mfma_f32_16x16x32_bf16 v[32:35], v[84:87], a[16:19], v[32:35]
 v_add_u32 v10, 0x10000, v10
 ds_read_b64_tr_b16 v[80:81], v10 offset:0
 v_mfma_f32_16x16x32_bf16 v[36:39], v[84:87], a[20:23], v[36:39]
 ds_read_b64_tr_b16 v[82:83], v10 offset:1024
 v_mfma_f32_16x16x32_bf16 v[40:43], v[84:87], a[24:27], v[40:43]
 s_mov_b32 s54, 995328
 v_mfma_f32_16x16x32_bf16 v[44:47], v[84:87], a[28:31], v[44:47]
 v_mfma_f32_16x16x32_bf16 v[48:51], v[88:91], a[16:19], v[48:51]
 v_add_u32 v11, 0x10000, v11
 ds_read_b64_tr_b16 v[84:85], v11 offset:0
 v_mfma_f32_16x16x32_bf16 v[52:55], v[88:91], a[20:23], v[52:55]
 ds_read_b64_tr_b16 v[86:87], v11 offset:1024
 v_mfma_f32_16x16x32_bf16 v[56:59], v[88:91], a[24:27], v[56:59]
 buffer_load_dwordx4 v2, s[12:15], s54 offen lds
 v_mfma_f32_16x16x32_bf16 v[60:63], v[88:91], a[28:31], v[60:63]
 v_mfma_f32_16x16x32_bf16 v[64:67], a[16:19], v[92:95], v[64:67]
 v_add_u32 v13, 0x10000, v13
 ds_read_b64_tr_b16 v[88:89], v13 offset:0
 v_mfma_f32_16x16x32_bf16 v[68:71], a[20:23], v[92:95], v[68:71]
 ds_read_b64_tr_b16 v[90:91], v13 offset:1024
 v_mfma_f32_16x16x32_bf16 v[72:75], a[24:27], v[92:95], v[72:75]
 buffer_load_dwordx4 v3, s[12:15], s54 offen offset:1024 lds
 v_mfma_f32_16x16x32_bf16 v[76:79], a[28:31], v[92:95], v[76:79]
 s_waitcnt lgkmcnt(6)
 s_waitcnt lgkmcnt(4)
 v_mfma_f32_16x16x32_bf16 v[16:19], v[80:83], a[32:35], v[16:19]
 v_add_u32 v12, 0x10000, v12
 ds_read_b64_tr_b16 v[92:93], v12 offset:0
 v_mfma_f32_16x16x32_bf16 v[20:23], v[80:83], a[36:39], v[20:23]
 ds_read_b64_tr_b16 v[94:95], v12 offset:1024
 v_mfma_f32_16x16x32_bf16 v[24:27], v[80:83], a[40:43], v[24:27]
 s_add_u32 m0, s53, 139264
 ds_read_b128 a[48:51], v7 offset:24576
 v_mfma_f32_16x16x32_bf16 v[28:31], v[80:83], a[44:47], v[28:31]
 ds_read_b128 a[52:55], v7 offset:25600
 s_waitcnt lgkmcnt(6)
 v_mfma_f32_16x16x32_bf16 v[32:35], v[84:87], a[32:35], v[32:35]
 ds_read_b64_tr_b16 v[80:81], v10 offset:16384
 v_mfma_f32_16x16x32_bf16 v[36:39], v[84:87], a[36:39], v[36:39]
 ds_read_b64_tr_b16 v[82:83], v10 offset:17408
 v_mfma_f32_16x16x32_bf16 v[40:43], v[84:87], a[40:43], v[40:43]
 s_mov_b32 s54, 1105920
 ds_read_b128 a[56:59], v7 offset:26624
 v_mfma_f32_16x16x32_bf16 v[44:47], v[84:87], a[44:47], v[44:47]
 ds_read_b128 a[60:63], v7 offset:27648
 s_waitcnt lgkmcnt(8)
 v_mfma_f32_16x16x32_bf16 v[48:51], v[88:91], a[32:35], v[48:51]
 ds_read_b64_tr_b16 v[84:85], v11 offset:16384
 v_mfma_f32_16x16x32_bf16 v[52:55], v[88:91], a[36:39], v[52:55]
 ds_read_b64_tr_b16 v[86:87], v11 offset:17408
 v_mfma_f32_16x16x32_bf16 v[56:59], v[88:91], a[40:43], v[56:59]
 buffer_load_dwordx4 v2, s[12:15], s54 offen lds
 ds_write_b128 v97, v[144:147] offset:0
 v_mfma_f32_16x16x32_bf16 v[60:63], v[88:91], a[44:47], v[60:63]
 ds_write_b128 v97, v[148:151] offset:128
 s_waitcnt lgkmcnt(10)
 v_mfma_f32_16x16x32_bf16 v[64:67], a[32:35], v[92:95], v[64:67]
 ds_read_b64_tr_b16 v[88:89], v13 offset:16384
 v_mfma_f32_16x16x32_bf16 v[68:71], a[36:39], v[92:95], v[68:71]
 ds_read_b64_tr_b16 v[90:91], v13 offset:17408
 v_mfma_f32_16x16x32_bf16 v[72:75], a[40:43], v[92:95], v[72:75]
 buffer_load_dwordx4 v3, s[12:15], s54 offen offset:1024 lds
 ds_write_b128 v97, v[152:155] offset:1024
 v_mfma_f32_16x16x32_bf16 v[76:79], a[44:47], v[92:95], v[76:79]
 s_waitcnt lgkmcnt(7)
 v_mfma_f32_16x16x32_bf16 v[16:19], v[80:83], a[48:51], v[16:19]
 ds_read_b64_tr_b16 v[92:93], v12 offset:16384
 v_mfma_f32_16x16x32_bf16 v[20:23], v[80:83], a[52:55], v[20:23]
 ds_read_b64_tr_b16 v[94:95], v12 offset:17408
 v_mfma_f32_16x16x32_bf16 v[24:27], v[80:83], a[56:59], v[24:27]
 s_add_u32 m0, s53, 40960
 ds_write_b128 v97, v[156:159] offset:1152
 v_mfma_f32_16x16x32_bf16 v[28:31], v[80:83], a[60:63], v[28:31]
 s_waitcnt vmcnt(13)
 s_waitcnt lgkmcnt(0)
 s_barrier
 ds_read_b128 a[64:67], v6 offset:0
 ds_read_b128 a[68:71], v6 offset:1024
 ds_read_b128 a[72:75], v6 offset:2048
 ds_read_b128 a[76:79], v6 offset:3072
 v_mfma_f32_16x16x32_bf16 v[32:35], v[84:87], a[48:51], v[32:35]
 ds_read_b64_tr_b16 v[80:81], v10 offset:24576
 v_mfma_f32_16x16x32_bf16 v[36:39], v[84:87], a[52:55], v[36:39]
 ds_read_b64_tr_b16 v[82:83], v10 offset:25600
 v_mfma_f32_16x16x32_bf16 v[40:43], v[84:87], a[56:59], v[40:43]
 s_mov_b32 s54, 1216512
 v_mfma_f32_16x16x32_bf16 v[44:47], v[84:87], a[60:63], v[44:47]
 v_mfma_f32_16x16x32_bf16 v[48:51], v[88:91], a[48:51], v[48:51]
 ds_read_b64_tr_b16 v[84:85], v11 offset:24576
 v_mfma_f32_16x16x32_bf16 v[52:55], v[88:91], a[52:55], v[52:55]
 ds_read_b64_tr_b16 v[86:87], v11 offset:25600
 v_mfma_f32_16x16x32_bf16 v[56:59], v[88:91], a[56:59], v[56:59]
 buffer_load_dwordx4 v2, s[12:15], s54 offen lds
 v_mfma_f32_16x16x32_bf16 v[60:63], v[88:91], a[60:63], v[60:63]
 v_mfma_f32_16x16x32_bf16 v[64:67], a[48:51], v[92:95], v[64:67]
 ds_read_b64_tr_b16 v[88:89], v13 offset:24576
 v_mfma_f32_16x16x32_bf16 v[68:71], a[52:55], v[92:95], v[68:71]
 ds_read_b64_tr_b16 v[90:91], v13 offset:25600
 v_mfma_f32_16x16x32_bf16 v[72:75], a[56:59], v[92:95], v[72:75]
 buffer_load_dwordx4 v3, s[12:15], s54 offen offset:1024 lds
 v_mfma_f32_16x16x32_bf16 v[76:79], a[60:63], v[92:95], v[76:79]
 s_waitcnt lgkmcnt(6)
 s_waitcnt lgkmcnt(4)
 v_mfma_f32_16x16x32_bf16 v[16:19], v[80:83], a[64:67], v[16:19]
 ds_read_b64_tr_b16 v[92:93], v12 offset:24576
 v_mfma_f32_16x16x32_bf16 v[20:23], v[80:83], a[68:71], v[20:23]
 ds_read_b64_tr_b16 v[94:95], v12 offset:25600
 v_mfma_f32_16x16x32_bf16 v[24:27], v[80:83], a[72:75], v[24:27]
 s_add_u32 m0, s53, 122880
 ds_read_b128 a[80:83], v7 offset:8192
 v_mfma_f32_16x16x32_bf16 v[28:31], v[80:83], a[76:79], v[28:31]
 ds_read_b128 a[84:87], v7 offset:9216
 s_waitcnt lgkmcnt(6)
 v_mfma_f32_16x16x32_bf16 v[32:35], v[84:87], a[64:67], v[32:35]
 v_add_u32 v10, 0xfffe0000, v10
 ds_read_b64_tr_b16 v[80:81], v10 offset:0
 v_mfma_f32_16x16x32_bf16 v[36:39], v[84:87], a[68:71], v[36:39]
 ds_read_b64_tr_b16 v[82:83], v10 offset:1024
 v_mfma_f32_16x16x32_bf16 v[40:43], v[84:87], a[72:75], v[40:43]
 s_mov_b32 s54, 1327104
 ds_read_b128 a[88:91], v7 offset:10240
 v_mfma_f32_16x16x32_bf16 v[44:47], v[84:87], a[76:79], v[44:47]
 ds_read_b128 a[92:95], v7 offset:11264
 s_waitcnt lgkmcnt(8)
 v_mfma_f32_16x16x32_bf16 v[48:51], v[88:91], a[64:67], v[48:51]
 v_add_u32 v11, 0xfffe0000, v11
 ds_read_b64_tr_b16 v[84:85], v11 offset:0
 v_mfma_f32_16x16x32_bf16 v[52:55], v[88:91], a[68:71], v[52:55]
 ds_read_b64_tr_b16 v[86:87], v11 offset:1024
 v_mfma_f32_16x16x32_bf16 v[56:59], v[88:91], a[72:75], v[56:59]
 buffer_load_dwordx4 v2, s[12:15], s54 offen lds
 ds_write_b128 v97, v[160:163] offset:16384
 v_mfma_f32_16x16x32_bf16 v[60:63], v[88:91], a[76:79], v[60:63]
 ds_write_b128 v97, v[164:167] offset:16512
 s_waitcnt lgkmcnt(10)
 v_mfma_f32_16x16x32_bf16 v[64:67], a[64:67], v[92:95], v[64:67]
 v_add_u32 v13, 0xfffe0000, v13
 ds_read_b64_tr_b16 v[88:89], v13 offset:0
 v_mfma_f32_16x16x32_bf16 v[68:71], a[68:71], v[92:95], v[68:71]
 ds_read_b64_tr_b16 v[90:91], v13 offset:1024
 v_mfma_f32_16x16x32_bf16 v[72:75], a[72:75], v[92:95], v[72:75]
 buffer_load_dwordx4 v3, s[12:15], s54 offen offset:1024 lds
 ds_write_b128 v97, v[168:171] offset:17408
 v_mfma_f32_16x16x32_bf16 v[76:79], a[76:79], v[92:95], v[76:79]
 s_waitcnt lgkmcnt(7)
 v_mfma_f32_16x16x32_bf16 v[16:19], v[80:83], a[80:83], v[16:19]
 v_add_u32 v12, 0xfffe0000, v12
 ds_read_b64_tr_b16 v[92:93], v12 offset:0
 v_mfma_f32_16x16x32_bf16 v[20:23], v[80:83], a[84:87], v[20:23]
 ds_read_b64_tr_b16 v[94:95], v12 offset:1024
 v_mfma_f32_16x16x32_bf16 v[24:27], v[80:83], a[88:91], v[24:27]
 s_add_u32 m0, s53, 131072
 ds_write_b128 v97, v[172:175] offset:17536
 v_mfma_f32_16x16x32_bf16 v[28:31], v[80:83], a[92:95], v[28:31]
 s_waitcnt vmcnt(13)
 s_waitcnt lgkmcnt(0)
 s_barrier
 ds_read_b128 a[96:99], v6 offset:16384
 ds_read_b128 a[100:103], v6 offset:17408
 ds_read_b128 a[104:107], v6 offset:18432
 ds_read_b128 a[108:111], v6 offset:19456
 v_mfma_f32_16x16x32_bf16 v[32:35], v[84:87], a[80:83], v[32:35]
 ds_read_b64_tr_b16 v[80:81], v10 offset:8192
 v_mfma_f32_16x16x32_bf16 v[36:39], v[84:87], a[84:87], v[36:39]
 ds_read_b64_tr_b16 v[82:83], v10 offset:9216
 v_mfma_f32_16x16x32_bf16 v[40:43], v[84:87], a[88:91], v[40:43]
 s_mov_b32 s54, 1437696
 v_mfma_f32_16x16x32_bf16 v[44:47], v[84:87], a[92:95], v[44:47]
 v_mfma_f32_16x16x32_bf16 v[48:51], v[88:91], a[80:83], v[48:51]
 ds_read_b64_tr_b16 v[84:85], v11 offset:8192
 v_mfma_f32_16x16x32_bf16 v[52:55], v[88:91], a[84:87], v[52:55]
 ds_read_b64_tr_b16 v[86:87], v11 offset:9216
 v_mfma_f32_16x16x32_bf16 v[56:59], v[88:91], a[88:91], v[56:59]
 buffer_load_dwordx4 v2, s[12:15], s54 offen lds
 v_mfma_f32_16x16x32_bf16 v[60:63], v[88:91], a[92:95], v[60:63]
 v_mfma_f32_16x16x32_bf16 v[64:67], a[80:83], v[92:95], v[64:67]
 ds_read_b64_tr_b16 v[88:89], v13 offset:8192
 v_mfma_f32_16x16x32_bf16 v[68:71], a[84:87], v[92:95], v[68:71]
 ds_read_b64_tr_b16 v[90:91], v13 offset:9216
 v_mfma_f32_16x16x32_bf16 v[72:75], a[88:91], v[92:95], v[72:75]
 buffer_load_dwordx4 v3, s[12:15], s54 offen offset:1024 lds
 v_mfma_f32_16x16x32_bf16 v[76:79], a[92:95], v[92:95], v[76:79]
 s_waitcnt lgkmcnt(6)
 s_waitcnt lgkmcnt(4)
 v_mfma_f32_16x16x32_bf16 v[16:19], v[80:83], a[96:99], v[16:19]
 ds_read_b64_tr_b16 v[92:93], v12 offset:8192
 v_mfma_f32_16x16x32_bf16 v[20:23], v[80:83], a[100:103], v[20:23]
 ds_read_b64_tr_b16 v[94:95], v12 offset:9216
 v_mfma_f32_16x16x32_bf16 v[24:27], v[80:83], a[104:107], v[24:27]
 s_add_u32 m0, s53, 147456
 ds_read_b128 a[112:115], v7 offset:24576
 v_mfma_f32_16x16x32_bf16 v[28:31], v[80:83], a[108:111], v[28:31]
 ds_read_b128 a[116:119], v7 offset:25600
 s_waitcnt lgkmcnt(6)
 v_mfma_f32_16x16x32_bf16 v[32:35], v[84:87], a[96:99], v[32:35]
 ds_read_b64_tr_b16 v[80:81], v10 offset:16384
 v_mfma_f32_16x16x32_bf16 v[36:39], v[84:87], a[100:103], v[36:39]
 ds_read_b64_tr_b16 v[82:83], v10 offset:17408
 v_mfma_f32_16x16x32_bf16 v[40:43], v[84:87], a[104:107], v[40:43]
 s_mov_b32 s54, 1548288
 ds_read_b128 a[120:123], v7 offset:26624
 v_mfma_f32_16x16x32_bf16 v[44:47], v[84:87], a[108:111], v[44:47]
 ds_read_b128 a[124:127], v7 offset:27648
 s_waitcnt lgkmcnt(8)
 v_mfma_f32_16x16x32_bf16 v[48:51], v[88:91], a[96:99], v[48:51]
 ds_read_b64_tr_b16 v[84:85], v11 offset:16384
 v_mfma_f32_16x16x32_bf16 v[52:55], v[88:91], a[100:103], v[52:55]
 ds_read_b64_tr_b16 v[86:87], v11 offset:17408
 v_mfma_f32_16x16x32_bf16 v[56:59], v[88:91], a[104:107], v[56:59]
 buffer_load_dwordx4 v2, s[12:15], s54 offen lds
 ds_write_b128 v97, v[176:179] offset:0
 v_mfma_f32_16x16x32_bf16 v[60:63], v[88:91], a[108:111], v[60:63]
 ds_write_b128 v97, v[180:183] offset:128
 s_waitcnt lgkmcnt(10)
 v_mfma_f32_16x16x32_bf16 v[64:67], a[96:99], v[92:95], v[64:67]
 ds_read_b64_tr_b16 v[88:89], v13 offset:16384
 v_mfma_f32_16x16x32_bf16 v[68:71], a[100:103], v[92:95], v[68:71]
 ds_read_b64_tr_b16 v[90:91], v13 offset:17408
 v_mfma_f32_16x16x32_bf16 v[72:75], a[104:107], v[92:95], v[72:75]
 buffer_load_dwordx4 v3, s[12:15], s54 offen offset:1024 lds
 ds_write_b128 v97, v[184:187] offset:1024
 v_mfma_f32_16x16x32_bf16 v[76:79], a[108:111], v[92:95], v[76:79]
 s_waitcnt lgkmcnt(7)
 v_mfma_f32_16x16x32_bf16 v[16:19], v[80:83], a[112:115], v[16:19]
 ds_read_b64_tr_b16 v[92:93], v12 offset:16384
 v_mfma_f32_16x16x32_bf16 v[20:23], v[80:83], a[116:119], v[20:23]
 ds_read_b64_tr_b16 v[94:95], v12 offset:17408
 v_mfma_f32_16x16x32_bf16 v[24:27], v[80:83], a[120:123], v[24:27]
 s_add_u32 m0, s53, 155648
 ds_write_b128 v97, v[188:191] offset:1152
 v_mfma_f32_16x16x32_bf16 v[28:31], v[80:83], a[124:127], v[28:31]
 s_waitcnt vmcnt(10)
 s_waitcnt lgkmcnt(0)
 s_barrier
 ds_read_b128 a[128:131], v6 offset:0
 ds_read_b128 a[132:135], v6 offset:1024
 ds_read_b128 a[136:139], v6 offset:2048
 ds_read_b128 a[140:143], v6 offset:3072
 v_mfma_f32_16x16x32_bf16 v[32:35], v[84:87], a[112:115], v[32:35]
 ds_read_b64_tr_b16 v[80:81], v10 offset:24576
 v_mfma_f32_16x16x32_bf16 v[36:39], v[84:87], a[116:119], v[36:39]
 ds_read_b64_tr_b16 v[82:83], v10 offset:25600
 v_mfma_f32_16x16x32_bf16 v[40:43], v[84:87], a[120:123], v[40:43]
 s_mov_b32 s54, 1658880
 v_mfma_f32_16x16x32_bf16 v[44:47], v[84:87], a[124:127], v[44:47]
 v_mfma_f32_16x16x32_bf16 v[48:51], v[88:91], a[112:115], v[48:51]
 ds_read_b64_tr_b16 v[84:85], v11 offset:24576
 v_mfma_f32_16x16x32_bf16 v[52:55], v[88:91], a[116:119], v[52:55]
 ds_read_b64_tr_b16 v[86:87], v11 offset:25600
 v_mfma_f32_16x16x32_bf16 v[56:59], v[88:91], a[120:123], v[56:59]
 buffer_load_dwordx4 v2, s[12:15], s54 offen lds
 v_mfma_f32_16x16x32_bf16 v[60:63], v[88:91], a[124:127], v[60:63]
 v_mfma_f32_16x16x32_bf16 v[64:67], a[112:115], v[92:95], v[64:67]
 ds_read_b64_tr_b16 v[88:89], v13 offset:24576
 v_mfma_f32_16x16x32_bf16 v[68:71], a[116:119], v[92:95], v[68:71]
 ds_read_b64_tr_b16 v[90:91], v13 offset:25600
 v_mfma_f32_16x16x32_bf16 v[72:75], a[120:123], v[92:95], v[72:75]
 buffer_load_dwordx4 v3, s[12:15], s54 offen offset:1024 lds
 v_mfma_f32_16x16x32_bf16 v[76:79], a[124:127], v[92:95], v[76:79]
 s_waitcnt lgkmcnt(6)
 s_waitcnt lgkmcnt(4)
 v_mfma_f32_16x16x32_bf16 v[16:19], v[80:83], a[128:131], v[16:19]
 ds_read_b64_tr_b16 v[92:93], v12 offset:24576
 v_mfma_f32_16x16x32_bf16 v[20:23], v[80:83], a[132:135], v[20:23]
 ds_read_b64_tr_b16 v[94:95], v12 offset:25600
 v_mfma_f32_16x16x32_bf16 v[24:27], v[80:83], a[136:139], v[24:27]
 s_add_u32 m0, s53, 0
 ds_read_b128 a[144:147], v7 offset:8192
 v_mfma_f32_16x16x32_bf16 v[28:31], v[80:83], a[140:143], v[28:31]
 ds_read_b128 a[148:151], v7 offset:9216
 s_waitcnt lgkmcnt(6)
 v_mfma_f32_16x16x32_bf16 v[32:35], v[84:87], a[128:131], v[32:35]
 ds_read_b64_tr_b16 v[80:81], v10 offset:32768
 v_mfma_f32_16x16x32_bf16 v[36:39], v[84:87], a[132:135], v[36:39]
 ds_read_b64_tr_b16 v[82:83], v10 offset:33792
 v_mfma_f32_16x16x32_bf16 v[40:43], v[84:87], a[136:139], v[40:43]
 s_mov_b32 s54, 1769472
 ds_read_b128 a[152:155], v7 offset:10240
 v_mfma_f32_16x16x32_bf16 v[44:47], v[84:87], a[140:143], v[44:47]
 ds_read_b128 a[156:159], v7 offset:11264
 s_waitcnt lgkmcnt(8)
 v_mfma_f32_16x16x32_bf16 v[48:51], v[88:91], a[128:131], v[48:51]
 ds_read_b64_tr_b16 v[84:85], v11 offset:32768
 v_mfma_f32_16x16x32_bf16 v[52:55], v[88:91], a[132:135], v[52:55]
 ds_read_b64_tr_b16 v[86:87], v11 offset:33792
 v_mfma_f32_16x16x32_bf16 v[56:59], v[88:91], a[136:139], v[56:59]
 buffer_load_dwordx4 v2, s[12:15], s54 offen lds
 ds_write_b128 v97, v[192:195] offset:16384
 v_mfma_f32_16x16x32_bf16 v[60:63], v[88:91], a[140:143], v[60:63]
 ds_write_b128 v97, v[196:199] offset:16512
 s_waitcnt lgkmcnt(10)
 v_mfma_f32_16x16x32_bf16 v[64:67], a[128:131], v[92:95], v[64:67]
 ds_read_b64_tr_b16 v[88:89], v13 offset:32768
 v_mfma_f32_16x16x32_bf16 v[68:71], a[132:135], v[92:95], v[68:71]
 ds_read_b64_tr_b16 v[90:91], v13 offset:33792
 v_mfma_f32_16x16x32_bf16 v[72:75], a[136:139], v[92:95], v[72:75]
 buffer_load_dwordx4 v3, s[12:15], s54 offen offset:1024 lds
 ds_write_b128 v97, v[200:203] offset:17408
 v_mfma_f32_16x16x32_bf16 v[76:79], a[140:143], v[92:95], v[76:79]
 s_waitcnt lgkmcnt(7)
 v_mfma_f32_16x16x32_bf16 v[16:19], v[80:83], a[144:147], v[16:19]
 ds_read_b64_tr_b16 v[92:93], v12 offset:32768
 v_mfma_f32_16x16x32_bf16 v[20:23], v[80:83], a[148:151], v[20:23]
 ds_read_b64_tr_b16 v[94:95], v12 offset:33792
 v_mfma_f32_16x16x32_bf16 v[24:27], v[80:83], a[152:155], v[24:27]
 s_add_u32 m0, s53, 8192
 ds_write_b128 v97, v[204:207] offset:17536
 v_mfma_f32_16x16x32_bf16 v[28:31], v[80:83], a[156:159], v[28:31]
 s_waitcnt vmcnt(10)
 s_waitcnt lgkmcnt(0)
 s_barrier
 ds_read_b128 a[160:163], v6 offset:16384
 ds_read_b128 a[164:167], v6 offset:17408
 ds_read_b128 a[168:171], v6 offset:18432
 ds_read_b128 a[172:175], v6 offset:19456
 v_mfma_f32_16x16x32_bf16 v[32:35], v[84:87], a[144:147], v[32:35]
 v_add_u32 v10, 0x20000, v10
 ds_read_b64_tr_b16 v[80:81], v10 offset:8192
 v_mfma_f32_16x16x32_bf16 v[36:39], v[84:87], a[148:151], v[36:39]
 ds_read_b64_tr_b16 v[82:83], v10 offset:9216
 v_mfma_f32_16x16x32_bf16 v[40:43], v[84:87], a[152:155], v[40:43]
 s_mov_b32 s54, 1880064
 v_mfma_f32_16x16x32_bf16 v[44:47], v[84:87], a[156:159], v[44:47]
 v_mfma_f32_16x16x32_bf16 v[48:51], v[88:91], a[144:147], v[48:51]
 v_add_u32 v11, 0x20000, v11
 ds_read_b64_tr_b16 v[84:85], v11 offset:8192
 v_mfma_f32_16x16x32_bf16 v[52:55], v[88:91], a[148:151], v[52:55]
 ds_read_b64_tr_b16 v[86:87], v11 offset:9216
 v_mfma_f32_16x16x32_bf16 v[56:59], v[88:91], a[152:155], v[56:59]
 buffer_load_dwordx4 v2, s[12:15], s54 offen lds
 v_mfma_f32_16x16x32_bf16 v[60:63], v[88:91], a[156:159], v[60:63]
 v_mfma_f32_16x16x32_bf16 v[64:67], a[144:147], v[92:95], v[64:67]
 v_add_u32 v13, 0x20000, v13
 ds_read_b64_tr_b16 v[88:89], v13 offset:8192
 v_mfma_f32_16x16x32_bf16 v[68:71], a[148:151], v[92:95], v[68:71]
 ds_read_b64_tr_b16 v[90:91], v13 offset:9216
 v_mfma_f32_16x16x32_bf16 v[72:75], a[152:155], v[92:95], v[72:75]
 buffer_load_dwordx4 v3, s[12:15], s54 offen offset:1024 lds
 v_mfma_f32_16x16x32_bf16 v[76:79], a[156:159], v[92:95], v[76:79]
 s_waitcnt lgkmcnt(6)
 s_waitcnt lgkmcnt(4)
 v_mfma_f32_16x16x32_bf16 v[16:19], v[80:83], a[160:163], v[16:19]
 v_add_u32 v12, 0x20000, v12
 ds_read_b64_tr_b16 v[92:93], v12 offset:8192
 v_mfma_f32_16x16x32_bf16 v[20:23], v[80:83], a[164:167], v[20:23]
 ds_read_b64_tr_b16 v[94:95], v12 offset:9216
 v_mfma_f32_16x16x32_bf16 v[24:27], v[80:83], a[168:171], v[24:27]
 s_add_u32 m0, s53, 16384
 ds_read_b128 a[176:179], v7 offset:24576
 v_mfma_f32_16x16x32_bf16 v[28:31], v[80:83], a[172:175], v[28:31]
 ds_read_b128 a[180:183], v7 offset:25600
 s_waitcnt lgkmcnt(6)
 v_mfma_f32_16x16x32_bf16 v[32:35], v[84:87], a[160:163], v[32:35]
 v_add_u32 v10, 0xfffe0000, v10
 ds_read_b64_tr_b16 v[80:81], v10 offset:40960
 v_mfma_f32_16x16x32_bf16 v[36:39], v[84:87], a[164:167], v[36:39]
 ds_read_b64_tr_b16 v[82:83], v10 offset:41984
 v_mfma_f32_16x16x32_bf16 v[40:43], v[84:87], a[168:171], v[40:43]
 s_mov_b32 s54, 0
 ds_read_b128 a[184:187], v7 offset:26624
 v_mfma_f32_16x16x32_bf16 v[44:47], v[84:87], a[172:175], v[44:47]
 ds_read_b128 a[188:191], v7 offset:27648
 s_waitcnt lgkmcnt(8)
 v_mfma_f32_16x16x32_bf16 v[48:51], v[88:91], a[160:163], v[48:51]
 v_add_u32 v11, 0xfffe0000, v11
 ds_read_b64_tr_b16 v[84:85], v11 offset:40960
 v_mfma_f32_16x16x32_bf16 v[52:55], v[88:91], a[164:167], v[52:55]
 ds_read_b64_tr_b16 v[86:87], v11 offset:41984
 v_mfma_f32_16x16x32_bf16 v[56:59], v[88:91], a[168:171], v[56:59]
 buffer_load_dwordx4 v4, s[16:19], s54 offen lds
 ds_write_b128 v97, v[208:211] offset:0
 v_mfma_f32_16x16x32_bf16 v[60:63], v[88:91], a[172:175], v[60:63]
 ds_write_b128 v97, v[212:215] offset:128
 s_waitcnt lgkmcnt(10)
 v_mfma_f32_16x16x32_bf16 v[64:67], a[160:163], v[92:95], v[64:67]
 v_add_u32 v13, 0xfffe0000, v13
 ds_read_b64_tr_b16 v[88:89], v13 offset:40960
 v_mfma_f32_16x16x32_bf16 v[68:71], a[164:167], v[92:95], v[68:71]
 ds_read_b64_tr_b16 v[90:91], v13 offset:41984
 v_mfma_f32_16x16x32_bf16 v[72:75], a[168:171], v[92:95], v[72:75]
 buffer_load_dwordx4 v4, s[20:23], s54 offen offset:1024 lds
 ds_write_b128 v97, v[216:219] offset:1024
 v_mfma_f32_16x16x32_bf16 v[76:79], a[172:175], v[92:95], v[76:79]
 s_waitcnt lgkmcnt(7)
 v_mfma_f32_16x16x32_bf16 v[16:19], v[80:83], a[176:179], v[16:19]
 v_add_u32 v12, 0xfffe0000, v12
 ds_read_b64_tr_b16 v[92:93], v12 offset:40960
 v_mfma_f32_16x16x32_bf16 v[20:23], v[80:83], a[180:183], v[20:23]
 ds_read_b64_tr_b16 v[94:95], v12 offset:41984
 v_mfma_f32_16x16x32_bf16 v[24:27], v[80:83], a[184:187], v[24:27]
 s_add_u32 m0, s53, 24576
 ds_write_b128 v97, v[220:223] offset:1152
 v_mfma_f32_16x16x32_bf16 v[28:31], v[80:83], a[188:191], v[28:31]
 s_waitcnt vmcnt(10)
 s_waitcnt lgkmcnt(0)
 s_barrier
 ds_read_b128 a[192:195], v6 offset:0
 ds_read_b128 a[196:199], v6 offset:1024
 ds_read_b128 a[200:203], v6 offset:2048
 ds_read_b128 a[204:207], v6 offset:3072
 v_mfma_f32_16x16x32_bf16 v[32:35], v[84:87], a[176:179], v[32:35]
 v_add_u32 v10, 0x10000, v10
 ds_read_b64_tr_b16 v[80:81], v10 offset:57344
 v_mfma_f32_16x16x32_bf16 v[36:39], v[84:87], a[180:183], v[36:39]
 ds_read_b64_tr_b16 v[82:83], v10 offset:58368
 v_mfma_f32_16x16x32_bf16 v[40:43], v[84:87], a[184:187], v[40:43]
 s_mov_b32 s54, 294912
 v_mfma_f32_16x16x32_bf16 v[44:47], v[84:87], a[188:191], v[44:47]
 v_mfma_f32_16x16x32_bf16 v[48:51], v[88:91], a[176:179], v[48:51]
 v_add_u32 v11, 0x10000, v11
 ds_read_b64_tr_b16 v[84:85], v11 offset:57344
 v_mfma_f32_16x16x32_bf16 v[52:55], v[88:91], a[180:183], v[52:55]
 ds_read_b64_tr_b16 v[86:87], v11 offset:58368
 v_mfma_f32_16x16x32_bf16 v[56:59], v[88:91], a[184:187], v[56:59]
 buffer_load_dwordx4 v4, s[16:19], s54 offen lds
 v_mfma_f32_16x16x32_bf16 v[60:63], v[88:91], a[188:191], v[60:63]
 v_mfma_f32_16x16x32_bf16 v[64:67], a[176:179], v[92:95], v[64:67]
 v_add_u32 v13, 0x10000, v13
 ds_read_b64_tr_b16 v[88:89], v13 offset:57344
 v_mfma_f32_16x16x32_bf16 v[68:71], a[180:183], v[92:95], v[68:71]
 ds_read_b64_tr_b16 v[90:91], v13 offset:58368
 v_mfma_f32_16x16x32_bf16 v[72:75], a[184:187], v[92:95], v[72:75]
 buffer_load_dwordx4 v4, s[20:23], s54 offen offset:1024 lds
 v_mfma_f32_16x16x32_bf16 v[76:79], a[188:191], v[92:95], v[76:79]
 s_waitcnt lgkmcnt(6)
 s_waitcnt lgkmcnt(4)
 v_mfma_f32_16x16x32_bf16 v[16:19], v[80:83], a[192:195], v[16:19]
 v_add_u32 v12, 0x10000, v12
 ds_read_b64_tr_b16 v[92:93], v12 offset:57344
 v_mfma_f32_16x16x32_bf16 v[20:23], v[80:83], a[196:199], v[20:23]
 ds_read_b64_tr_b16 v[94:95], v12 offset:58368
 v_mfma_f32_16x16x32_bf16 v[24:27], v[80:83], a[200:203], v[24:27]
 s_add_u32 m0, s53, 32768
 ds_read_b128 a[208:211], v7 offset:8192
 v_mfma_f32_16x16x32_bf16 v[28:31], v[80:83], a[204:207], v[28:31]
 ds_read_b128 a[212:215], v7 offset:9216
 s_waitcnt lgkmcnt(6)
 v_mfma_f32_16x16x32_bf16 v[32:35], v[84:87], a[192:195], v[32:35]
 v_add_u32 v10, 0x10000, v10
 ds_read_b64_tr_b16 v[80:81], v10 offset:0
 v_mfma_f32_16x16x32_bf16 v[36:39], v[84:87], a[196:199], v[36:39]
 ds_read_b64_tr_b16 v[82:83], v10 offset:1024
 v_mfma_f32_16x16x32_bf16 v[40:43], v[84:87], a[200:203], v[40:43]
 s_mov_b32 s54, 589824
 ds_read_b128 a[216:219], v7 offset:10240
 v_mfma_f32_16x16x32_bf16 v[44:47], v[84:87], a[204:207], v[44:47]
 ds_read_b128 a[220:223], v7 offset:11264
 s_waitcnt lgkmcnt(8)
 v_mfma_f32_16x16x32_bf16 v[48:51], v[88:91], a[192:195], v[48:51]
 v_add_u32 v11, 0x10000, v11
 ds_read_b64_tr_b16 v[84:85], v11 offset:0
 v_mfma_f32_16x16x32_bf16 v[52:55], v[88:91], a[196:199], v[52:55]
 ds_read_b64_tr_b16 v[86:87], v11 offset:1024
 v_mfma_f32_16x16x32_bf16 v[56:59], v[88:91], a[200:203], v[56:59]
 buffer_load_dwordx4 v4, s[16:19], s54 offen lds
 ds_write_b128 v97, v[224:227] offset:16384
 v_mfma_f32_16x16x32_bf16 v[60:63], v[88:91], a[204:207], v[60:63]
 ds_write_b128 v97, v[228:231] offset:16512
 s_waitcnt lgkmcnt(10)
 v_mfma_f32_16x16x32_bf16 v[64:67], a[192:195], v[92:95], v[64:67]
 v_add_u32 v13, 0x10000, v13
 ds_read_b64_tr_b16 v[88:89], v13 offset:0
 v_mfma_f32_16x16x32_bf16 v[68:71], a[196:199], v[92:95], v[68:71]
 ds_read_b64_tr_b16 v[90:91], v13 offset:1024
 v_mfma_f32_16x16x32_bf16 v[72:75], a[200:203], v[92:95], v[72:75]
 buffer_load_dwordx4 v4, s[20:23], s54 offen offset:1024 lds
 ds_write_b128 v97, v[232:235] offset:17408
 v_mfma_f32_16x16x32_bf16 v[76:79], a[204:207], v[92:95], v[76:79]
 s_waitcnt lgkmcnt(7)
 v_mfma_f32_16x16x32_bf16 v[16:19], v[80:83], a[208:211], v[16:19]
 v_add_u32 v12, 0x10000, v12
 ds_read_b64_tr_b16 v[92:93], v12 offset:0
 v_mfma_f32_16x16x32_bf16 v[20:23], v[80:83], a[212:215], v[20:23]
 ds_read_b64_tr_b16 v[94:95], v12 offset:1024
 v_mfma_f32_16x16x32_bf16 v[24:27], v[80:83], a[216:219], v[24:27]
 s_add_u32 m0, s53, 49152
 ds_write_b128 v97, v[236:239] offset:17536
 v_mfma_f32_16x16x32_bf16 v[28:31], v[80:83], a[220:223], v[28:31]
 s_waitcnt vmcnt(10)
 s_waitcnt lgkmcnt(0)
 s_barrier
 ds_read_b128 a[224:227], v6 offset:16384
 ds_read_b128 a[228:231], v6 offset:17408
 ds_read_b128 a[232:235], v6 offset:18432
 ds_read_b128 a[236:239], v6 offset:19456
 v_mfma_f32_16x16x32_bf16 v[32:35], v[84:87], a[208:211], v[32:35]
 ds_read_b64_tr_b16 v[80:81], v10 offset:16384
 v_mfma_f32_16x16x32_bf16 v[36:39], v[84:87], a[212:215], v[36:39]
 ds_read_b64_tr_b16 v[82:83], v10 offset:17408
 v_mfma_f32_16x16x32_bf16 v[40:43], v[84:87], a[216:219], v[40:43]
 s_mov_b32 s54, 884736
 v_mfma_f32_16x16x32_bf16 v[44:47], v[84:87], a[220:223], v[44:47]
 v_mfma_f32_16x16x32_bf16 v[48:51], v[88:91], a[208:211], v[48:51]
 ds_read_b64_tr_b16 v[84:85], v11 offset:16384
 v_mfma_f32_16x16x32_bf16 v[52:55], v[88:91], a[212:215], v[52:55]
 ds_read_b64_tr_b16 v[86:87], v11 offset:17408
 v_mfma_f32_16x16x32_bf16 v[56:59], v[88:91], a[216:219], v[56:59]
 buffer_load_dwordx4 v4, s[16:19], s54 offen lds
 v_mfma_f32_16x16x32_bf16 v[60:63], v[88:91], a[220:223], v[60:63]
 v_mfma_f32_16x16x32_bf16 v[64:67], a[208:211], v[92:95], v[64:67]
 ds_read_b64_tr_b16 v[88:89], v13 offset:16384
 v_mfma_f32_16x16x32_bf16 v[68:71], a[212:215], v[92:95], v[68:71]
 ds_read_b64_tr_b16 v[90:91], v13 offset:17408
 v_mfma_f32_16x16x32_bf16 v[72:75], a[216:219], v[92:95], v[72:75]
 buffer_load_dwordx4 v4, s[20:23], s54 offen offset:1024 lds
 v_mfma_f32_16x16x32_bf16 v[76:79], a[220:223], v[92:95], v[76:79]
 s_waitcnt lgkmcnt(6)
 s_waitcnt lgkmcnt(4)
 v_mfma_f32_16x16x32_bf16 v[16:19], v[80:83], a[224:227], v[16:19]
 ds_read_b64_tr_b16 v[92:93], v12 offset:16384
 v_mfma_f32_16x16x32_bf16 v[20:23], v[80:83], a[228:231], v[20:23]
 ds_read_b64_tr_b16 v[94:95], v12 offset:17408
 v_mfma_f32_16x16x32_bf16 v[24:27], v[80:83], a[232:235], v[24:27]
 s_add_u32 m0, s53, 122880
 ds_read_b128 a[240:243], v7 offset:24576
 v_mfma_f32_16x16x32_bf16 v[28:31], v[80:83], a[236:239], v[28:31]
 ds_read_b128 a[244:247], v7 offset:25600
 s_waitcnt lgkmcnt(6)
 v_mfma_f32_16x16x32_bf16 v[32:35], v[84:87], a[224:227], v[32:35]
 ds_read_b64_tr_b16 v[80:81], v10 offset:24576
 v_mfma_f32_16x16x32_bf16 v[36:39], v[84:87], a[228:231], v[36:39]
 ds_read_b64_tr_b16 v[82:83], v10 offset:25600
 v_mfma_f32_16x16x32_bf16 v[40:43], v[84:87], a[232:235], v[40:43]
 s_mov_b32 s54, 1179648
 ds_read_b128 a[248:251], v7 offset:26624
 v_mfma_f32_16x16x32_bf16 v[44:47], v[84:87], a[236:239], v[44:47]
 ds_read_b128 a[252:255], v7 offset:27648
 s_waitcnt lgkmcnt(8)
 v_mfma_f32_16x16x32_bf16 v[48:51], v[88:91], a[224:227], v[48:51]
 ds_read_b64_tr_b16 v[84:85], v11 offset:24576
 v_mfma_f32_16x16x32_bf16 v[52:55], v[88:91], a[228:231], v[52:55]
 ds_read_b64_tr_b16 v[86:87], v11 offset:25600
 v_mfma_f32_16x16x32_bf16 v[56:59], v[88:91], a[232:235], v[56:59]
 buffer_load_dwordx4 v4, s[16:19], s54 offen lds
 ds_write_b128 v97, v[240:243] offset:0
 v_mfma_f32_16x16x32_bf16 v[60:63], v[88:91], a[236:239], v[60:63]
 ds_write_b128 v97, v[244:247] offset:128
 s_waitcnt lgkmcnt(10)
 v_mfma_f32_16x16x32_bf16 v[64:67], a[224:227], v[92:95], v[64:67]
 ds_read_b64_tr_b16 v[88:89], v13 offset:24576
 v_mfma_f32_16x16x32_bf16 v[68:71], a[228:231], v[92:95], v[68:71]
 ds_read_b64_tr_b16 v[90:91], v13 offset:25600
 v_mfma_f32_16x16x32_bf16 v[72:75], a[232:235], v[92:95], v[72:75]
 buffer_load_dwordx4 v4, s[20:23], s54 offen offset:1024 lds
 ds_write_b128 v97, v[248:251] offset:1024
 v_mfma_f32_16x16x32_bf16 v[76:79], a[236:239], v[92:95], v[76:79]
 s_waitcnt lgkmcnt(7)
 v_mfma_f32_16x16x32_bf16 v[16:19], v[80:83], a[240:243], v[16:19]
 ds_read_b64_tr_b16 v[92:93], v12 offset:24576
 v_mfma_f32_16x16x32_bf16 v[20:23], v[80:83], a[244:247], v[20:23]
 ds_read_b64_tr_b16 v[94:95], v12 offset:25600
 v_mfma_f32_16x16x32_bf16 v[24:27], v[80:83], a[248:251], v[24:27]
 s_add_u32 m0, s53, 40960
 ds_write_b128 v97, v[252:255] offset:1152
 v_mfma_f32_16x16x32_bf16 v[28:31], v[80:83], a[252:255], v[28:31]
 s_waitcnt vmcnt(10)
 s_waitcnt lgkmcnt(0)
 s_barrier
 ds_read_b128 v[112:115], v6 offset:0
 ds_read_b128 v[116:119], v6 offset:1024
 ds_read_b128 v[120:123], v6 offset:2048
 ds_read_b128 v[124:127], v6 offset:3072
 v_mfma_f32_16x16x32_bf16 v[32:35], v[84:87], a[240:243], v[32:35]
 v_add_u32 v10, 0xfffe0000, v10
 ds_read_b64_tr_b16 v[80:81], v10 offset:0
 v_mfma_f32_16x16x32_bf16 v[36:39], v[84:87], a[244:247], v[36:39]
 ds_read_b64_tr_b16 v[82:83], v10 offset:1024
 v_mfma_f32_16x16x32_bf16 v[40:43], v[84:87], a[248:251], v[40:43]
 s_mov_b32 s54, 1474560
 v_mfma_f32_16x16x32_bf16 v[44:47], v[84:87], a[252:255], v[44:47]
 v_mfma_f32_16x16x32_bf16 v[48:51], v[88:91], a[240:243], v[48:51]
 v_add_u32 v11, 0xfffe0000, v11
 ds_read_b64_tr_b16 v[84:85], v11 offset:0
 v_mfma_f32_16x16x32_bf16 v[52:55], v[88:91], a[244:247], v[52:55]
 ds_read_b64_tr_b16 v[86:87], v11 offset:1024
 v_mfma_f32_16x16x32_bf16 v[56:59], v[88:91], a[248:251], v[56:59]
 buffer_load_dwordx4 v4, s[16:19], s54 offen lds
 v_mfma_f32_16x16x32_bf16 v[60:63], v[88:91], a[252:255], v[60:63]
 v_mfma_f32_16x16x32_bf16 v[64:67], a[240:243], v[92:95], v[64:67]
 v_add_u32 v13, 0xfffe0000, v13
 ds_read_b64_tr_b16 v[88:89], v13 offset:0
 v_mfma_f32_16x16x32_bf16 v[68:71], a[244:247], v[92:95], v[68:71]
 ds_read_b64_tr_b16 v[90:91], v13 offset:1024
 v_mfma_f32_16x16x32_bf16 v[72:75], a[248:251], v[92:95], v[72:75]
 buffer_load_dwordx4 v4, s[20:23], s54 offen offset:1024 lds
 v_mfma_f32_16x16x32_bf16 v[76:79], a[252:255], v[92:95], v[76:79]
 s_waitcnt lgkmcnt(6)
 s_waitcnt lgkmcnt(4)
 v_mfma_f32_16x16x32_bf16 v[16:19], v[80:83], v[112:115], v[16:19]
 v_add_u32 v12, 0xfffe0000, v12
 ds_read_b64_tr_b16 v[92:93], v12 offset:0
 v_mfma_f32_16x16x32_bf16 v[20:23], v[80:83], v[116:119], v[20:23]
 ds_read_b64_tr_b16 v[94:95], v12 offset:1024
 v_mfma_f32_16x16x32_bf16 v[24:27], v[80:83], v[120:123], v[24:27]
 s_add_u32 m0, s53, 131072
 ds_read_b128 v[128:131], v7 offset:8192
 v_mfma_f32_16x16x32_bf16 v[28:31], v[80:83], v[124:127], v[28:31]
 ds_read_b128 v[132:135], v7 offset:9216
 s_waitcnt lgkmcnt(6)
 v_mfma_f32_16x16x32_bf16 v[32:35], v[84:87], v[112:115], v[32:35]
 ds_read_b64_tr_b16 v[80:81], v10 offset:8192
 v_mfma_f32_16x16x32_bf16 v[36:39], v[84:87], v[116:119], v[36:39]
 ds_read_b64_tr_b16 v[82:83], v10 offset:9216
 v_mfma_f32_16x16x32_bf16 v[40:43], v[84:87], v[120:123], v[40:43]
 s_mov_b32 s54, 1769472
 ds_read_b128 v[136:139], v7 offset:10240
 v_mfma_f32_16x16x32_bf16 v[44:47], v[84:87], v[124:127], v[44:47]
 s_waitcnt lgkmcnt(7)
 v_mfma_f32_16x16x32_bf16 v[48:51], v[88:91], v[112:115], v[48:51]
 ds_read_b64_tr_b16 v[84:85], v11 offset:8192
 v_mfma_f32_16x16x32_bf16 v[52:55], v[88:91], v[116:119], v[52:55]
 ds_read_b64_tr_b16 v[86:87], v11 offset:9216
 v_mfma_f32_16x16x32_bf16 v[56:59], v[88:91], v[120:123], v[56:59]
 buffer_load_dwordx4 v4, s[16:19], s54 offen lds
 ds_read_b128 v[140:143], v7 offset:11264
 v_mfma_f32_16x16x32_bf16 v[60:63], v[88:91], v[124:127], v[60:63]
 s_waitcnt lgkmcnt(8)
 v_mfma_f32_16x16x32_bf16 v[64:67], v[112:115], v[92:95], v[64:67]
 ds_read_b64_tr_b16 v[88:89], v13 offset:8192
 v_mfma_f32_16x16x32_bf16 v[68:71], v[116:119], v[92:95], v[68:71]
 ds_read_b64_tr_b16 v[90:91], v13 offset:9216
 v_mfma_f32_16x16x32_bf16 v[72:75], v[120:123], v[92:95], v[72:75]
 buffer_load_dwordx4 v4, s[20:23], s54 offen offset:1024 lds
 v_mfma_f32_16x16x32_bf16 v[76:79], v[124:127], v[92:95], v[76:79]
 s_waitcnt lgkmcnt(2)
 v_mfma_f32_16x16x32_bf16 v[16:19], v[80:83], v[128:131], v[16:19]
 ds_read_b64_tr_b16 v[92:93], v12 offset:8192
 v_mfma_f32_16x16x32_bf16 v[20:23], v[80:83], v[132:135], v[20:23]
 ds_read_b64_tr_b16 v[94:95], v12 offset:9216
 v_mfma_f32_16x16x32_bf16 v[24:27], v[80:83], v[136:139], v[24:27]
 s_add_u32 m0, s53, 147456
 v_mfma_f32_16x16x32_bf16 v[28:31], v[80:83], v[140:143], v[28:31]
 v_mfma_f32_16x16x32_bf16 v[32:35], v[84:87], v[128:131], v[32:35]
 v_mfma_f32_16x16x32_bf16 v[36:39], v[84:87], v[132:135], v[36:39]
 v_mfma_f32_16x16x32_bf16 v[40:43], v[84:87], v[136:139], v[40:43]
 s_mov_b32 s54, 2064384
 v_mfma_f32_16x16x32_bf16 v[44:47], v[84:87], v[140:143], v[44:47]
 s_waitcnt lgkmcnt(2)
 v_mfma_f32_16x16x32_bf16 v[48:51], v[88:91], v[128:131], v[48:51]
 v_mfma_f32_16x16x32_bf16 v[52:55], v[88:91], v[132:135], v[52:55]
 v_mfma_f32_16x16x32_bf16 v[56:59], v[88:91], v[136:139], v[56:59]
 buffer_load_dwordx4 v4, s[16:19], s54 offen lds
 v_mfma_f32_16x16x32_bf16 v[60:63], v[88:91], v[140:143], v[60:63]
 s_waitcnt lgkmcnt(0)
 v_mfma_f32_16x16x32_bf16 v[64:67], v[128:131], v[92:95], v[64:67]
 v_mfma_f32_16x16x32_bf16 v[68:71], v[132:135], v[92:95], v[68:71]
 v_mfma_f32_16x16x32_bf16 v[72:75], v[136:139], v[92:95], v[72:75]
 buffer_load_dwordx4 v4, s[20:23], s54 offen offset:1024 lds
 v_mfma_f32_16x16x32_bf16 v[76:79], v[140:143], v[92:95], v[76:79]
 v_and_b32 v251, 15, v0
 v_lshrrev_b32 v252, 4, v0
 v_lshrrev_b32 v248, 1, v251
 v_add_u32 v249, 0, v252
 v_xor_b32 v248, v248, v249
 v_lshlrev_b32 v248, 5, v248
 v_and_b32 v250, 1, v0
 v_lshl_add_u32 v248, v250, 4, v248
 s_lshl_b32 s57, s48, 3
 v_add_u32 v249, s57, v249
 v_mul_u32_u24 v249, 0x480, v249
 v_add_u32 v248, v248, v249
 v_add_u32 v6, 0x0, v248
 v_lshrrev_b32 v248, 1, v251
 v_add_u32 v249, 4, v252
 v_xor_b32 v248, v248, v249
 v_lshlrev_b32 v248, 5, v248
 v_and_b32 v250, 1, v0
 v_lshl_add_u32 v248, v250, 4, v248
 s_lshl_b32 s57, s48, 3
 v_add_u32 v249, s57, v249
 v_mul_u32_u24 v249, 0x480, v249
 v_add_u32 v248, v248, v249
 v_add_u32 v7, 0xfffffc00, v248
 v_lshrrev_b32 v248, 3, v0
 v_lshrrev_b32 v249, 1, v248
 v_and_b32 v250, 7, v0
 v_lshrrev_b32 v250, 1, v250
 v_xor_b32 v249, v249, v250
 v_lshlrev_b32 v249, 5, v249
 v_and_b32 v250, 1, v0
 v_lshl_add_u32 v249, v250, 4, v249
 s_lshl_b32 s57, s48, 4
 v_add_u32 v248, s57, v248
 v_mul_u32_u24 v248, 0x480, v248
 v_add_u32 v248, v248, v249
 v_add_u32 v8, 1024, v248
 v_add_u32 v9, 9216, v248
 v_mov_b32 v200, 0
 v_mov_b32 v201, 0
 v_mov_b32 v203, 0
 v_mov_b32 v208, 0x3f80
 v_mov_b32 v209, 0x3f800000
 v_mov_b32 v202, 0
 v_cmp_eq_u32 vcc, 32, v0
 s_nop 1
 v_cndmask_b32 v202, v202, v208, vcc
 v_cmp_eq_u32 vcc, 33, v0
 s_nop 1
 v_cndmask_b32 v202, v202, v209, vcc
 v_and_b32 v208, 3, v0
 v_cmp_eq_u32 vcc, 2, v208
 v_mov_b32 v209, 0
 s_nop 0
 v_cndmask_b32 v204, v209, 1.0, vcc
 v_mov_b32 v205, v204
 v_mov_b32 v206, v204
 v_mov_b32 v207, v204
 v_cndmask_b32 v212, v60, v62, s[78:79]
 v_cndmask_b32 v213, v61, v63, s[78:79]
 v_cvt_pk_bf16_f32 v176, v44, v45
 v_cvt_pk_bf16_f32 v177, v46, v47
 v_cvt_pk_bf16_f32 v178, v212, v213
 v_mov_b32 v179, 0
 v_cvt_pk_bf16_f32 v188, v76, v77
 v_cvt_pk_bf16_f32 v189, v78, v79
 v_mfma_f32_16x16x32_bf16 v[60:63], v[176:179], v[200:203], v[204:207]
 v_mov_b32 v214, v178
 v_mov_b32 v215, v178
 v_cvt_pk_bf16_f32 v156, v28, v29
 v_cvt_pk_bf16_f32 v157, v30, v31
 v_permlane16_swap_b32 v214, v215
 v_mov_b32 v159, 0
 v_cndmask_b32 v158, v159, v214, s[76:77]
 s_nop 0
 v_cvt_pk_bf16_f32 v198, v60, v61
 v_cvt_pk_bf16_f32 v199, v62, v63
 buffer_store_dwordx4 v[176:179], v105, s[28:31], 0 offen sc1
 buffer_store_dwordx2 v[188:189], v105, s[28:31], 0 offen offset:1024 sc1
 buffer_store_dwordx2 v[198:199], v105, s[28:31], 0 offen offset:1032 sc1
 s_cmp_eq_u32 s49, 0
 s_cbranch_scc0 L1_nohw
 v_add_u32 v216, s92, v98
 ds_write_b128 v216, v[176:179]
 ds_write_b64 v216, v[188:189] offset:1024
 ds_write_b64 v216, v[198:199] offset:1032
 s_waitcnt lgkmcnt(0)
L1_nohw:
 v_cndmask_b32 v208, v48, v50, s[78:79]
 v_cndmask_b32 v209, v49, v51, s[78:79]
 v_cvt_pk_bf16_f32 v164, v32, v33
 v_cvt_pk_bf16_f32 v165, v34, v35
 v_cvt_pk_bf16_f32 v166, v208, v209
 v_mov_b32 v167, 0
 v_cvt_pk_bf16_f32 v182, v64, v65
 v_cvt_pk_bf16_f32 v183, v66, v67
 v_mfma_f32_16x16x32_bf16 v[48:51], v[164:167], v[200:203], v[204:207]
 v_mov_b32 v210, v166
 v_mov_b32 v211, v166
 v_cvt_pk_bf16_f32 v144, v16, v17
 v_cvt_pk_bf16_f32 v145, v18, v19
 v_permlane16_swap_b32 v210, v211
 v_mov_b32 v147, 0
 v_cndmask_b32 v146, v147, v210, s[76:77]
 s_nop 0
 v_cvt_pk_bf16_f32 v192, v48, v49
 v_cvt_pk_bf16_f32 v193, v50, v51
 v_cndmask_b32 v212, v52, v54, s[78:79]
 v_cndmask_b32 v213, v53, v55, s[78:79]
 v_cvt_pk_bf16_f32 v168, v36, v37
 v_cvt_pk_bf16_f32 v169, v38, v39
 v_cvt_pk_bf16_f32 v170, v212, v213
 v_mov_b32 v171, 0
 v_cvt_pk_bf16_f32 v184, v68, v69
 v_cvt_pk_bf16_f32 v185, v70, v71
 v_mfma_f32_16x16x32_bf16 v[52:55], v[168:171], v[200:203], v[204:207]
 v_mov_b32 v214, v170
 v_mov_b32 v215, v170
 v_cvt_pk_bf16_f32 v148, v20, v21
 v_cvt_pk_bf16_f32 v149, v22, v23
 v_permlane16_swap_b32 v214, v215
 v_mov_b32 v151, 0
 v_cndmask_b32 v150, v151, v214, s[76:77]
 s_nop 0
 v_cvt_pk_bf16_f32 v194, v52, v53
 v_cvt_pk_bf16_f32 v195, v54, v55
 v_cndmask_b32 v208, v56, v58, s[78:79]
 v_cndmask_b32 v209, v57, v59, s[78:79]
 v_cvt_pk_bf16_f32 v172, v40, v41
 v_cvt_pk_bf16_f32 v173, v42, v43
 v_cvt_pk_bf16_f32 v174, v208, v209
 v_mov_b32 v175, 0
 v_cvt_pk_bf16_f32 v186, v72, v73
 v_cvt_pk_bf16_f32 v187, v74, v75
 v_mfma_f32_16x16x32_bf16 v[56:59], v[172:175], v[200:203], v[204:207]
 v_mov_b32 v210, v174
 v_mov_b32 v211, v174
 v_cvt_pk_bf16_f32 v152, v24, v25
 v_cvt_pk_bf16_f32 v153, v26, v27
 v_permlane16_swap_b32 v210, v211
 v_mov_b32 v155, 0
 v_cndmask_b32 v154, v155, v210, s[76:77]
 s_nop 0
 v_cvt_pk_bf16_f32 v196, v56, v57
 v_cvt_pk_bf16_f32 v197, v58, v59
 v_mfma_f32_16x16x32_bf16 v[16:19], v[164:167], v[148:151], 0
 v_mfma_f32_16x16x32_bf16 v[20:23], v[168:171], v[148:151], 0
 v_mfma_f32_16x16x32_bf16 v[32:35], v[168:171], v[152:155], 0
 v_mfma_f32_16x16x32_bf16 v[36:39], v[172:175], v[152:155], 0
 v_mfma_f32_16x16x32_bf16 v[48:51], v[172:175], v[156:159], 0
 v_mfma_f32_16x16x32_bf16 v[52:55], v[176:179], v[156:159], 0
 v_mov_b32 v24, s83
 v_mov_b32 v40, s83
 v_mov_b32 v56, s83
 v_cndmask_b32 v16, v24, v16, s[60:61]
 v_cndmask_b32 v20, v24, v20, s[68:69]
 v_cndmask_b32 v32, v40, v32, s[60:61]
 v_cndmask_b32 v36, v40, v36, s[68:69]
 v_cndmask_b32 v48, v56, v48, s[60:61]
 v_cndmask_b32 v52, v56, v52, s[68:69]
 v_cndmask_b32 v17, v24, v17, s[62:63]
 v_cndmask_b32 v21, v24, v21, s[70:71]
 v_cndmask_b32 v33, v40, v33, s[62:63]
 v_cndmask_b32 v37, v40, v37, s[70:71]
 v_cndmask_b32 v49, v56, v49, s[62:63]
 v_cndmask_b32 v53, v56, v53, s[70:71]
 v_cndmask_b32 v18, v24, v18, s[64:65]
 v_cndmask_b32 v22, v24, v22, s[72:73]
 v_cndmask_b32 v34, v40, v34, s[64:65]
 v_cndmask_b32 v38, v40, v38, s[72:73]
 v_cndmask_b32 v50, v56, v50, s[64:65]
 v_cndmask_b32 v54, v56, v54, s[72:73]
 v_cndmask_b32 v19, v24, v19, s[66:67]
 v_cndmask_b32 v23, v24, v23, s[74:75]
 v_cndmask_b32 v35, v40, v35, s[66:67]
 v_cndmask_b32 v39, v40, v39, s[74:75]
 v_cndmask_b32 v51, v56, v51, s[66:67]
 v_cndmask_b32 v55, v56, v55, s[74:75]
 v_max3_f32 v25, v16, v17, v18
 v_max3_f32 v41, v32, v33, v34
 v_max3_f32 v57, v48, v49, v50
 v_max3_f32 v26, v19, v20, v21
 v_max3_f32 v42, v35, v36, v37
 v_max3_f32 v58, v51, v52, v53
 v_max3_f32 v25, v25, v22, v23
 v_max3_f32 v41, v41, v38, v39
 v_max3_f32 v57, v57, v54, v55
 v_max_f32 v25, v25, v26
 v_max_f32 v41, v41, v42
 v_max_f32 v57, v57, v58
 v_mov_b32 v26, v25
 v_mov_b32 v42, v41
 v_mov_b32 v58, v57
 v_permlane16_swap_b32 v25, v26
 v_permlane16_swap_b32 v41, v42
 v_permlane16_swap_b32 v57, v58
 v_max_f32 v25, v25, v26
 v_max_f32 v41, v41, v42
 v_max_f32 v57, v57, v58
 v_mov_b32 v26, v25
 v_mov_b32 v42, v41
 v_mov_b32 v58, v57
 v_permlane32_swap_b32 v25, v26
 v_permlane32_swap_b32 v41, v42
 v_permlane32_swap_b32 v57, v58
 v_max_f32 v25, v25, v26
 v_max_f32 v41, v41, v42
 v_max_f32 v57, v57, v58
 v_mul_f32 v25, s82, v25
 v_mul_f32 v41, s82, v41
 v_mul_f32 v57, s82, v57
 v_fma_f32 v16, v16, s82, -v25
 v_fma_f32 v32, v32, s82, -v41
 v_fma_f32 v48, v48, s82, -v57
 v_fma_f32 v17, v17, s82, -v25
 v_fma_f32 v33, v33, s82, -v41
 v_fma_f32 v49, v49, s82, -v57
 v_fma_f32 v18, v18, s82, -v25
 v_fma_f32 v34, v34, s82, -v41
 v_fma_f32 v50, v50, s82, -v57
 v_fma_f32 v19, v19, s82, -v25
 v_fma_f32 v35, v35, s82, -v41
 v_fma_f32 v51, v51, s82, -v57
 v_fma_f32 v20, v20, s82, -v25
 v_fma_f32 v36, v36, s82, -v41
 v_fma_f32 v52, v52, s82, -v57
 v_fma_f32 v21, v21, s82, -v25
 v_fma_f32 v37, v37, s82, -v41
 v_fma_f32 v53, v53, s82, -v57
 v_fma_f32 v22, v22, s82, -v25
 v_fma_f32 v38, v38, s82, -v41
 v_fma_f32 v54, v54, s82, -v57
 v_fma_f32 v23, v23, s82, -v25
 v_fma_f32 v39, v39, s82, -v41
 v_fma_f32 v55, v55, s82, -v57
 v_exp_f32 v16, v16
 v_exp_f32 v32, v32
 v_exp_f32 v48, v48
 v_exp_f32 v17, v17
 v_exp_f32 v33, v33
 v_exp_f32 v49, v49
 v_exp_f32 v18, v18
 v_exp_f32 v34, v34
 v_exp_f32 v50, v50
 v_exp_f32 v19, v19
 v_exp_f32 v35, v35
 v_exp_f32 v51, v51
 v_exp_f32 v20, v20
 v_exp_f32 v36, v36
 v_exp_f32 v52, v52
 v_exp_f32 v21, v21
 v_exp_f32 v37, v37
 v_exp_f32 v53, v53
 v_exp_f32 v22, v22
 v_exp_f32 v38, v38
 v_exp_f32 v54, v54
 v_exp_f32 v23, v23
 v_exp_f32 v39, v39
 v_exp_f32 v55, v55
 s_waitcnt vmcnt(0)
 s_barrier
 v_mov_b32 v1, s85
 buffer_atomic_or v1, v107, s[32:35], 0 offen
 v_cvt_pk_bf16_f32 v28, v16, v17
 v_cvt_pk_bf16_f32 v44, v32, v33
 v_cvt_pk_bf16_f32 v60, v48, v49
 v_cvt_pk_bf16_f32 v29, v18, v19
 v_cvt_pk_bf16_f32 v45, v34, v35
 v_cvt_pk_bf16_f32 v61, v50, v51
 v_cvt_pk_bf16_f32 v30, v20, v21
 v_cvt_pk_bf16_f32 v46, v36, v37
 v_cvt_pk_bf16_f32 v62, v52, v53
 v_cvt_pk_bf16_f32 v31, v22, v23
 v_cvt_pk_bf16_f32 v47, v38, v39
 v_cvt_pk_bf16_f32 v63, v54, v55
 v_mfma_f32_16x16x32_bf16 v[16:19], v[182:185], v[28:31], 0
 v_mfma_f32_16x16x32_bf16 v[20:23], v[192:195], v[28:31], 0
 v_mfma_f32_16x16x32_bf16 v[32:35], v[184:187], v[44:47], 0
 v_mfma_f32_16x16x32_bf16 v[36:39], v[194:197], v[44:47], 0
 v_mfma_f32_16x16x32_bf16 v[48:51], v[186:189], v[60:63], 0
 v_mfma_f32_16x16x32_bf16 v[52:55], v[196:199], v[60:63], 0
 s_nop 3
 v_rcp_f32 v24, v22
 s_nop 0
 v_rcp_f32 v40, v38
 s_nop 0
 v_rcp_f32 v56, v54
 v_mul_f32 v16, v16, v24
 v_mul_f32 v32, v32, v40
 v_mul_f32 v48, v48, v56
 v_mul_f32 v17, v17, v24
 v_mul_f32 v33, v33, v40
 v_mul_f32 v49, v49, v56
 v_mul_f32 v18, v18, v24
 v_mul_f32 v34, v34, v40
 v_mul_f32 v50, v50, v56
 v_mul_f32 v19, v19, v24
 v_mul_f32 v35, v35, v40
 v_mul_f32 v51, v51, v56
 v_mul_f32 v20, v20, v24
 v_mul_f32 v36, v36, v40
 v_mul_f32 v52, v52, v56
 v_mul_f32 v21, v21, v24
 v_mul_f32 v37, v37, v40
 v_mul_f32 v53, v53, v56
 v_cvt_pk_bf16_f32 v24, v16, v17
 v_cvt_pk_bf16_f32 v25, v18, v19
 v_cvt_pk_bf16_f32 v26, v20, v21
 v_cvt_pk_bf16_f32 v40, v32, v33
 v_cvt_pk_bf16_f32 v41, v34, v35
 v_cvt_pk_bf16_f32 v42, v36, v37
 v_cvt_pk_bf16_f32 v56, v48, v49
 v_cvt_pk_bf16_f32 v57, v50, v51
 v_cvt_pk_bf16_f32 v58, v52, v53
 s_mov_b32 s94, 18432
 buffer_store_dwordx2 v[24:25], v103, s[28:31], s94 offen sc1
 buffer_store_dword v26, v104, s[28:31], s94 offen sc1
 s_mov_b32 s94, 36864
 buffer_store_dwordx2 v[40:41], v103, s[28:31], s94 offen sc1
 buffer_store_dword v42, v104, s[28:31], s94 offen sc1
 s_mov_b32 s94, 55296
 buffer_store_dwordx2 v[56:57], v103, s[28:31], s94 offen sc1
 buffer_store_dword v58, v104, s[28:31], s94 offen sc1
 v_lshrrev_b32 v248, 4, v0
 v_lshrrev_b32 v249, 2, v0
 v_and_b32 v249, 3, v249
 v_lshl_add_u32 v250, v248, 2, v249
 v_and_b32 v251, 7, v250
 v_lshlrev_b32 v250, 8, v250
 v_and_b32 v248, 3, v0
 v_lshl_add_u32 v250, v248, 3, v250
 s_lshl_b32 s57, s50, 2
 s_add_u32 s57, s57, 0
 v_xor_b32 v248, s57, v251
 v_lshl_add_u32 v10, v248, 5, v250
 s_lshl_b32 s57, s50, 2
 s_add_u32 s57, s57, 1
 v_xor_b32 v248, s57, v251
 v_lshl_add_u32 v11, v248, 5, v250
 s_lshl_b32 s57, s50, 2
 s_add_u32 s57, s57, 2
 v_xor_b32 v248, s57, v251
 v_lshl_add_u32 v12, v248, 5, v250
 s_lshl_b32 s57, s50, 2
 s_add_u32 s57, s57, 3
 v_xor_b32 v248, s57, v251
 v_lshl_add_u32 v13, v248, 5, v250
 s_barrier
 ds_read_b64_tr_b16 v[80:81], v14 offset:16384
 ds_read_b64_tr_b16 v[82:83], v14 offset:16896
 ds_read_b64_tr_b16 v[84:85], v14 offset:17408
 ds_read_b64_tr_b16 v[86:87], v14 offset:17920
 ds_read_b64_tr_b16 v[88:89], v15 offset:16384
 ds_read_b64_tr_b16 v[90:91], v15 offset:16896
 s_waitcnt lgkmcnt(4)
 v_mfma_f32_16x16x32_bf16 v[16:19], v[80:83], a[0:3], 0
 ds_read_b64_tr_b16 v[92:93], v15 offset:17408
 v_mfma_f32_16x16x32_bf16 v[20:23], v[80:83], a[4:7], 0
 ds_read_b64_tr_b16 v[94:95], v15 offset:17920
 v_mfma_f32_16x16x32_bf16 v[24:27], v[80:83], a[8:11], 0
 s_add_u32 m0, s53, 90112
 v_mfma_f32_16x16x32_bf16 v[28:31], v[80:83], a[12:15], 0
 s_waitcnt lgkmcnt(4)
 v_mfma_f32_16x16x32_bf16 v[32:35], v[84:87], a[0:3], 0
 ds_read_b64_tr_b16 v[80:81], v14 offset:24576
 v_mfma_f32_16x16x32_bf16 v[36:39], v[84:87], a[4:7], 0
 ds_read_b64_tr_b16 v[82:83], v14 offset:25088
 v_mfma_f32_16x16x32_bf16 v[40:43], v[84:87], a[8:11], 0
 s_mov_b32 s54, 2359296
 v_mfma_f32_16x16x32_bf16 v[44:47], v[84:87], a[12:15], 0
 s_waitcnt lgkmcnt(4)
 v_mfma_f32_16x16x32_bf16 v[48:51], v[88:91], a[0:3], 0
 ds_read_b64_tr_b16 v[84:85], v14 offset:25600
 v_mfma_f32_16x16x32_bf16 v[52:55], v[88:91], a[4:7], 0
 ds_read_b64_tr_b16 v[86:87], v14 offset:26112
 v_mfma_f32_16x16x32_bf16 v[56:59], v[88:91], a[8:11], 0
 buffer_load_dwordx4 v4, s[16:19], s54 offen lds
 v_mfma_f32_16x16x32_bf16 v[60:63], v[88:91], a[12:15], 0
 s_waitcnt lgkmcnt(4)
 v_mfma_f32_16x16x32_bf16 v[64:67], v[92:95], a[0:3], 0
 ds_read_b64_tr_b16 v[88:89], v15 offset:24576
 v_mfma_f32_16x16x32_bf16 v[68:71], v[92:95], a[4:7], 0
 ds_read_b64_tr_b16 v[90:91], v15 offset:25088
 v_mfma_f32_16x16x32_bf16 v[72:75], v[92:95], a[8:11], 0
 buffer_load_dwordx4 v4, s[20:23], s54 offen offset:1024 lds
 v_mfma_f32_16x16x32_bf16 v[76:79], v[92:95], a[12:15], 0
 s_waitcnt lgkmcnt(4)
 v_mfma_f32_16x16x32_bf16 v[16:19], v[80:83], a[16:19], v[16:19]
 ds_read_b64_tr_b16 v[92:93], v15 offset:25600
 v_mfma_f32_16x16x32_bf16 v[20:23], v[80:83], a[20:23], v[20:23]
 ds_read_b64_tr_b16 v[94:95], v15 offset:26112
 v_mfma_f32_16x16x32_bf16 v[24:27], v[80:83], a[24:27], v[24:27]
 s_add_u32 m0, s53, 98304
 v_mfma_f32_16x16x32_bf16 v[28:31], v[80:83], a[28:31], v[28:31]
 s_waitcnt lgkmcnt(4)
 v_mfma_f32_16x16x32_bf16 v[32:35], v[84:87], a[16:19], v[32:35]
 ds_read_b64_tr_b16 v[80:81], v14 offset:32768
 v_mfma_f32_16x16x32_bf16 v[36:39], v[84:87], a[20:23], v[36:39]
 ds_read_b64_tr_b16 v[82:83], v14 offset:33280
 v_mfma_f32_16x16x32_bf16 v[40:43], v[84:87], a[24:27], v[40:43]
 s_mov_b32 s54, 2654208
 v_mfma_f32_16x16x32_bf16 v[44:47], v[84:87], a[28:31], v[44:47]
 s_waitcnt lgkmcnt(4)
 v_mfma_f32_16x16x32_bf16 v[48:51], v[88:91], a[16:19], v[48:51]
 ds_read_b64_tr_b16 v[84:85], v14 offset:33792
 v_mfma_f32_16x16x32_bf16 v[52:55], v[88:91], a[20:23], v[52:55]
 ds_read_b64_tr_b16 v[86:87], v14 offset:34304
 v_mfma_f32_16x16x32_bf16 v[56:59], v[88:91], a[24:27], v[56:59]
 buffer_load_dwordx4 v4, s[16:19], s54 offen lds
 v_mfma_f32_16x16x32_bf16 v[60:63], v[88:91], a[28:31], v[60:63]
 s_waitcnt lgkmcnt(4)
 v_mfma_f32_16x16x32_bf16 v[64:67], v[92:95], a[16:19], v[64:67]
 ds_read_b64_tr_b16 v[88:89], v15 offset:32768
 v_mfma_f32_16x16x32_bf16 v[68:71], v[92:95], a[20:23], v[68:71]
 ds_read_b64_tr_b16 v[90:91], v15 offset:33280
 v_mfma_f32_16x16x32_bf16 v[72:75], v[92:95], a[24:27], v[72:75]
 buffer_load_dwordx4 v4, s[20:23], s54 offen offset:1024 lds
 v_mfma_f32_16x16x32_bf16 v[76:79], v[92:95], a[28:31], v[76:79]
 s_waitcnt lgkmcnt(4)
 v_mfma_f32_16x16x32_bf16 v[16:19], v[80:83], a[32:35], v[16:19]
 ds_read_b64_tr_b16 v[92:93], v15 offset:33792
 v_mfma_f32_16x16x32_bf16 v[20:23], v[80:83], a[36:39], v[20:23]
 ds_read_b64_tr_b16 v[94:95], v15 offset:34304
 v_mfma_f32_16x16x32_bf16 v[24:27], v[80:83], a[40:43], v[24:27]
 s_add_u32 m0, s53, 106496
 v_mfma_f32_16x16x32_bf16 v[28:31], v[80:83], a[44:47], v[28:31]
 s_barrier
 s_waitcnt lgkmcnt(4)
 v_mfma_f32_16x16x32_bf16 v[32:35], v[84:87], a[32:35], v[32:35]
 ds_read_b64_tr_b16 v[80:81], v14 offset:49152
 v_mfma_f32_16x16x32_bf16 v[36:39], v[84:87], a[36:39], v[36:39]
 ds_read_b64_tr_b16 v[82:83], v14 offset:49664
 v_mfma_f32_16x16x32_bf16 v[40:43], v[84:87], a[40:43], v[40:43]
 s_mov_b32 s54, 2949120
 v_mfma_f32_16x16x32_bf16 v[44:47], v[84:87], a[44:47], v[44:47]
 s_waitcnt lgkmcnt(4)
 v_mfma_f32_16x16x32_bf16 v[48:51], v[88:91], a[32:35], v[48:51]
 ds_read_b64_tr_b16 v[84:85], v14 offset:50176
 v_mfma_f32_16x16x32_bf16 v[52:55], v[88:91], a[36:39], v[52:55]
 ds_read_b64_tr_b16 v[86:87], v14 offset:50688
 v_mfma_f32_16x16x32_bf16 v[56:59], v[88:91], a[40:43], v[56:59]
 buffer_load_dwordx4 v4, s[16:19], s54 offen lds
 v_mfma_f32_16x16x32_bf16 v[60:63], v[88:91], a[44:47], v[60:63]
 s_waitcnt lgkmcnt(4)
 v_mfma_f32_16x16x32_bf16 v[64:67], v[92:95], a[32:35], v[64:67]
 ds_read_b64_tr_b16 v[88:89], v15 offset:49152
 v_mfma_f32_16x16x32_bf16 v[68:71], v[92:95], a[36:39], v[68:71]
 ds_read_b64_tr_b16 v[90:91], v15 offset:49664
 v_mfma_f32_16x16x32_bf16 v[72:75], v[92:95], a[40:43], v[72:75]
 buffer_load_dwordx4 v4, s[20:23], s54 offen offset:1024 lds
 v_mfma_f32_16x16x32_bf16 v[76:79], v[92:95], a[44:47], v[76:79]
 s_waitcnt lgkmcnt(4)
 v_mfma_f32_16x16x32_bf16 v[16:19], v[80:83], a[48:51], v[16:19]
 ds_read_b64_tr_b16 v[92:93], v15 offset:50176
 v_mfma_f32_16x16x32_bf16 v[20:23], v[80:83], a[52:55], v[20:23]
 ds_read_b64_tr_b16 v[94:95], v15 offset:50688
 v_mfma_f32_16x16x32_bf16 v[24:27], v[80:83], a[56:59], v[24:27]
 s_add_u32 m0, s53, 114688
 v_mfma_f32_16x16x32_bf16 v[28:31], v[80:83], a[60:63], v[28:31]
 s_waitcnt lgkmcnt(4)
 v_mfma_f32_16x16x32_bf16 v[32:35], v[84:87], a[48:51], v[32:35]
 v_add_u32 v14, 0x10000, v14
 ds_read_b64_tr_b16 v[80:81], v14 offset:57344
 v_mfma_f32_16x16x32_bf16 v[36:39], v[84:87], a[52:55], v[36:39]
 ds_read_b64_tr_b16 v[82:83], v14 offset:57856
 v_mfma_f32_16x16x32_bf16 v[40:43], v[84:87], a[56:59], v[40:43]
 s_mov_b32 s54, 3244032
 v_mfma_f32_16x16x32_bf16 v[44:47], v[84:87], a[60:63], v[44:47]
 s_waitcnt lgkmcnt(4)
 v_mfma_f32_16x16x32_bf16 v[48:51], v[88:91], a[48:51], v[48:51]
 ds_read_b64_tr_b16 v[84:85], v14 offset:58368
 v_mfma_f32_16x16x32_bf16 v[52:55], v[88:91], a[52:55], v[52:55]
 ds_read_b64_tr_b16 v[86:87], v14 offset:58880
 v_mfma_f32_16x16x32_bf16 v[56:59], v[88:91], a[56:59], v[56:59]
 buffer_load_dwordx4 v4, s[16:19], s54 offen lds
 v_mfma_f32_16x16x32_bf16 v[60:63], v[88:91], a[60:63], v[60:63]
 s_waitcnt lgkmcnt(4)
 v_mfma_f32_16x16x32_bf16 v[64:67], v[92:95], a[48:51], v[64:67]
 v_add_u32 v15, 0x10000, v15
 ds_read_b64_tr_b16 v[88:89], v15 offset:57344
 v_mfma_f32_16x16x32_bf16 v[68:71], v[92:95], a[52:55], v[68:71]
 ds_read_b64_tr_b16 v[90:91], v15 offset:57856
 v_mfma_f32_16x16x32_bf16 v[72:75], v[92:95], a[56:59], v[72:75]
 buffer_load_dwordx4 v4, s[20:23], s54 offen offset:1024 lds
 v_mfma_f32_16x16x32_bf16 v[76:79], v[92:95], a[60:63], v[76:79]
 buffer_load_dword v111, v108, s[32:35], 0 offen sc1
 s_waitcnt lgkmcnt(4)
 v_mfma_f32_16x16x32_bf16 v[16:19], v[80:83], a[64:67], v[16:19]
 ds_read_b64_tr_b16 v[92:93], v15 offset:58368
 v_mfma_f32_16x16x32_bf16 v[20:23], v[80:83], a[68:71], v[20:23]
 ds_read_b64_tr_b16 v[94:95], v15 offset:58880
 v_mfma_f32_16x16x32_bf16 v[24:27], v[80:83], a[72:75], v[24:27]
 s_add_u32 m0, s53, 155648
 v_mfma_f32_16x16x32_bf16 v[28:31], v[80:83], a[76:79], v[28:31]
 s_waitcnt lgkmcnt(4)
 v_mfma_f32_16x16x32_bf16 v[32:35], v[84:87], a[64:67], v[32:35]
 v_add_u32 v14, 0xffff0000, v14
 ds_read_b64_tr_b16 v[80:81], v14 offset:40960
 v_mfma_f32_16x16x32_bf16 v[36:39], v[84:87], a[68:71], v[36:39]
 ds_read_b64_tr_b16 v[82:83], v14 offset:41472
 v_mfma_f32_16x16x32_bf16 v[40:43], v[84:87], a[72:75], v[40:43]
 s_mov_b32 s54, 3538944
 v_mfma_f32_16x16x32_bf16 v[44:47], v[84:87], a[76:79], v[44:47]
 s_waitcnt lgkmcnt(4)
 v_mfma_f32_16x16x32_bf16 v[48:51], v[88:91], a[64:67], v[48:51]
 ds_read_b64_tr_b16 v[84:85], v14 offset:41984
 v_mfma_f32_16x16x32_bf16 v[52:55], v[88:91], a[68:71], v[52:55]
 ds_read_b64_tr_b16 v[86:87], v14 offset:42496
 v_mfma_f32_16x16x32_bf16 v[56:59], v[88:91], a[72:75], v[56:59]
 buffer_load_dwordx4 v4, s[16:19], s54 offen lds
 v_mfma_f32_16x16x32_bf16 v[60:63], v[88:91], a[76:79], v[60:63]
 s_waitcnt lgkmcnt(4)
 v_mfma_f32_16x16x32_bf16 v[64:67], v[92:95], a[64:67], v[64:67]
 v_add_u32 v15, 0xffff0000, v15
 ds_read_b64_tr_b16 v[88:89], v15 offset:40960
 v_mfma_f32_16x16x32_bf16 v[68:71], v[92:95], a[68:71], v[68:71]
 ds_read_b64_tr_b16 v[90:91], v15 offset:41472
 v_mfma_f32_16x16x32_bf16 v[72:75], v[92:95], a[72:75], v[72:75]
 buffer_load_dwordx4 v4, s[20:23], s54 offen offset:1024 lds
 v_mfma_f32_16x16x32_bf16 v[76:79], v[92:95], a[76:79], v[76:79]
 s_waitcnt lgkmcnt(4)
 v_mfma_f32_16x16x32_bf16 v[16:19], v[80:83], a[80:83], v[16:19]
 ds_read_b64_tr_b16 v[92:93], v15 offset:41984
 v_mfma_f32_16x16x32_bf16 v[20:23], v[80:83], a[84:87], v[20:23]
 ds_read_b64_tr_b16 v[94:95], v15 offset:42496
 v_mfma_f32_16x16x32_bf16 v[24:27], v[80:83], a[88:91], v[24:27]
 s_add_u32 m0, s53, 0
 v_mfma_f32_16x16x32_bf16 v[28:31], v[80:83], a[92:95], v[28:31]
 s_waitcnt vmcnt(9)
 s_barrier
 s_waitcnt lgkmcnt(4)
 v_mfma_f32_16x16x32_bf16 v[32:35], v[84:87], a[80:83], v[32:35]
 v_add_u32 v14, 0x20000, v14
 ds_read_b64_tr_b16 v[80:81], v14 offset:0
 v_mfma_f32_16x16x32_bf16 v[36:39], v[84:87], a[84:87], v[36:39]
 ds_read_b64_tr_b16 v[82:83], v14 offset:512
 v_mfma_f32_16x16x32_bf16 v[40:43], v[84:87], a[88:91], v[40:43]
 s_mov_b32 s54, 3833856
 v_mfma_f32_16x16x32_bf16 v[44:47], v[84:87], a[92:95], v[44:47]
 s_waitcnt lgkmcnt(4)
 v_mfma_f32_16x16x32_bf16 v[48:51], v[88:91], a[80:83], v[48:51]
 ds_read_b64_tr_b16 v[84:85], v14 offset:1024
 v_mfma_f32_16x16x32_bf16 v[52:55], v[88:91], a[84:87], v[52:55]
 ds_read_b64_tr_b16 v[86:87], v14 offset:1536
 v_mfma_f32_16x16x32_bf16 v[56:59], v[88:91], a[88:91], v[56:59]
 buffer_load_dwordx4 v4, s[16:19], s54 offen lds
 v_mfma_f32_16x16x32_bf16 v[60:63], v[88:91], a[92:95], v[60:63]
 s_waitcnt lgkmcnt(4)
 v_mfma_f32_16x16x32_bf16 v[64:67], v[92:95], a[80:83], v[64:67]
 v_add_u32 v15, 0x20000, v15
 ds_read_b64_tr_b16 v[88:89], v15 offset:0
 v_mfma_f32_16x16x32_bf16 v[68:71], v[92:95], a[84:87], v[68:71]
 ds_read_b64_tr_b16 v[90:91], v15 offset:512
 v_mfma_f32_16x16x32_bf16 v[72:75], v[92:95], a[88:91], v[72:75]
 buffer_load_dwordx4 v4, s[20:23], s54 offen offset:1024 lds
 v_mfma_f32_16x16x32_bf16 v[76:79], v[92:95], a[92:95], v[76:79]
 s_waitcnt lgkmcnt(4)
 v_mfma_f32_16x16x32_bf16 v[16:19], v[80:83], a[96:99], v[16:19]
 ds_read_b64_tr_b16 v[92:93], v15 offset:1024
 v_mfma_f32_16x16x32_bf16 v[20:23], v[80:83], a[100:103], v[20:23]
 ds_read_b64_tr_b16 v[94:95], v15 offset:1536
 v_mfma_f32_16x16x32_bf16 v[24:27], v[80:83], a[104:107], v[24:27]
 s_add_u32 m0, s53, 122880
 v_mfma_f32_16x16x32_bf16 v[28:31], v[80:83], a[108:111], v[28:31]
 s_waitcnt lgkmcnt(4)
 v_mfma_f32_16x16x32_bf16 v[32:35], v[84:87], a[96:99], v[32:35]
 ds_read_b64_tr_b16 v[80:81], v14 offset:16384
 v_mfma_f32_16x16x32_bf16 v[36:39], v[84:87], a[100:103], v[36:39]
 ds_read_b64_tr_b16 v[82:83], v14 offset:16896
 v_mfma_f32_16x16x32_bf16 v[40:43], v[84:87], a[104:107], v[40:43]
 s_mov_b32 s54, 4128768
 v_mfma_f32_16x16x32_bf16 v[44:47], v[84:87], a[108:111], v[44:47]
 s_waitcnt lgkmcnt(4)
 v_mfma_f32_16x16x32_bf16 v[48:51], v[88:91], a[96:99], v[48:51]
 ds_read_b64_tr_b16 v[84:85], v14 offset:17408
 v_mfma_f32_16x16x32_bf16 v[52:55], v[88:91], a[100:103], v[52:55]
 ds_read_b64_tr_b16 v[86:87], v14 offset:17920
 v_mfma_f32_16x16x32_bf16 v[56:59], v[88:91], a[104:107], v[56:59]
 buffer_load_dwordx4 v4, s[16:19], s54 offen lds
 v_mfma_f32_16x16x32_bf16 v[60:63], v[88:91], a[108:111], v[60:63]
 s_waitcnt lgkmcnt(4)
 v_mfma_f32_16x16x32_bf16 v[64:67], v[92:95], a[96:99], v[64:67]
 ds_read_b64_tr_b16 v[88:89], v15 offset:16384
 v_mfma_f32_16x16x32_bf16 v[68:71], v[92:95], a[100:103], v[68:71]
 ds_read_b64_tr_b16 v[90:91], v15 offset:16896
 v_mfma_f32_16x16x32_bf16 v[72:75], v[92:95], a[104:107], v[72:75]
 buffer_load_dwordx4 v4, s[20:23], s54 offen offset:1024 lds
 v_mfma_f32_16x16x32_bf16 v[76:79], v[92:95], a[108:111], v[76:79]
 s_waitcnt lgkmcnt(4)
 v_mfma_f32_16x16x32_bf16 v[16:19], v[80:83], a[112:115], v[16:19]
 ds_read_b64_tr_b16 v[92:93], v15 offset:17408
 v_mfma_f32_16x16x32_bf16 v[20:23], v[80:83], a[116:119], v[20:23]
 ds_read_b64_tr_b16 v[94:95], v15 offset:17920
 v_mfma_f32_16x16x32_bf16 v[24:27], v[80:83], a[120:123], v[24:27]
 s_add_u32 m0, s53, 8192
 v_mfma_f32_16x16x32_bf16 v[28:31], v[80:83], a[124:127], v[28:31]
 s_waitcnt lgkmcnt(4)
 v_mfma_f32_16x16x32_bf16 v[32:35], v[84:87], a[112:115], v[32:35]
 v_add_u32 v14, 0xffff0000, v14
 ds_read_b64_tr_b16 v[80:81], v14 offset:24576
 v_mfma_f32_16x16x32_bf16 v[36:39], v[84:87], a[116:119], v[36:39]
 ds_read_b64_tr_b16 v[82:83], v14 offset:25088
 v_mfma_f32_16x16x32_bf16 v[40:43], v[84:87], a[120:123], v[40:43]
 s_mov_b32 s54, 4423680
 v_mfma_f32_16x16x32_bf16 v[44:47], v[84:87], a[124:127], v[44:47]
 s_waitcnt lgkmcnt(4)
 v_mfma_f32_16x16x32_bf16 v[48:51], v[88:91], a[112:115], v[48:51]
 ds_read_b64_tr_b16 v[84:85], v14 offset:25600
 v_mfma_f32_16x16x32_bf16 v[52:55], v[88:91], a[116:119], v[52:55]
 ds_read_b64_tr_b16 v[86:87], v14 offset:26112
 v_mfma_f32_16x16x32_bf16 v[56:59], v[88:91], a[120:123], v[56:59]
 buffer_load_dwordx4 v4, s[16:19], s54 offen lds
 v_mfma_f32_16x16x32_bf16 v[60:63], v[88:91], a[124:127], v[60:63]
 s_waitcnt lgkmcnt(4)
 v_mfma_f32_16x16x32_bf16 v[64:67], v[92:95], a[112:115], v[64:67]
 v_add_u32 v15, 0xffff0000, v15
 ds_read_b64_tr_b16 v[88:89], v15 offset:24576
 v_mfma_f32_16x16x32_bf16 v[68:71], v[92:95], a[116:119], v[68:71]
 ds_read_b64_tr_b16 v[90:91], v15 offset:25088
 v_mfma_f32_16x16x32_bf16 v[72:75], v[92:95], a[120:123], v[72:75]
 buffer_load_dwordx4 v4, s[20:23], s54 offen offset:1024 lds
 v_mfma_f32_16x16x32_bf16 v[76:79], v[92:95], a[124:127], v[76:79]
 s_waitcnt vmcnt(8)
 v_readfirstlane_b32 s57, v111
 s_nop 0
 s_and_b32 s57, s57, s85
 s_or_b32 s57, s57, s91
 s_cmp_lg_u32 s57, 0
 s_cbranch_scc1 L1_flagok
 s_mov_b32 s95, 0
L1_spin:
 s_add_u32 s95, s95, 1
 s_cmp_ge_u32 s95, 0x80000
 s_cbranch_scc1 L1_flagok
 s_sleep 8
 buffer_load_dword v111, v108, s[32:35], 0 offen sc1
 s_waitcnt vmcnt(0)
 v_readfirstlane_b32 s57, v111
 s_nop 0
 s_and_b32 s57, s57, s85
 s_cmp_lg_u32 s57, 0
 s_cbranch_scc0 L1_spin
L1_flagok:
 s_waitcnt lgkmcnt(4)
 v_mfma_f32_16x16x32_bf16 v[16:19], v[80:83], a[128:131], v[16:19]
 ds_read_b64_tr_b16 v[92:93], v15 offset:25600
 v_mfma_f32_16x16x32_bf16 v[20:23], v[80:83], a[132:135], v[20:23]
 ds_read_b64_tr_b16 v[94:95], v15 offset:26112
 v_mfma_f32_16x16x32_bf16 v[24:27], v[80:83], a[136:139], v[24:27]
 s_add_u32 m0, s53, 16384
 v_mfma_f32_16x16x32_bf16 v[28:31], v[80:83], a[140:143], v[28:31]
 s_barrier
 s_waitcnt lgkmcnt(4)
 v_mfma_f32_16x16x32_bf16 v[32:35], v[84:87], a[128:131], v[32:35]
 ds_read_b64_tr_b16 v[80:81], v14 offset:32768
 v_mfma_f32_16x16x32_bf16 v[36:39], v[84:87], a[132:135], v[36:39]
 ds_read_b64_tr_b16 v[82:83], v14 offset:33280
 v_mfma_f32_16x16x32_bf16 v[40:43], v[84:87], a[136:139], v[40:43]
 s_mov_b32 s54, 4718592
 v_mfma_f32_16x16x32_bf16 v[44:47], v[84:87], a[140:143], v[44:47]
 s_waitcnt lgkmcnt(4)
 v_mfma_f32_16x16x32_bf16 v[48:51], v[88:91], a[128:131], v[48:51]
 ds_read_b64_tr_b16 v[84:85], v14 offset:33792
 v_mfma_f32_16x16x32_bf16 v[52:55], v[88:91], a[132:135], v[52:55]
 ds_read_b64_tr_b16 v[86:87], v14 offset:34304
 v_mfma_f32_16x16x32_bf16 v[56:59], v[88:91], a[136:139], v[56:59]
 buffer_load_dwordx4 v4, s[16:19], s54 offen lds
 v_mfma_f32_16x16x32_bf16 v[60:63], v[88:91], a[140:143], v[60:63]
 s_waitcnt lgkmcnt(4)
 v_mfma_f32_16x16x32_bf16 v[64:67], v[92:95], a[128:131], v[64:67]
 ds_read_b64_tr_b16 v[88:89], v15 offset:32768
 v_mfma_f32_16x16x32_bf16 v[68:71], v[92:95], a[132:135], v[68:71]
 ds_read_b64_tr_b16 v[90:91], v15 offset:33280
 v_mfma_f32_16x16x32_bf16 v[72:75], v[92:95], a[136:139], v[72:75]
 buffer_load_dwordx4 v4, s[20:23], s54 offen offset:1024 lds
 v_mfma_f32_16x16x32_bf16 v[76:79], v[92:95], a[140:143], v[76:79]
 buffer_load_dwordx4 v[160:163], v106, s[28:31], 0 offen sc1
 buffer_load_dwordx2 v[180:181], v106, s[28:31], 0 offen offset:1024 sc1
 buffer_load_dwordx2 v[190:191], v106, s[28:31], 0 offen offset:1032 sc1
 s_waitcnt lgkmcnt(4)
 v_mfma_f32_16x16x32_bf16 v[16:19], v[80:83], a[144:147], v[16:19]
 ds_read_b64_tr_b16 v[92:93], v15 offset:33792
 v_mfma_f32_16x16x32_bf16 v[20:23], v[80:83], a[148:151], v[20:23]
 ds_read_b64_tr_b16 v[94:95], v15 offset:34304
 v_mfma_f32_16x16x32_bf16 v[24:27], v[80:83], a[152:155], v[24:27]
 s_add_u32 m0, s53, 131072
 v_mfma_f32_16x16x32_bf16 v[28:31], v[80:83], a[156:159], v[28:31]
 s_waitcnt lgkmcnt(4)
 v_mfma_f32_16x16x32_bf16 v[32:35], v[84:87], a[144:147], v[32:35]
 ds_read_b64_tr_b16 v[80:81], v14 offset:40960
 v_mfma_f32_16x16x32_bf16 v[36:39], v[84:87], a[148:151], v[36:39]
 ds_read_b64_tr_b16 v[82:83], v14 offset:41472
 v_mfma_f32_16x16x32_bf16 v[40:43], v[84:87], a[152:155], v[40:43]
 s_mov_b32 s54, 5013504
 v_mfma_f32_16x16x32_bf16 v[44:47], v[84:87], a[156:159], v[44:47]
 s_waitcnt lgkmcnt(4)
 v_mfma_f32_16x16x32_bf16 v[48:51], v[88:91], a[144:147], v[48:51]
 ds_read_b64_tr_b16 v[84:85], v14 offset:41984
 v_mfma_f32_16x16x32_bf16 v[52:55], v[88:91], a[148:151], v[52:55]
 ds_read_b64_tr_b16 v[86:87], v14 offset:42496
 v_mfma_f32_16x16x32_bf16 v[56:59], v[88:91], a[152:155], v[56:59]
 buffer_load_dwordx4 v4, s[16:19], s54 offen lds
 v_mfma_f32_16x16x32_bf16 v[60:63], v[88:91], a[156:159], v[60:63]
 s_waitcnt lgkmcnt(4)
 v_mfma_f32_16x16x32_bf16 v[64:67], v[92:95], a[144:147], v[64:67]
 ds_read_b64_tr_b16 v[88:89], v15 offset:40960
 v_mfma_f32_16x16x32_bf16 v[68:71], v[92:95], a[148:151], v[68:71]
 ds_read_b64_tr_b16 v[90:91], v15 offset:41472
 v_mfma_f32_16x16x32_bf16 v[72:75], v[92:95], a[152:155], v[72:75]
 buffer_load_dwordx4 v4, s[20:23], s54 offen offset:1024 lds
 v_mfma_f32_16x16x32_bf16 v[76:79], v[92:95], a[156:159], v[76:79]
 s_waitcnt lgkmcnt(4)
 v_mfma_f32_16x16x32_bf16 v[16:19], v[80:83], a[160:163], v[16:19]
 ds_read_b64_tr_b16 v[92:93], v15 offset:41984
 v_mfma_f32_16x16x32_bf16 v[20:23], v[80:83], a[164:167], v[20:23]
 ds_read_b64_tr_b16 v[94:95], v15 offset:42496
 v_mfma_f32_16x16x32_bf16 v[24:27], v[80:83], a[168:171], v[24:27]
 s_add_u32 m0, s53, 147456
 v_mfma_f32_16x16x32_bf16 v[28:31], v[80:83], a[172:175], v[28:31]
 s_waitcnt lgkmcnt(4)
 v_mfma_f32_16x16x32_bf16 v[32:35], v[84:87], a[160:163], v[32:35]
 ds_read_b64_tr_b16 v[80:81], v14 offset:49152
 v_mfma_f32_16x16x32_bf16 v[36:39], v[84:87], a[164:167], v[36:39]
 ds_read_b64_tr_b16 v[82:83], v14 offset:49664
 v_mfma_f32_16x16x32_bf16 v[40:43], v[84:87], a[168:171], v[40:43]
 s_mov_b32 s54, 128
 v_mfma_f32_16x16x32_bf16 v[44:47], v[84:87], a[172:175], v[44:47]
 s_waitcnt lgkmcnt(4)
 v_mfma_f32_16x16x32_bf16 v[48:51], v[88:91], a[160:163], v[48:51]
 ds_read_b64_tr_b16 v[84:85], v14 offset:50176
 v_mfma_f32_16x16x32_bf16 v[52:55], v[88:91], a[164:167], v[52:55]
 ds_read_b64_tr_b16 v[86:87], v14 offset:50688
 v_mfma_f32_16x16x32_bf16 v[56:59], v[88:91], a[168:171], v[56:59]
 buffer_load_dwordx4 v4, s[16:19], s54 offen lds
 v_mfma_f32_16x16x32_bf16 v[60:63], v[88:91], a[172:175], v[60:63]
 s_waitcnt lgkmcnt(4)
 v_mfma_f32_16x16x32_bf16 v[64:67], v[92:95], a[160:163], v[64:67]
 ds_read_b64_tr_b16 v[88:89], v15 offset:49152
 v_mfma_f32_16x16x32_bf16 v[68:71], v[92:95], a[164:167], v[68:71]
 ds_read_b64_tr_b16 v[90:91], v15 offset:49664
 v_mfma_f32_16x16x32_bf16 v[72:75], v[92:95], a[168:171], v[72:75]
 buffer_load_dwordx4 v4, s[20:23], s54 offen offset:1024 lds
 v_mfma_f32_16x16x32_bf16 v[76:79], v[92:95], a[172:175], v[76:79]
 s_waitcnt lgkmcnt(4)
 v_mfma_f32_16x16x32_bf16 v[16:19], v[80:83], a[176:179], v[16:19]
 ds_read_b64_tr_b16 v[92:93], v15 offset:50176
 v_mfma_f32_16x16x32_bf16 v[20:23], v[80:83], a[180:183], v[20:23]
 ds_read_b64_tr_b16 v[94:95], v15 offset:50688
 v_mfma_f32_16x16x32_bf16 v[24:27], v[80:83], a[184:187], v[24:27]
 s_add_u32 m0, s53, 24576
 v_mfma_f32_16x16x32_bf16 v[28:31], v[80:83], a[188:191], v[28:31]
 s_waitcnt vmcnt(11)
 s_barrier
 s_waitcnt lgkmcnt(4)
 v_mfma_f32_16x16x32_bf16 v[32:35], v[84:87], a[176:179], v[32:35]
 v_add_u32 v14, 0x10000, v14
 ds_read_b64_tr_b16 v[80:81], v14 offset:24576
 v_mfma_f32_16x16x32_bf16 v[36:39], v[84:87], a[180:183], v[36:39]
 ds_read_b64_tr_b16 v[82:83], v14 offset:25088
 v_mfma_f32_16x16x32_bf16 v[40:43], v[84:87], a[184:187], v[40:43]
 s_mov_b32 s54, 295040
 v_mfma_f32_16x16x32_bf16 v[44:47], v[84:87], a[188:191], v[44:47]
 s_waitcnt lgkmcnt(4)
 v_mfma_f32_16x16x32_bf16 v[48:51], v[88:91], a[176:179], v[48:51]
 ds_read_b64_tr_b16 v[84:85], v14 offset:25600
 v_mfma_f32_16x16x32_bf16 v[52:55], v[88:91], a[180:183], v[52:55]
 ds_read_b64_tr_b16 v[86:87], v14 offset:26112
 v_mfma_f32_16x16x32_bf16 v[56:59], v[88:91], a[184:187], v[56:59]
 buffer_load_dwordx4 v4, s[16:19], s54 offen lds
 v_mfma_f32_16x16x32_bf16 v[60:63], v[88:91], a[188:191], v[60:63]
 s_waitcnt lgkmcnt(4)
 v_mfma_f32_16x16x32_bf16 v[64:67], v[92:95], a[176:179], v[64:67]
 v_add_u32 v15, 0x10000, v15
 ds_read_b64_tr_b16 v[88:89], v15 offset:24576
 v_mfma_f32_16x16x32_bf16 v[68:71], v[92:95], a[180:183], v[68:71]
 ds_read_b64_tr_b16 v[90:91], v15 offset:25088
 v_mfma_f32_16x16x32_bf16 v[72:75], v[92:95], a[184:187], v[72:75]
 buffer_load_dwordx4 v4, s[20:23], s54 offen offset:1024 lds
 v_mfma_f32_16x16x32_bf16 v[76:79], v[92:95], a[188:191], v[76:79]
 s_waitcnt lgkmcnt(4)
 v_mfma_f32_16x16x32_bf16 v[16:19], v[80:83], a[192:195], v[16:19]
 ds_read_b64_tr_b16 v[92:93], v15 offset:25600
 v_mfma_f32_16x16x32_bf16 v[20:23], v[80:83], a[196:199], v[20:23]
 ds_read_b64_tr_b16 v[94:95], v15 offset:26112
 v_mfma_f32_16x16x32_bf16 v[24:27], v[80:83], a[200:203], v[24:27]
 s_add_u32 m0, s53, 106496
 v_mfma_f32_16x16x32_bf16 v[28:31], v[80:83], a[204:207], v[28:31]
 s_waitcnt lgkmcnt(4)
 v_mfma_f32_16x16x32_bf16 v[32:35], v[84:87], a[192:195], v[32:35]
 v_add_u32 v14, 0xfffe0000, v14
 ds_read_b64_tr_b16 v[80:81], v14 offset:0
 v_mfma_f32_16x16x32_bf16 v[36:39], v[84:87], a[196:199], v[36:39]
 ds_read_b64_tr_b16 v[82:83], v14 offset:512
 v_mfma_f32_16x16x32_bf16 v[40:43], v[84:87], a[200:203], v[40:43]
 s_mov_b32 s54, 589952
 v_mfma_f32_16x16x32_bf16 v[44:47], v[84:87], a[204:207], v[44:47]
 s_waitcnt lgkmcnt(4)
 v_mfma_f32_16x16x32_bf16 v[48:51], v[88:91], a[192:195], v[48:51]
 ds_read_b64_tr_b16 v[84:85], v14 offset:1024
 v_mfma_f32_16x16x32_bf16 v[52:55], v[88:91], a[196:199], v[52:55]
 ds_read_b64_tr_b16 v[86:87], v14 offset:1536
 v_mfma_f32_16x16x32_bf16 v[56:59], v[88:91], a[200:203], v[56:59]
 buffer_load_dwordx4 v4, s[16:19], s54 offen lds
 v_mfma_f32_16x16x32_bf16 v[60:63], v[88:91], a[204:207], v[60:63]
 s_waitcnt lgkmcnt(4)
 v_mfma_f32_16x16x32_bf16 v[64:67], v[92:95], a[192:195], v[64:67]
 v_add_u32 v15, 0xfffe0000, v15
 ds_read_b64_tr_b16 v[88:89], v15 offset:0
 v_mfma_f32_16x16x32_bf16 v[68:71], v[92:95], a[196:199], v[68:71]
 ds_read_b64_tr_b16 v[90:91], v15 offset:512
 v_mfma_f32_16x16x32_bf16 v[72:75], v[92:95], a[200:203], v[72:75]
 buffer_load_dwordx4 v4, s[20:23], s54 offen offset:1024 lds
 v_mfma_f32_16x16x32_bf16 v[76:79], v[92:95], a[204:207], v[76:79]
 s_waitcnt lgkmcnt(4)
 v_mfma_f32_16x16x32_bf16 v[16:19], v[80:83], a[208:211], v[16:19]
 ds_read_b64_tr_b16 v[92:93], v15 offset:1024
 v_mfma_f32_16x16x32_bf16 v[20:23], v[80:83], a[212:215], v[20:23]
 ds_read_b64_tr_b16 v[94:95], v15 offset:1536
 v_mfma_f32_16x16x32_bf16 v[24:27], v[80:83], a[216:219], v[24:27]
 s_add_u32 m0, s53, 32768
 v_mfma_f32_16x16x32_bf16 v[28:31], v[80:83], a[220:223], v[28:31]
 s_waitcnt lgkmcnt(4)
 v_mfma_f32_16x16x32_bf16 v[32:35], v[84:87], a[208:211], v[32:35]
 v_add_u32 v14, 0x10000, v14
 ds_read_b64_tr_b16 v[80:81], v14 offset:57344
 v_mfma_f32_16x16x32_bf16 v[36:39], v[84:87], a[212:215], v[36:39]
 ds_read_b64_tr_b16 v[82:83], v14 offset:57856
 v_mfma_f32_16x16x32_bf16 v[40:43], v[84:87], a[216:219], v[40:43]
 s_mov_b32 s54, 884864
 v_mfma_f32_16x16x32_bf16 v[44:47], v[84:87], a[220:223], v[44:47]
 s_waitcnt lgkmcnt(4)
 v_mfma_f32_16x16x32_bf16 v[48:51], v[88:91], a[208:211], v[48:51]
 ds_read_b64_tr_b16 v[84:85], v14 offset:58368
 v_mfma_f32_16x16x32_bf16 v[52:55], v[88:91], a[212:215], v[52:55]
 ds_read_b64_tr_b16 v[86:87], v14 offset:58880
 v_mfma_f32_16x16x32_bf16 v[56:59], v[88:91], a[216:219], v[56:59]
 buffer_load_dwordx4 v4, s[16:19], s54 offen lds
 v_mfma_f32_16x16x32_bf16 v[60:63], v[88:91], a[220:223], v[60:63]
 s_waitcnt lgkmcnt(4)
 v_mfma_f32_16x16x32_bf16 v[64:67], v[92:95], a[208:211], v[64:67]
 v_add_u32 v15, 0x10000, v15
 ds_read_b64_tr_b16 v[88:89], v15 offset:57344
 v_mfma_f32_16x16x32_bf16 v[68:71], v[92:95], a[212:215], v[68:71]
 ds_read_b64_tr_b16 v[90:91], v15 offset:57856
 v_mfma_f32_16x16x32_bf16 v[72:75], v[92:95], a[216:219], v[72:75]
 buffer_load_dwordx4 v4, s[20:23], s54 offen offset:1024 lds
 v_mfma_f32_16x16x32_bf16 v[76:79], v[92:95], a[220:223], v[76:79]
 s_waitcnt lgkmcnt(4)
 v_mfma_f32_16x16x32_bf16 v[16:19], v[80:83], a[224:227], v[16:19]
 ds_read_b64_tr_b16 v[92:93], v15 offset:58368
 v_mfma_f32_16x16x32_bf16 v[20:23], v[80:83], a[228:231], v[20:23]
 ds_read_b64_tr_b16 v[94:95], v15 offset:58880
 v_mfma_f32_16x16x32_bf16 v[24:27], v[80:83], a[232:235], v[24:27]
 s_add_u32 m0, s53, 40960
 v_mfma_f32_16x16x32_bf16 v[28:31], v[80:83], a[236:239], v[28:31]
 s_waitcnt vmcnt(8)
 s_barrier
 s_waitcnt lgkmcnt(4)
 v_mfma_f32_16x16x32_bf16 v[32:35], v[84:87], a[224:227], v[32:35]
 v_add_u32 v14, 0xffff0000, v14
 ds_read_b64_tr_b16 v[80:81], v14 offset:8192
 v_mfma_f32_16x16x32_bf16 v[36:39], v[84:87], a[228:231], v[36:39]
 ds_read_b64_tr_b16 v[82:83], v14 offset:8704
 v_mfma_f32_16x16x32_bf16 v[40:43], v[84:87], a[232:235], v[40:43]
 s_mov_b32 s54, 1179776
 v_mfma_f32_16x16x32_bf16 v[44:47], v[84:87], a[236:239], v[44:47]
 s_waitcnt lgkmcnt(4)
 v_mfma_f32_16x16x32_bf16 v[48:51], v[88:91], a[224:227], v[48:51]
 ds_read_b64_tr_b16 v[84:85], v14 offset:9216
 v_mfma_f32_16x16x32_bf16 v[52:55], v[88:91], a[228:231], v[52:55]
 ds_read_b64_tr_b16 v[86:87], v14 offset:9728
 v_mfma_f32_16x16x32_bf16 v[56:59], v[88:91], a[232:235], v[56:59]
 buffer_load_dwordx4 v4, s[16:19], s54 offen lds
 v_mfma_f32_16x16x32_bf16 v[60:63], v[88:91], a[236:239], v[60:63]
 s_waitcnt lgkmcnt(4)
 v_mfma_f32_16x16x32_bf16 v[64:67], v[92:95], a[224:227], v[64:67]
 v_add_u32 v15, 0xffff0000, v15
 ds_read_b64_tr_b16 v[88:89], v15 offset:8192
 v_mfma_f32_16x16x32_bf16 v[68:71], v[92:95], a[228:231], v[68:71]
 ds_read_b64_tr_b16 v[90:91], v15 offset:8704
 v_mfma_f32_16x16x32_bf16 v[72:75], v[92:95], a[232:235], v[72:75]
 buffer_load_dwordx4 v4, s[20:23], s54 offen offset:1024 lds
 v_mfma_f32_16x16x32_bf16 v[76:79], v[92:95], a[236:239], v[76:79]
 s_waitcnt lgkmcnt(4)
 v_mfma_f32_16x16x32_bf16 v[16:19], v[80:83], a[240:243], v[16:19]
 ds_read_b64_tr_b16 v[92:93], v15 offset:9216
 v_mfma_f32_16x16x32_bf16 v[20:23], v[80:83], a[244:247], v[20:23]
 ds_read_b64_tr_b16 v[94:95], v15 offset:9728
 v_mfma_f32_16x16x32_bf16 v[24:27], v[80:83], a[248:251], v[24:27]
 s_add_u32 m0, s53, 114688
 v_mfma_f32_16x16x32_bf16 v[28:31], v[80:83], a[252:255], v[28:31]
 s_waitcnt lgkmcnt(4)
 v_mfma_f32_16x16x32_bf16 v[32:35], v[84:87], a[240:243], v[32:35]
 ds_read_b64_tr_b16 v[80:81], v14 offset:16384
 v_mfma_f32_16x16x32_bf16 v[36:39], v[84:87], a[244:247], v[36:39]
 ds_read_b64_tr_b16 v[82:83], v14 offset:16896
 v_mfma_f32_16x16x32_bf16 v[40:43], v[84:87], a[248:251], v[40:43]
 s_mov_b32 s54, 1474688
 v_mfma_f32_16x16x32_bf16 v[44:47], v[84:87], a[252:255], v[44:47]
 s_waitcnt lgkmcnt(4)
 v_mfma_f32_16x16x32_bf16 v[48:51], v[88:91], a[240:243], v[48:51]
 ds_read_b64_tr_b16 v[84:85], v14 offset:17408
 v_mfma_f32_16x16x32_bf16 v[52:55], v[88:91], a[244:247], v[52:55]
 ds_read_b64_tr_b16 v[86:87], v14 offset:17920
 v_mfma_f32_16x16x32_bf16 v[56:59], v[88:91], a[248:251], v[56:59]
 buffer_load_dwordx4 v4, s[16:19], s54 offen lds
 v_mfma_f32_16x16x32_bf16 v[60:63], v[88:91], a[252:255], v[60:63]
 s_waitcnt lgkmcnt(4)
 v_mfma_f32_16x16x32_bf16 v[64:67], v[92:95], a[240:243], v[64:67]
 ds_read_b64_tr_b16 v[88:89], v15 offset:16384
 v_mfma_f32_16x16x32_bf16 v[68:71], v[92:95], a[244:247], v[68:71]
 ds_read_b64_tr_b16 v[90:91], v15 offset:16896
 v_mfma_f32_16x16x32_bf16 v[72:75], v[92:95], a[248:251], v[72:75]
 buffer_load_dwordx4 v4, s[20:23], s54 offen offset:1024 lds
 v_mfma_f32_16x16x32_bf16 v[76:79], v[92:95], a[252:255], v[76:79]
 s_waitcnt lgkmcnt(4)
 v_mfma_f32_16x16x32_bf16 v[16:19], v[80:83], v[112:115], v[16:19]
 ds_read_b64_tr_b16 v[92:93], v15 offset:17408
 v_mfma_f32_16x16x32_bf16 v[20:23], v[80:83], v[116:119], v[20:23]
 ds_read_b64_tr_b16 v[94:95], v15 offset:17920
 v_mfma_f32_16x16x32_bf16 v[24:27], v[80:83], v[120:123], v[24:27]
 s_add_u32 m0, s53, 155648
 v_mfma_f32_16x16x32_bf16 v[28:31], v[80:83], v[124:127], v[28:31]
 s_waitcnt lgkmcnt(4)
 v_mfma_f32_16x16x32_bf16 v[32:35], v[84:87], v[112:115], v[32:35]
 v_add_u32 v14, 0x20000, v14
 ds_read_b64_tr_b16 v[80:81], v14 offset:0
 v_mfma_f32_16x16x32_bf16 v[36:39], v[84:87], v[116:119], v[36:39]
 ds_read_b64_tr_b16 v[82:83], v14 offset:512
 v_mfma_f32_16x16x32_bf16 v[40:43], v[84:87], v[120:123], v[40:43]
 s_mov_b32 s54, 1769600
 v_mfma_f32_16x16x32_bf16 v[44:47], v[84:87], v[124:127], v[44:47]
 s_waitcnt lgkmcnt(4)
 v_mfma_f32_16x16x32_bf16 v[48:51], v[88:91], v[112:115], v[48:51]
 ds_read_b64_tr_b16 v[84:85], v14 offset:1024
 v_mfma_f32_16x16x32_bf16 v[52:55], v[88:91], v[116:119], v[52:55]
 ds_read_b64_tr_b16 v[86:87], v14 offset:1536
 v_mfma_f32_16x16x32_bf16 v[56:59], v[88:91], v[120:123], v[56:59]
 buffer_load_dwordx4 v4, s[16:19], s54 offen lds
 v_mfma_f32_16x16x32_bf16 v[60:63], v[88:91], v[124:127], v[60:63]
 s_waitcnt lgkmcnt(4)
 v_mfma_f32_16x16x32_bf16 v[64:67], v[92:95], v[112:115], v[64:67]
 v_add_u32 v15, 0x20000, v15
 ds_read_b64_tr_b16 v[88:89], v15 offset:0
 v_mfma_f32_16x16x32_bf16 v[68:71], v[92:95], v[116:119], v[68:71]
 ds_read_b64_tr_b16 v[90:91], v15 offset:512
 v_mfma_f32_16x16x32_bf16 v[72:75], v[92:95], v[120:123], v[72:75]
 buffer_load_dwordx4 v4, s[20:23], s54 offen offset:1024 lds
 v_mfma_f32_16x16x32_bf16 v[76:79], v[92:95], v[124:127], v[76:79]
 s_waitcnt lgkmcnt(4)
 v_mfma_f32_16x16x32_bf16 v[16:19], v[80:83], v[128:131], v[16:19]
 ds_read_b64_tr_b16 v[92:93], v15 offset:1024
 v_mfma_f32_16x16x32_bf16 v[20:23], v[80:83], v[132:135], v[20:23]
 ds_read_b64_tr_b16 v[94:95], v15 offset:1536
 v_mfma_f32_16x16x32_bf16 v[24:27], v[80:83], v[136:139], v[24:27]
 s_add_u32 m0, s53, 0
 v_mfma_f32_16x16x32_bf16 v[28:31], v[80:83], v[140:143], v[28:31]
 s_waitcnt lgkmcnt(4)
 v_mfma_f32_16x16x32_bf16 v[32:35], v[84:87], v[128:131], v[32:35]
 v_mfma_f32_16x16x32_bf16 v[36:39], v[84:87], v[132:135], v[36:39]
 v_mfma_f32_16x16x32_bf16 v[40:43], v[84:87], v[136:139], v[40:43]
 s_mov_b32 s54, 2064512
 v_mfma_f32_16x16x32_bf16 v[44:47], v[84:87], v[140:143], v[44:47]
 s_waitcnt lgkmcnt(2)
 v_mfma_f32_16x16x32_bf16 v[48:51], v[88:91], v[128:131], v[48:51]
 v_mfma_f32_16x16x32_bf16 v[52:55], v[88:91], v[132:135], v[52:55]
 v_mfma_f32_16x16x32_bf16 v[56:59], v[88:91], v[136:139], v[56:59]
 buffer_load_dwordx4 v4, s[16:19], s54 offen lds
 v_mfma_f32_16x16x32_bf16 v[60:63], v[88:91], v[140:143], v[60:63]
 s_waitcnt lgkmcnt(0)
 v_mfma_f32_16x16x32_bf16 v[64:67], v[92:95], v[128:131], v[64:67]
 v_mfma_f32_16x16x32_bf16 v[68:71], v[92:95], v[132:135], v[68:71]
 v_mfma_f32_16x16x32_bf16 v[72:75], v[92:95], v[136:139], v[72:75]
 buffer_load_dwordx4 v4, s[20:23], s54 offen offset:1024 lds
 v_mfma_f32_16x16x32_bf16 v[76:79], v[92:95], v[140:143], v[76:79]
 s_cmp_eq_u32 s49, 1
 s_cbranch_scc0 L1_nohr
 v_add_u32 v216, s92, v98
 ds_read_b128 v[160:163], v216
 ds_read_b64 v[180:181], v216 offset:1024
 ds_read_b64 v[190:191], v216 offset:1032
 s_waitcnt lgkmcnt(0)
L1_nohr:
 v_mfma_f32_16x16x32_bf16 v[208:211], v[160:163], v[144:147], 0
 v_mfma_f32_16x16x32_bf16 v[212:215], v[164:167], v[144:147], 0
 s_cmp_eq_u32 s84, 1
 s_cselect_b64 s[40:41], 0, s[60:61]
 s_cselect_b64 s[42:43], 0, s[62:63]
 s_cselect_b64 s[44:45], 0, s[64:65]
 s_cselect_b64 s[46:47], 0, s[66:67]
 v_mov_b32 v216, s83
 s_nop 0
 v_cndmask_b32 v208, v216, v208, s[40:41]
 v_cndmask_b32 v212, v216, v212, s[68:69]
 v_cndmask_b32 v209, v216, v209, s[42:43]
 v_cndmask_b32 v213, v216, v213, s[70:71]
 v_cndmask_b32 v210, v216, v210, s[44:45]
 v_cndmask_b32 v214, v216, v214, s[72:73]
 v_cndmask_b32 v211, v216, v211, s[46:47]
 v_cndmask_b32 v215, v216, v215, s[74:75]
 v_max3_f32 v217, v208, v209, v210
 v_max3_f32 v218, v211, v212, v213
 v_max3_f32 v217, v217, v214, v215
 v_max_f32 v217, v217, v218
 v_mov_b32 v218, v217
 s_nop 1
 v_permlane16_swap_b32 v217, v218
 v_max_f32 v217, v217, v218
 v_mov_b32 v218, v217
 s_nop 1
 v_permlane32_swap_b32 v217, v218
 v_max_f32 v217, v217, v218
 v_mul_f32 v217, s82, v217
 v_fma_f32 v208, v208, s82, -v217
 v_fma_f32 v209, v209, s82, -v217
 v_fma_f32 v210, v210, s82, -v217
 v_fma_f32 v211, v211, s82, -v217
 v_fma_f32 v212, v212, s82, -v217
 v_fma_f32 v213, v213, s82, -v217
 v_fma_f32 v214, v214, s82, -v217
 v_fma_f32 v215, v215, s82, -v217
 v_exp_f32 v208, v208
 v_exp_f32 v209, v209
 v_exp_f32 v210, v210
 v_exp_f32 v211, v211
 v_exp_f32 v212, v212
 v_exp_f32 v213, v213
 v_exp_f32 v214, v214
 v_exp_f32 v215, v215
 v_cvt_pk_bf16_f32 v220, v208, v209
 v_cvt_pk_bf16_f32 v221, v210, v211
 v_cvt_pk_bf16_f32 v222, v212, v213
 v_cvt_pk_bf16_f32 v223, v214, v215
 s_nop 1
 v_mfma_f32_16x16x32_bf16 v[208:211], v[180:183], v[220:223], 0
 v_mfma_f32_16x16x32_bf16 v[212:215], v[190:193], v[220:223], 0
 s_nop 7
 v_rcp_f32 v216, v214
 s_nop 0
 v_mul_f32 v208, v208, v216
 v_mul_f32 v209, v209, v216
 v_mul_f32 v210, v210, v216
 v_mul_f32 v211, v211, v216
 v_mul_f32 v212, v212, v216
 v_mul_f32 v213, v213, v216
 v_cvt_pk_bf16_f32 v216, v208, v209
 v_cvt_pk_bf16_f32 v217, v210, v211
 v_cvt_pk_bf16_f32 v218, v212, v213
 s_mov_b32 s94, 0
 buffer_store_dwordx2 v[216:217], v103, s[28:31], s94 offen sc1
 buffer_store_dword v218, v104, s[28:31], s94 offen sc1
 s_waitcnt vmcnt(12)
 s_barrier
 ds_read_b64_tr_b16 v[80:81], v14 offset:16384
 ds_read_b64_tr_b16 v[82:83], v14 offset:16896
 ds_read_b64_tr_b16 v[84:85], v14 offset:17408
 ds_read_b64_tr_b16 v[86:87], v14 offset:17920
 ds_read_b64_tr_b16 v[88:89], v15 offset:16384
 ds_read_b64_tr_b16 v[90:91], v15 offset:16896
 s_waitcnt lgkmcnt(4)
 v_mfma_f32_16x16x32_bf16 v[144:147], v[80:83], a[0:3], 0
 ds_read_b64_tr_b16 v[92:93], v15 offset:17408
 v_mfma_f32_16x16x32_bf16 v[148:151], v[80:83], a[4:7], 0
 ds_read_b64_tr_b16 v[94:95], v15 offset:17920
 v_mfma_f32_16x16x32_bf16 v[152:155], v[80:83], a[8:11], 0
 s_add_u32 m0, s53, 122880
 v_max_f32 v16, 0, v16
 v_mfma_f32_16x16x32_bf16 v[156:159], v[80:83], a[12:15], 0
 v_max_f32 v17, 0, v17
 s_waitcnt lgkmcnt(4)
 v_mfma_f32_16x16x32_bf16 v[160:163], v[84:87], a[0:3], 0
 v_add_u32 v14, 0xfffe0000, v14
 ds_read_b64_tr_b16 v[80:81], v14 offset:24576
 v_mfma_f32_16x16x32_bf16 v[164:167], v[84:87], a[4:7], 0
 ds_read_b64_tr_b16 v[82:83], v14 offset:25088
 v_mfma_f32_16x16x32_bf16 v[168:171], v[84:87], a[8:11], 0
 s_mov_b32 s54, 2359424
 v_max_f32 v18, 0, v18
 v_mfma_f32_16x16x32_bf16 v[172:175], v[84:87], a[12:15], 0
 v_max_f32 v19, 0, v19
 s_waitcnt lgkmcnt(4)
 v_mfma_f32_16x16x32_bf16 v[176:179], v[88:91], a[0:3], 0
 ds_read_b64_tr_b16 v[84:85], v14 offset:25600
 v_mfma_f32_16x16x32_bf16 v[180:183], v[88:91], a[4:7], 0
 ds_read_b64_tr_b16 v[86:87], v14 offset:26112
 v_mfma_f32_16x16x32_bf16 v[184:187], v[88:91], a[8:11], 0
 buffer_load_dwordx4 v4, s[16:19], s54 offen lds
 v_mul_f32 v16, v16, v32
 v_mfma_f32_16x16x32_bf16 v[188:191], v[88:91], a[12:15], 0
 v_mul_f32 v17, v17, v33
 s_waitcnt lgkmcnt(4)
 v_mfma_f32_16x16x32_bf16 v[192:195], v[92:95], a[0:3], 0
 v_add_u32 v15, 0xfffe0000, v15
 ds_read_b64_tr_b16 v[88:89], v15 offset:24576
 v_mfma_f32_16x16x32_bf16 v[196:199], v[92:95], a[4:7], 0
 ds_read_b64_tr_b16 v[90:91], v15 offset:25088
 v_mfma_f32_16x16x32_bf16 v[200:203], v[92:95], a[8:11], 0
 buffer_load_dwordx4 v4, s[20:23], s54 offen offset:1024 lds
 v_mul_f32 v18, v18, v34
 v_mfma_f32_16x16x32_bf16 v[204:207], v[92:95], a[12:15], 0
 v_mul_f32 v19, v19, v35
 s_waitcnt lgkmcnt(4)
 v_mfma_f32_16x16x32_bf16 v[144:147], v[80:83], a[16:19], v[144:147]
 ds_read_b64_tr_b16 v[92:93], v15 offset:25600
 v_mfma_f32_16x16x32_bf16 v[148:151], v[80:83], a[20:23], v[148:151]
 ds_read_b64_tr_b16 v[94:95], v15 offset:26112
 v_mfma_f32_16x16x32_bf16 v[152:155], v[80:83], a[24:27], v[152:155]
 s_add_u32 m0, s53, 139264
 v_cvt_pk_bf16_f32 v208, v16, v17
 v_mfma_f32_16x16x32_bf16 v[156:159], v[80:83], a[28:31], v[156:159]
 v_cvt_pk_bf16_f32 v209, v18, v19
 s_waitcnt lgkmcnt(4)
 v_mfma_f32_16x16x32_bf16 v[160:163], v[84:87], a[16:19], v[160:163]
 v_add_u32 v14, 0x10000, v14
 ds_read_b64_tr_b16 v[80:81], v14 offset:40960
 v_mfma_f32_16x16x32_bf16 v[164:167], v[84:87], a[20:23], v[164:167]
 ds_read_b64_tr_b16 v[82:83], v14 offset:41472
 v_mfma_f32_16x16x32_bf16 v[168:171], v[84:87], a[24:27], v[168:171]
 s_mov_b32 s54, 2654336
 v_max_f32 v48, 0, v48
 v_mfma_f32_16x16x32_bf16 v[172:175], v[84:87], a[28:31], v[172:175]
 v_max_f32 v49, 0, v49
 s_waitcnt lgkmcnt(4)
 v_mfma_f32_16x16x32_bf16 v[176:179], v[88:91], a[16:19], v[176:179]
 ds_read_b64_tr_b16 v[84:85], v14 offset:41984
 v_mfma_f32_16x16x32_bf16 v[180:183], v[88:91], a[20:23], v[180:183]
 ds_read_b64_tr_b16 v[86:87], v14 offset:42496
 v_mfma_f32_16x16x32_bf16 v[184:187], v[88:91], a[24:27], v[184:187]
 buffer_load_dwordx4 v4, s[16:19], s54 offen lds
 v_max_f32 v50, 0, v50
 v_mfma_f32_16x16x32_bf16 v[188:191], v[88:91], a[28:31], v[188:191]
 v_max_f32 v51, 0, v51
 s_waitcnt lgkmcnt(4)
 v_mfma_f32_16x16x32_bf16 v[192:195], v[92:95], a[16:19], v[192:195]
 v_add_u32 v15, 0x10000, v15
 ds_read_b64_tr_b16 v[88:89], v15 offset:40960
 v_mfma_f32_16x16x32_bf16 v[196:199], v[92:95], a[20:23], v[196:199]
 ds_read_b64_tr_b16 v[90:91], v15 offset:41472
 v_mfma_f32_16x16x32_bf16 v[200:203], v[92:95], a[24:27], v[200:203]
 buffer_load_dwordx4 v4, s[20:23], s54 offen offset:1024 lds
 v_mul_f32 v48, v48, v64
 v_mfma_f32_16x16x32_bf16 v[204:207], v[92:95], a[28:31], v[204:207]
 v_mul_f32 v49, v49, v65
 s_waitcnt lgkmcnt(4)
 v_mfma_f32_16x16x32_bf16 v[144:147], v[80:83], a[32:35], v[144:147]
 ds_read_b64_tr_b16 v[92:93], v15 offset:41984
 v_mfma_f32_16x16x32_bf16 v[148:151], v[80:83], a[36:39], v[148:151]
 ds_read_b64_tr_b16 v[94:95], v15 offset:42496
 v_mfma_f32_16x16x32_bf16 v[152:155], v[80:83], a[40:43], v[152:155]
 s_add_u32 m0, s53, 8192
 v_mul_f32 v50, v50, v66
 v_mfma_f32_16x16x32_bf16 v[156:159], v[80:83], a[44:47], v[156:159]
 v_mul_f32 v51, v51, v67
 s_waitcnt vmcnt(10)
 s_waitcnt vmcnt(4)
 s_barrier
 s_lshl_b32 s57, s52, 4
 v_mov_b32 v248, s57
 v_mov_b32 v249, 0x7ff00000
 v_cmp_eq_u32 vcc, 0, v0
 s_nop 1
 v_cndmask_b32 v248, v249, v248, vcc
 s_cmp_eq_u32 s48, 2
 s_cselect_b64 s[86:87], -1, 0
 v_cndmask_b32 v248, v249, v248, s[86:87]
 s_add_u32 s57, s51, 16
 s_lshl_b32 s57, 1, s57
 v_mov_b32 v249, s57
 buffer_atomic_or v249, v248, s[32:35], 0 offen
 s_waitcnt lgkmcnt(4)
 v_mfma_f32_16x16x32_bf16 v[160:163], v[84:87], a[32:35], v[160:163]
 v_add_u32 v14, 0xffff0000, v14
 ds_read_b64_tr_b16 v[80:81], v14 offset:32768
 v_mfma_f32_16x16x32_bf16 v[164:167], v[84:87], a[36:39], v[164:167]
 ds_read_b64_tr_b16 v[82:83], v14 offset:33280
 v_mfma_f32_16x16x32_bf16 v[168:171], v[84:87], a[40:43], v[168:171]
 s_mov_b32 s54, 2949248
 v_cvt_pk_bf16_f32 v210, v48, v49
 v_mfma_f32_16x16x32_bf16 v[172:175], v[84:87], a[44:47], v[172:175]
 v_cvt_pk_bf16_f32 v211, v50, v51
 s_waitcnt lgkmcnt(4)
 v_mfma_f32_16x16x32_bf16 v[176:179], v[88:91], a[32:35], v[176:179]
 ds_read_b64_tr_b16 v[84:85], v14 offset:33792
 v_mfma_f32_16x16x32_bf16 v[180:183], v[88:91], a[36:39], v[180:183]
 ds_read_b64_tr_b16 v[86:87], v14 offset:34304
 v_mfma_f32_16x16x32_bf16 v[184:187], v[88:91], a[40:43], v[184:187]
 buffer_load_dwordx4 v4, s[16:19], s54 offen lds
 ds_write_b128 v99, v[208:211] offset:0
 v_mfma_f32_16x16x32_bf16 v[188:191], v[88:91], a[44:47], v[188:191]
 v_max_f32 v20, 0, v20
 s_waitcnt lgkmcnt(5)
 v_mfma_f32_16x16x32_bf16 v[192:195], v[92:95], a[32:35], v[192:195]
 v_add_u32 v15, 0xffff0000, v15
 ds_read_b64_tr_b16 v[88:89], v15 offset:32768
 v_mfma_f32_16x16x32_bf16 v[196:199], v[92:95], a[36:39], v[196:199]
 ds_read_b64_tr_b16 v[90:91], v15 offset:33280
 v_mfma_f32_16x16x32_bf16 v[200:203], v[92:95], a[40:43], v[200:203]
 buffer_load_dwordx4 v4, s[20:23], s54 offen offset:1024 lds
 v_max_f32 v21, 0, v21
 v_mfma_f32_16x16x32_bf16 v[204:207], v[92:95], a[44:47], v[204:207]
 v_max_f32 v22, 0, v22
 s_waitcnt lgkmcnt(5)
 v_mfma_f32_16x16x32_bf16 v[144:147], v[80:83], a[48:51], v[144:147]
 ds_read_b64_tr_b16 v[92:93], v15 offset:33792
 v_mfma_f32_16x16x32_bf16 v[148:151], v[80:83], a[52:55], v[148:151]
 ds_read_b64_tr_b16 v[94:95], v15 offset:34304
 v_mfma_f32_16x16x32_bf16 v[152:155], v[80:83], a[56:59], v[152:155]
 s_add_u32 m0, s53, 131072
 v_max_f32 v23, 0, v23
 v_mfma_f32_16x16x32_bf16 v[156:159], v[80:83], a[60:63], v[156:159]
 s_waitcnt lgkmcnt(5)
 v_mfma_f32_16x16x32_bf16 v[160:163], v[84:87], a[48:51], v[160:163]
 ds_read_b64_tr_b16 v[80:81], v14 offset:40960
 v_mfma_f32_16x16x32_bf16 v[164:167], v[84:87], a[52:55], v[164:167]
 ds_read_b64_tr_b16 v[82:83], v14 offset:41472
 v_mfma_f32_16x16x32_bf16 v[168:171], v[84:87], a[56:59], v[168:171]
 s_mov_b32 s54, 3244160
 v_mul_f32 v20, v20, v36
 v_mfma_f32_16x16x32_bf16 v[172:175], v[84:87], a[60:63], v[172:175]
 s_waitcnt lgkmcnt(4)
 v_mfma_f32_16x16x32_bf16 v[176:179], v[88:91], a[48:51], v[176:179]
 ds_read_b64_tr_b16 v[84:85], v14 offset:41984
 v_mfma_f32_16x16x32_bf16 v[180:183], v[88:91], a[52:55], v[180:183]
 ds_read_b64_tr_b16 v[86:87], v14 offset:42496
 v_mfma_f32_16x16x32_bf16 v[184:187], v[88:91], a[56:59], v[184:187]
 buffer_load_dwordx4 v4, s[16:19], s54 offen lds
 v_mul_f32 v21, v21, v37
 v_mfma_f32_16x16x32_bf16 v[188:191], v[88:91], a[60:63], v[188:191]
 s_waitcnt lgkmcnt(4)
 v_mfma_f32_16x16x32_bf16 v[192:195], v[92:95], a[48:51], v[192:195]
 ds_read_b64_tr_b16 v[88:89], v15 offset:40960
 v_mfma_f32_16x16x32_bf16 v[196:199], v[92:95], a[52:55], v[196:199]
 ds_read_b64_tr_b16 v[90:91], v15 offset:41472
 v_mfma_f32_16x16x32_bf16 v[200:203], v[92:95], a[56:59], v[200:203]
 buffer_load_dwordx4 v4, s[20:23], s54 offen offset:1024 lds
 v_mul_f32 v22, v22, v38
 v_mfma_f32_16x16x32_bf16 v[204:207], v[92:95], a[60:63], v[204:207]
 s_waitcnt lgkmcnt(4)
 v_mfma_f32_16x16x32_bf16 v[144:147], v[80:83], a[64:67], v[144:147]
 ds_read_b64_tr_b16 v[92:93], v15 offset:41984
 v_mfma_f32_16x16x32_bf16 v[148:151], v[80:83], a[68:71], v[148:151]
 ds_read_b64_tr_b16 v[94:95], v15 offset:42496
 v_mfma_f32_16x16x32_bf16 v[152:155], v[80:83], a[72:75], v[152:155]
 s_add_u32 m0, s53, 147456
 v_mul_f32 v23, v23, v39
 v_mfma_f32_16x16x32_bf16 v[156:159], v[80:83], a[76:79], v[156:159]
 s_waitcnt lgkmcnt(4)
 v_mfma_f32_16x16x32_bf16 v[160:163], v[84:87], a[64:67], v[160:163]
 v_add_u32 v14, 0x10000, v14
 ds_read_b64_tr_b16 v[80:81], v14 offset:49152
 v_mfma_f32_16x16x32_bf16 v[164:167], v[84:87], a[68:71], v[164:167]
 ds_read_b64_tr_b16 v[82:83], v14 offset:49664
 v_mfma_f32_16x16x32_bf16 v[168:171], v[84:87], a[72:75], v[168:171]
 s_mov_b32 s54, 3539072
 v_cvt_pk_bf16_f32 v212, v20, v21
 v_mfma_f32_16x16x32_bf16 v[172:175], v[84:87], a[76:79], v[172:175]
 s_waitcnt lgkmcnt(4)
 v_mfma_f32_16x16x32_bf16 v[176:179], v[88:91], a[64:67], v[176:179]
 ds_read_b64_tr_b16 v[84:85], v14 offset:50176
 v_mfma_f32_16x16x32_bf16 v[180:183], v[88:91], a[68:71], v[180:183]
 ds_read_b64_tr_b16 v[86:87], v14 offset:50688
 v_mfma_f32_16x16x32_bf16 v[184:187], v[88:91], a[72:75], v[184:187]
 buffer_load_dwordx4 v4, s[16:19], s54 offen lds
 v_cvt_pk_bf16_f32 v213, v22, v23
 v_mfma_f32_16x16x32_bf16 v[188:191], v[88:91], a[76:79], v[188:191]
 s_waitcnt lgkmcnt(4)
 v_mfma_f32_16x16x32_bf16 v[192:195], v[92:95], a[64:67], v[192:195]
 v_add_u32 v15, 0x10000, v15
 ds_read_b64_tr_b16 v[88:89], v15 offset:49152
 v_mfma_f32_16x16x32_bf16 v[196:199], v[92:95], a[68:71], v[196:199]
 ds_read_b64_tr_b16 v[90:91], v15 offset:49664
 v_mfma_f32_16x16x32_bf16 v[200:203], v[92:95], a[72:75], v[200:203]
 buffer_load_dwordx4 v4, s[20:23], s54 offen offset:1024 lds
 v_max_f32 v52, 0, v52
 v_mfma_f32_16x16x32_bf16 v[204:207], v[92:95], a[76:79], v[204:207]
 s_waitcnt lgkmcnt(4)
 v_mfma_f32_16x16x32_bf16 v[144:147], v[80:83], a[80:83], v[144:147]
 ds_read_b64_tr_b16 v[92:93], v15 offset:50176
 v_mfma_f32_16x16x32_bf16 v[148:151], v[80:83], a[84:87], v[148:151]
 ds_read_b64_tr_b16 v[94:95], v15 offset:50688
 v_mfma_f32_16x16x32_bf16 v[152:155], v[80:83], a[88:91], v[152:155]
 s_add_u32 m0, s53, 16384
 v_max_f32 v53, 0, v53
 v_mfma_f32_16x16x32_bf16 v[156:159], v[80:83], a[92:95], v[156:159]
 s_waitcnt vmcnt(9)
 s_barrier
 s_waitcnt lgkmcnt(4)
 v_mfma_f32_16x16x32_bf16 v[160:163], v[84:87], a[80:83], v[160:163]
 v_add_u32 v14, 0x10000, v14
 ds_read_b64_tr_b16 v[80:81], v14 offset:24576
 v_mfma_f32_16x16x32_bf16 v[164:167], v[84:87], a[84:87], v[164:167]
 ds_read_b64_tr_b16 v[82:83], v14 offset:25088
 v_mfma_f32_16x16x32_bf16 v[168:171], v[84:87], a[88:91], v[168:171]
 s_mov_b32 s54, 3833984
 v_max_f32 v54, 0, v54
 v_mfma_f32_16x16x32_bf16 v[172:175], v[84:87], a[92:95], v[172:175]
 s_waitcnt lgkmcnt(4)
 v_mfma_f32_16x16x32_bf16 v[176:179], v[88:91], a[80:83], v[176:179]
 ds_read_b64_tr_b16 v[84:85], v14 offset:25600
 v_mfma_f32_16x16x32_bf16 v[180:183], v[88:91], a[84:87], v[180:183]
 ds_read_b64_tr_b16 v[86:87], v14 offset:26112
 v_mfma_f32_16x16x32_bf16 v[184:187], v[88:91], a[88:91], v[184:187]
 buffer_load_dwordx4 v4, s[16:19], s54 offen lds
 v_max_f32 v55, 0, v55
 v_mfma_f32_16x16x32_bf16 v[188:191], v[88:91], a[92:95], v[188:191]
 s_waitcnt lgkmcnt(4)
 v_mfma_f32_16x16x32_bf16 v[192:195], v[92:95], a[80:83], v[192:195]
 v_add_u32 v15, 0x10000, v15
 ds_read_b64_tr_b16 v[88:89], v15 offset:24576
 v_mfma_f32_16x16x32_bf16 v[196:199], v[92:95], a[84:87], v[196:199]
 ds_read_b64_tr_b16 v[90:91], v15 offset:25088
 v_mfma_f32_16x16x32_bf16 v[200:203], v[92:95], a[88:91], v[200:203]
 buffer_load_dwordx4 v4, s[20:23], s54 offen offset:1024 lds
 v_mul_f32 v52, v52, v68
 v_mfma_f32_16x16x32_bf16 v[204:207], v[92:95], a[92:95], v[204:207]
 s_waitcnt lgkmcnt(4)
 v_mfma_f32_16x16x32_bf16 v[144:147], v[80:83], a[96:99], v[144:147]
 ds_read_b64_tr_b16 v[92:93], v15 offset:25600
 v_mfma_f32_16x16x32_bf16 v[148:151], v[80:83], a[100:103], v[148:151]
 ds_read_b64_tr_b16 v[94:95], v15 offset:26112
 v_mfma_f32_16x16x32_bf16 v[152:155], v[80:83], a[104:107], v[152:155]
 s_add_u32 m0, s53, 106496
 v_mul_f32 v53, v53, v69
 v_mfma_f32_16x16x32_bf16 v[156:159], v[80:83], a[108:111], v[156:159]
 s_waitcnt lgkmcnt(4)
 v_mfma_f32_16x16x32_bf16 v[160:163], v[84:87], a[96:99], v[160:163]
 v_add_u32 v14, 0xfffe0000, v14
 ds_read_b64_tr_b16 v[80:81], v14 offset:0
 v_mfma_f32_16x16x32_bf16 v[164:167], v[84:87], a[100:103], v[164:167]
 ds_read_b64_tr_b16 v[82:83], v14 offset:512
 v_mfma_f32_16x16x32_bf16 v[168:171], v[84:87], a[104:107], v[168:171]
 s_mov_b32 s54, 4128896
 v_mul_f32 v54, v54, v70
 v_mfma_f32_16x16x32_bf16 v[172:175], v[84:87], a[108:111], v[172:175]
 s_waitcnt lgkmcnt(4)
 v_mfma_f32_16x16x32_bf16 v[176:179], v[88:91], a[96:99], v[176:179]
 ds_read_b64_tr_b16 v[84:85], v14 offset:1024
 v_mfma_f32_16x16x32_bf16 v[180:183], v[88:91], a[100:103], v[180:183]
 ds_read_b64_tr_b16 v[86:87], v14 offset:1536
 v_mfma_f32_16x16x32_bf16 v[184:187], v[88:91], a[104:107], v[184:187]
 buffer_load_dwordx4 v4, s[16:19], s54 offen lds
 v_mul_f32 v55, v55, v71
 v_mfma_f32_16x16x32_bf16 v[188:191], v[88:91], a[108:111], v[188:191]
 s_waitcnt lgkmcnt(4)
 v_mfma_f32_16x16x32_bf16 v[192:195], v[92:95], a[96:99], v[192:195]
 v_add_u32 v15, 0xfffe0000, v15
 ds_read_b64_tr_b16 v[88:89], v15 offset:0
 v_mfma_f32_16x16x32_bf16 v[196:199], v[92:95], a[100:103], v[196:199]
 ds_read_b64_tr_b16 v[90:91], v15 offset:512
 v_mfma_f32_16x16x32_bf16 v[200:203], v[92:95], a[104:107], v[200:203]
 buffer_load_dwordx4 v4, s[20:23], s54 offen offset:1024 lds
 v_cvt_pk_bf16_f32 v214, v52, v53
 v_mfma_f32_16x16x32_bf16 v[204:207], v[92:95], a[108:111], v[204:207]
 s_waitcnt lgkmcnt(4)
 v_mfma_f32_16x16x32_bf16 v[144:147], v[80:83], a[112:115], v[144:147]
 ds_read_b64_tr_b16 v[92:93], v15 offset:1024
 v_mfma_f32_16x16x32_bf16 v[148:151], v[80:83], a[116:119], v[148:151]
 ds_read_b64_tr_b16 v[94:95], v15 offset:1536
 v_mfma_f32_16x16x32_bf16 v[152:155], v[80:83], a[120:123], v[152:155]
 s_add_u32 m0, s53, 24576
 v_cvt_pk_bf16_f32 v215, v54, v55
 v_mfma_f32_16x16x32_bf16 v[156:159], v[80:83], a[124:127], v[156:159]
 s_waitcnt lgkmcnt(4)
 v_mfma_f32_16x16x32_bf16 v[160:163], v[84:87], a[112:115], v[160:163]
 v_add_u32 v14, 0x10000, v14
 ds_read_b64_tr_b16 v[80:81], v14 offset:57344
 v_mfma_f32_16x16x32_bf16 v[164:167], v[84:87], a[116:119], v[164:167]
 ds_read_b64_tr_b16 v[82:83], v14 offset:57856
 v_mfma_f32_16x16x32_bf16 v[168:171], v[84:87], a[120:123], v[168:171]
 s_mov_b32 s54, 4423808
 ds_write_b128 v99, v[212:215] offset:1024
 v_mfma_f32_16x16x32_bf16 v[172:175], v[84:87], a[124:127], v[172:175]
 s_waitcnt lgkmcnt(5)
 v_mfma_f32_16x16x32_bf16 v[176:179], v[88:91], a[112:115], v[176:179]
 ds_read_b64_tr_b16 v[84:85], v14 offset:58368
 v_mfma_f32_16x16x32_bf16 v[180:183], v[88:91], a[116:119], v[180:183]
 ds_read_b64_tr_b16 v[86:87], v14 offset:58880
 v_mfma_f32_16x16x32_bf16 v[184:187], v[88:91], a[120:123], v[184:187]
 buffer_load_dwordx4 v4, s[16:19], s54 offen lds
 v_max_f32 v24, 0, v24
 v_mfma_f32_16x16x32_bf16 v[188:191], v[88:91], a[124:127], v[188:191]
 s_waitcnt lgkmcnt(5)
 v_mfma_f32_16x16x32_bf16 v[192:195], v[92:95], a[112:115], v[192:195]
 v_add_u32 v15, 0x10000, v15
 ds_read_b64_tr_b16 v[88:89], v15 offset:57344
 v_mfma_f32_16x16x32_bf16 v[196:199], v[92:95], a[116:119], v[196:199]
 ds_read_b64_tr_b16 v[90:91], v15 offset:57856
 v_mfma_f32_16x16x32_bf16 v[200:203], v[92:95], a[120:123], v[200:203]
 buffer_load_dwordx4 v4, s[20:23], s54 offen offset:1024 lds
 v_max_f32 v25, 0, v25
 v_mfma_f32_16x16x32_bf16 v[204:207], v[92:95], a[124:127], v[204:207]
 s_waitcnt lgkmcnt(5)
 v_mfma_f32_16x16x32_bf16 v[144:147], v[80:83], a[128:131], v[144:147]
 ds_read_b64_tr_b16 v[92:93], v15 offset:58368
 v_mfma_f32_16x16x32_bf16 v[148:151], v[80:83], a[132:135], v[148:151]
 ds_read_b64_tr_b16 v[94:95], v15 offset:58880
 v_mfma_f32_16x16x32_bf16 v[152:155], v[80:83], a[136:139], v[152:155]
 s_add_u32 m0, s53, 32768
 v_max_f32 v26, 0, v26
 v_mfma_f32_16x16x32_bf16 v[156:159], v[80:83], a[140:143], v[156:159]
 s_waitcnt vmcnt(8)
 s_barrier
 s_waitcnt lgkmcnt(4)
 v_mfma_f32_16x16x32_bf16 v[160:163], v[84:87], a[128:131], v[160:163]
 v_add_u32 v14, 0x10000, v14
 ds_read_b64_tr_b16 v[80:81], v14 offset:8192
 v_mfma_f32_16x16x32_bf16 v[164:167], v[84:87], a[132:135], v[164:167]
 ds_read_b64_tr_b16 v[82:83], v14 offset:8704
 v_mfma_f32_16x16x32_bf16 v[168:171], v[84:87], a[136:139], v[168:171]
 s_mov_b32 s54, 4718720
 v_max_f32 v27, 0, v27
 v_mfma_f32_16x16x32_bf16 v[172:175], v[84:87], a[140:143], v[172:175]
 s_waitcnt lgkmcnt(4)
 v_mfma_f32_16x16x32_bf16 v[176:179], v[88:91], a[128:131], v[176:179]
 ds_read_b64_tr_b16 v[84:85], v14 offset:9216
 v_mfma_f32_16x16x32_bf16 v[180:183], v[88:91], a[132:135], v[180:183]
 ds_read_b64_tr_b16 v[86:87], v14 offset:9728
 v_mfma_f32_16x16x32_bf16 v[184:187], v[88:91], a[136:139], v[184:187]
 buffer_load_dwordx4 v4, s[16:19], s54 offen lds
 v_mul_f32 v24, v24, v40
 v_mfma_f32_16x16x32_bf16 v[188:191], v[88:91], a[140:143], v[188:191]
 s_waitcnt lgkmcnt(4)
 v_mfma_f32_16x16x32_bf16 v[192:195], v[92:95], a[128:131], v[192:195]
 v_add_u32 v15, 0x10000, v15
 ds_read_b64_tr_b16 v[88:89], v15 offset:8192
 v_mfma_f32_16x16x32_bf16 v[196:199], v[92:95], a[132:135], v[196:199]
 ds_read_b64_tr_b16 v[90:91], v15 offset:8704
 v_mfma_f32_16x16x32_bf16 v[200:203], v[92:95], a[136:139], v[200:203]
 buffer_load_dwordx4 v4, s[20:23], s54 offen offset:1024 lds
 v_mul_f32 v25, v25, v41
 v_mfma_f32_16x16x32_bf16 v[204:207], v[92:95], a[140:143], v[204:207]
 s_waitcnt lgkmcnt(4)
 v_mfma_f32_16x16x32_bf16 v[144:147], v[80:83], a[144:147], v[144:147]
 ds_read_b64_tr_b16 v[92:93], v15 offset:9216
 v_mfma_f32_16x16x32_bf16 v[148:151], v[80:83], a[148:151], v[148:151]
 ds_read_b64_tr_b16 v[94:95], v15 offset:9728
 v_mfma_f32_16x16x32_bf16 v[152:155], v[80:83], a[152:155], v[152:155]
 s_add_u32 m0, s53, 155648
 v_mul_f32 v26, v26, v42
 v_mfma_f32_16x16x32_bf16 v[156:159], v[80:83], a[156:159], v[156:159]
 s_waitcnt lgkmcnt(4)
 v_mfma_f32_16x16x32_bf16 v[160:163], v[84:87], a[144:147], v[160:163]
 v_add_u32 v14, 0xfffe0000, v14
 ds_read_b64_tr_b16 v[80:81], v14 offset:8192
 v_mfma_f32_16x16x32_bf16 v[164:167], v[84:87], a[148:151], v[164:167]
 ds_read_b64_tr_b16 v[82:83], v14 offset:8704
 v_mfma_f32_16x16x32_bf16 v[168:171], v[84:87], a[152:155], v[168:171]
 s_mov_b32 s54, 5013632
 v_mul_f32 v27, v27, v43
 v_mfma_f32_16x16x32_bf16 v[172:175], v[84:87], a[156:159], v[172:175]
 s_waitcnt lgkmcnt(4)
 v_mfma_f32_16x16x32_bf16 v[176:179], v[88:91], a[144:147], v[176:179]
 ds_read_b64_tr_b16 v[84:85], v14 offset:9216
 v_mfma_f32_16x16x32_bf16 v[180:183], v[88:91], a[148:151], v[180:183]
 ds_read_b64_tr_b16 v[86:87], v14 offset:9728
 v_mfma_f32_16x16x32_bf16 v[184:187], v[88:91], a[152:155], v[184:187]
 buffer_load_dwordx4 v4, s[16:19], s54 offen lds
 v_cvt_pk_bf16_f32 v208, v24, v25
 v_mfma_f32_16x16x32_bf16 v[188:191], v[88:91], a[156:159], v[188:191]
 s_waitcnt lgkmcnt(4)
 v_mfma_f32_16x16x32_bf16 v[192:195], v[92:95], a[144:147], v[192:195]
 v_add_u32 v15, 0xfffe0000, v15
 ds_read_b64_tr_b16 v[88:89], v15 offset:8192
 v_mfma_f32_16x16x32_bf16 v[196:199], v[92:95], a[148:151], v[196:199]
 ds_read_b64_tr_b16 v[90:91], v15 offset:8704
 v_mfma_f32_16x16x32_bf16 v[200:203], v[92:95], a[152:155], v[200:203]
 buffer_load_dwordx4 v4, s[20:23], s54 offen offset:1024 lds
 v_cvt_pk_bf16_f32 v209, v26, v27
 v_mfma_f32_16x16x32_bf16 v[204:207], v[92:95], a[156:159], v[204:207]
 s_waitcnt lgkmcnt(4)
 v_mfma_f32_16x16x32_bf16 v[144:147], v[80:83], a[160:163], v[144:147]
 ds_read_b64_tr_b16 v[92:93], v15 offset:9216
 v_mfma_f32_16x16x32_bf16 v[148:151], v[80:83], a[164:167], v[148:151]
 ds_read_b64_tr_b16 v[94:95], v15 offset:9728
 v_mfma_f32_16x16x32_bf16 v[152:155], v[80:83], a[168:171], v[152:155]
 s_add_u32 m0, s53, 0
 v_max_f32 v56, 0, v56
 v_mfma_f32_16x16x32_bf16 v[156:159], v[80:83], a[172:175], v[156:159]
 s_waitcnt lgkmcnt(4)
 v_mfma_f32_16x16x32_bf16 v[160:163], v[84:87], a[160:163], v[160:163]
 v_add_u32 v14, 0x20000, v14
 ds_read_b64_tr_b16 v[80:81], v14 offset:0
 v_mfma_f32_16x16x32_bf16 v[164:167], v[84:87], a[164:167], v[164:167]
 ds_read_b64_tr_b16 v[82:83], v14 offset:512
 v_mfma_f32_16x16x32_bf16 v[168:171], v[84:87], a[168:171], v[168:171]
 s_mov_b32 s54, 256
 v_max_f32 v57, 0, v57
 v_mfma_f32_16x16x32_bf16 v[172:175], v[84:87], a[172:175], v[172:175]
 s_waitcnt lgkmcnt(4)
 v_mfma_f32_16x16x32_bf16 v[176:179], v[88:91], a[160:163], v[176:179]
 ds_read_b64_tr_b16 v[84:85], v14 offset:1024
 v_mfma_f32_16x16x32_bf16 v[180:183], v[88:91], a[164:167], v[180:183]
 ds_read_b64_tr_b16 v[86:87], v14 offset:1536
 v_mfma_f32_16x16x32_bf16 v[184:187], v[88:91], a[168:171], v[184:187]
 buffer_load_dwordx4 v4, s[16:19], s54 offen lds
 v_max_f32 v58, 0, v58
 v_mfma_f32_16x16x32_bf16 v[188:191], v[88:91], a[172:175], v[188:191]
 s_waitcnt lgkmcnt(4)
 v_mfma_f32_16x16x32_bf16 v[192:195], v[92:95], a[160:163], v[192:195]
 v_add_u32 v15, 0x20000, v15
 ds_read_b64_tr_b16 v[88:89], v15 offset:0
 v_mfma_f32_16x16x32_bf16 v[196:199], v[92:95], a[164:167], v[196:199]
 ds_read_b64_tr_b16 v[90:91], v15 offset:512
 v_mfma_f32_16x16x32_bf16 v[200:203], v[92:95], a[168:171], v[200:203]
 buffer_load_dwordx4 v4, s[20:23], s54 offen offset:1024 lds
 v_max_f32 v59, 0, v59
 v_mfma_f32_16x16x32_bf16 v[204:207], v[92:95], a[172:175], v[204:207]
 s_waitcnt lgkmcnt(4)
 v_mfma_f32_16x16x32_bf16 v[144:147], v[80:83], a[176:179], v[144:147]
 ds_read_b64_tr_b16 v[92:93], v15 offset:1024
 v_mfma_f32_16x16x32_bf16 v[148:151], v[80:83], a[180:183], v[148:151]
 ds_read_b64_tr_b16 v[94:95], v15 offset:1536
 v_mfma_f32_16x16x32_bf16 v[152:155], v[80:83], a[184:187], v[152:155]
 s_add_u32 m0, s53, 40960
 v_mul_f32 v56, v56, v72
 v_mfma_f32_16x16x32_bf16 v[156:159], v[80:83], a[188:191], v[156:159]
 s_waitcnt vmcnt(8)
 s_barrier
 s_waitcnt lgkmcnt(4)
 v_mfma_f32_16x16x32_bf16 v[160:163], v[84:87], a[176:179], v[160:163]
 ds_read_b64_tr_b16 v[80:81], v14 offset:16384
 v_mfma_f32_16x16x32_bf16 v[164:167], v[84:87], a[180:183], v[164:167]
 ds_read_b64_tr_b16 v[82:83], v14 offset:16896
 v_mfma_f32_16x16x32_bf16 v[168:171], v[84:87], a[184:187], v[168:171]
 s_mov_b32 s54, 295168
 v_mul_f32 v57, v57, v73
 v_mfma_f32_16x16x32_bf16 v[172:175], v[84:87], a[188:191], v[172:175]
 s_waitcnt lgkmcnt(4)
 v_mfma_f32_16x16x32_bf16 v[176:179], v[88:91], a[176:179], v[176:179]
 ds_read_b64_tr_b16 v[84:85], v14 offset:17408
 v_mfma_f32_16x16x32_bf16 v[180:183], v[88:91], a[180:183], v[180:183]
 ds_read_b64_tr_b16 v[86:87], v14 offset:17920
 v_mfma_f32_16x16x32_bf16 v[184:187], v[88:91], a[184:187], v[184:187]
 buffer_load_dwordx4 v4, s[16:19], s54 offen lds
 v_mul_f32 v58, v58, v74
 v_mfma_f32_16x16x32_bf16 v[188:191], v[88:91], a[188:191], v[188:191]
 s_waitcnt lgkmcnt(4)
 v_mfma_f32_16x16x32_bf16 v[192:195], v[92:95], a[176:179], v[192:195]
 ds_read_b64_tr_b16 v[88:89], v15 offset:16384
 v_mfma_f32_16x16x32_bf16 v[196:199], v[92:95], a[180:183], v[196:199]
 ds_read_b64_tr_b16 v[90:91], v15 offset:16896
 v_mfma_f32_16x16x32_bf16 v[200:203], v[92:95], a[184:187], v[200:203]
 buffer_load_dwordx4 v4, s[20:23], s54 offen offset:1024 lds
 v_mul_f32 v59, v59, v75
 v_mfma_f32_16x16x32_bf16 v[204:207], v[92:95], a[188:191], v[204:207]
 s_waitcnt lgkmcnt(4)
 v_mfma_f32_16x16x32_bf16 v[144:147], v[80:83], a[192:195], v[144:147]
 ds_read_b64_tr_b16 v[92:93], v15 offset:17408
 v_mfma_f32_16x16x32_bf16 v[148:151], v[80:83], a[196:199], v[148:151]
 ds_read_b64_tr_b16 v[94:95], v15 offset:17920
 v_mfma_f32_16x16x32_bf16 v[152:155], v[80:83], a[200:203], v[152:155]
 s_add_u32 m0, s53, 122880
 v_cvt_pk_bf16_f32 v210, v56, v57
 v_mfma_f32_16x16x32_bf16 v[156:159], v[80:83], a[204:207], v[156:159]
 s_waitcnt lgkmcnt(4)
 v_mfma_f32_16x16x32_bf16 v[160:163], v[84:87], a[192:195], v[160:163]
 v_add_u32 v14, 0xfffe0000, v14
 ds_read_b64_tr_b16 v[80:81], v14 offset:16384
 v_mfma_f32_16x16x32_bf16 v[164:167], v[84:87], a[196:199], v[164:167]
 ds_read_b64_tr_b16 v[82:83], v14 offset:16896
 v_mfma_f32_16x16x32_bf16 v[168:171], v[84:87], a[200:203], v[168:171]
 s_mov_b32 s54, 590080
 v_cvt_pk_bf16_f32 v211, v58, v59
 v_mfma_f32_16x16x32_bf16 v[172:175], v[84:87], a[204:207], v[172:175]
 s_waitcnt lgkmcnt(4)
 v_mfma_f32_16x16x32_bf16 v[176:179], v[88:91], a[192:195], v[176:179]
 ds_read_b64_tr_b16 v[84:85], v14 offset:17408
 v_mfma_f32_16x16x32_bf16 v[180:183], v[88:91], a[196:199], v[180:183]
 ds_read_b64_tr_b16 v[86:87], v14 offset:17920
 v_mfma_f32_16x16x32_bf16 v[184:187], v[88:91], a[200:203], v[184:187]
 buffer_load_dwordx4 v4, s[16:19], s54 offen lds
 ds_write_b128 v99, v[208:211] offset:2048
 v_mfma_f32_16x16x32_bf16 v[188:191], v[88:91], a[204:207], v[188:191]
 s_waitcnt lgkmcnt(5)
 v_mfma_f32_16x16x32_bf16 v[192:195], v[92:95], a[192:195], v[192:195]
 v_add_u32 v15, 0xfffe0000, v15
 ds_read_b64_tr_b16 v[88:89], v15 offset:16384
 v_mfma_f32_16x16x32_bf16 v[196:199], v[92:95], a[196:199], v[196:199]
 ds_read_b64_tr_b16 v[90:91], v15 offset:16896
 v_mfma_f32_16x16x32_bf16 v[200:203], v[92:95], a[200:203], v[200:203]
 buffer_load_dwordx4 v4, s[20:23], s54 offen offset:1024 lds
 v_max_f32 v28, 0, v28
 v_mfma_f32_16x16x32_bf16 v[204:207], v[92:95], a[204:207], v[204:207]
 s_waitcnt lgkmcnt(5)
 v_mfma_f32_16x16x32_bf16 v[144:147], v[80:83], a[208:211], v[144:147]
 ds_read_b64_tr_b16 v[92:93], v15 offset:17408
 v_mfma_f32_16x16x32_bf16 v[148:151], v[80:83], a[212:215], v[148:151]
 ds_read_b64_tr_b16 v[94:95], v15 offset:17920
 v_mfma_f32_16x16x32_bf16 v[152:155], v[80:83], a[216:219], v[152:155]
 s_add_u32 m0, s53, 139264
 v_max_f32 v29, 0, v29
 v_mfma_f32_16x16x32_bf16 v[156:159], v[80:83], a[220:223], v[156:159]
 s_waitcnt lgkmcnt(5)
 v_mfma_f32_16x16x32_bf16 v[160:163], v[84:87], a[208:211], v[160:163]
 v_add_u32 v14, 0x10000, v14
 ds_read_b64_tr_b16 v[80:81], v14 offset:40960
 v_mfma_f32_16x16x32_bf16 v[164:167], v[84:87], a[212:215], v[164:167]
 ds_read_b64_tr_b16 v[82:83], v14 offset:41472
 v_mfma_f32_16x16x32_bf16 v[168:171], v[84:87], a[216:219], v[168:171]
 s_mov_b32 s54, 884992
 v_max_f32 v30, 0, v30
 v_mfma_f32_16x16x32_bf16 v[172:175], v[84:87], a[220:223], v[172:175]
 s_waitcnt lgkmcnt(4)
 v_mfma_f32_16x16x32_bf16 v[176:179], v[88:91], a[208:211], v[176:179]
 ds_read_b64_tr_b16 v[84:85], v14 offset:41984
 v_mfma_f32_16x16x32_bf16 v[180:183], v[88:91], a[212:215], v[180:183]
 ds_read_b64_tr_b16 v[86:87], v14 offset:42496
 v_mfma_f32_16x16x32_bf16 v[184:187], v[88:91], a[216:219], v[184:187]
 buffer_load_dwordx4 v4, s[16:19], s54 offen lds
 v_max_f32 v31, 0, v31
 v_mfma_f32_16x16x32_bf16 v[188:191], v[88:91], a[220:223], v[188:191]
 s_waitcnt lgkmcnt(4)
 v_mfma_f32_16x16x32_bf16 v[192:195], v[92:95], a[208:211], v[192:195]
 v_add_u32 v15, 0x10000, v15
 ds_read_b64_tr_b16 v[88:89], v15 offset:40960
 v_mfma_f32_16x16x32_bf16 v[196:199], v[92:95], a[212:215], v[196:199]
 ds_read_b64_tr_b16 v[90:91], v15 offset:41472
 v_mfma_f32_16x16x32_bf16 v[200:203], v[92:95], a[216:219], v[200:203]
 buffer_load_dwordx4 v4, s[20:23], s54 offen offset:1024 lds
 v_mul_f32 v28, v28, v44
 v_mfma_f32_16x16x32_bf16 v[204:207], v[92:95], a[220:223], v[204:207]
 s_waitcnt lgkmcnt(4)
 v_mfma_f32_16x16x32_bf16 v[144:147], v[80:83], a[224:227], v[144:147]
 ds_read_b64_tr_b16 v[92:93], v15 offset:41984
 v_mfma_f32_16x16x32_bf16 v[148:151], v[80:83], a[228:231], v[148:151]
 ds_read_b64_tr_b16 v[94:95], v15 offset:42496
 v_mfma_f32_16x16x32_bf16 v[152:155], v[80:83], a[232:235], v[152:155]
 s_add_u32 m0, s53, 8192
 v_mul_f32 v29, v29, v45
 v_mfma_f32_16x16x32_bf16 v[156:159], v[80:83], a[236:239], v[156:159]
 s_waitcnt vmcnt(8)
 s_barrier
 s_waitcnt lgkmcnt(4)
 v_mfma_f32_16x16x32_bf16 v[160:163], v[84:87], a[224:227], v[160:163]
 v_add_u32 v14, 0xffff0000, v14
 ds_read_b64_tr_b16 v[80:81], v14 offset:24576
 v_mfma_f32_16x16x32_bf16 v[164:167], v[84:87], a[228:231], v[164:167]
 ds_read_b64_tr_b16 v[82:83], v14 offset:25088
 v_mfma_f32_16x16x32_bf16 v[168:171], v[84:87], a[232:235], v[168:171]
 s_mov_b32 s54, 1179904
 v_mul_f32 v30, v30, v46
 v_mfma_f32_16x16x32_bf16 v[172:175], v[84:87], a[236:239], v[172:175]
 s_waitcnt lgkmcnt(4)
 v_mfma_f32_16x16x32_bf16 v[176:179], v[88:91], a[224:227], v[176:179]
 ds_read_b64_tr_b16 v[84:85], v14 offset:25600
 v_mfma_f32_16x16x32_bf16 v[180:183], v[88:91], a[228:231], v[180:183]
 ds_read_b64_tr_b16 v[86:87], v14 offset:26112
 v_mfma_f32_16x16x32_bf16 v[184:187], v[88:91], a[232:235], v[184:187]
 buffer_load_dwordx4 v4, s[16:19], s54 offen lds
 v_mul_f32 v31, v31, v47
 v_mfma_f32_16x16x32_bf16 v[188:191], v[88:91], a[236:239], v[188:191]
 s_waitcnt lgkmcnt(4)
 v_mfma_f32_16x16x32_bf16 v[192:195], v[92:95], a[224:227], v[192:195]
 v_add_u32 v15, 0xffff0000, v15
 ds_read_b64_tr_b16 v[88:89], v15 offset:24576
 v_mfma_f32_16x16x32_bf16 v[196:199], v[92:95], a[228:231], v[196:199]
 ds_read_b64_tr_b16 v[90:91], v15 offset:25088
 v_mfma_f32_16x16x32_bf16 v[200:203], v[92:95], a[232:235], v[200:203]
 buffer_load_dwordx4 v4, s[20:23], s54 offen offset:1024 lds
 v_cvt_pk_bf16_f32 v212, v28, v29
 v_mfma_f32_16x16x32_bf16 v[204:207], v[92:95], a[236:239], v[204:207]
 s_waitcnt lgkmcnt(4)
 v_mfma_f32_16x16x32_bf16 v[144:147], v[80:83], a[240:243], v[144:147]
 ds_read_b64_tr_b16 v[92:93], v15 offset:25600
 v_mfma_f32_16x16x32_bf16 v[148:151], v[80:83], a[244:247], v[148:151]
 ds_read_b64_tr_b16 v[94:95], v15 offset:26112
 v_mfma_f32_16x16x32_bf16 v[152:155], v[80:83], a[248:251], v[152:155]
 s_add_u32 m0, s53, 131072
 v_cvt_pk_bf16_f32 v213, v30, v31
 v_mfma_f32_16x16x32_bf16 v[156:159], v[80:83], a[252:255], v[156:159]
 s_waitcnt lgkmcnt(4)
 v_mfma_f32_16x16x32_bf16 v[160:163], v[84:87], a[240:243], v[160:163]
 ds_read_b64_tr_b16 v[80:81], v14 offset:32768
 v_mfma_f32_16x16x32_bf16 v[164:167], v[84:87], a[244:247], v[164:167]
 ds_read_b64_tr_b16 v[82:83], v14 offset:33280
 v_mfma_f32_16x16x32_bf16 v[168:171], v[84:87], a[248:251], v[168:171]
 s_mov_b32 s54, 1474816
 v_max_f32 v60, 0, v60
 v_mfma_f32_16x16x32_bf16 v[172:175], v[84:87], a[252:255], v[172:175]
 s_waitcnt lgkmcnt(4)
 v_mfma_f32_16x16x32_bf16 v[176:179], v[88:91], a[240:243], v[176:179]
 ds_read_b64_tr_b16 v[84:85], v14 offset:33792
 v_mfma_f32_16x16x32_bf16 v[180:183], v[88:91], a[244:247], v[180:183]
 ds_read_b64_tr_b16 v[86:87], v14 offset:34304
 v_mfma_f32_16x16x32_bf16 v[184:187], v[88:91], a[248:251], v[184:187]
 buffer_load_dwordx4 v4, s[16:19], s54 offen lds
 v_max_f32 v61, 0, v61
 v_mfma_f32_16x16x32_bf16 v[188:191], v[88:91], a[252:255], v[188:191]
 s_waitcnt lgkmcnt(4)
 v_mfma_f32_16x16x32_bf16 v[192:195], v[92:95], a[240:243], v[192:195]
 ds_read_b64_tr_b16 v[88:89], v15 offset:32768
 v_mfma_f32_16x16x32_bf16 v[196:199], v[92:95], a[244:247], v[196:199]
 ds_read_b64_tr_b16 v[90:91], v15 offset:33280
 v_mfma_f32_16x16x32_bf16 v[200:203], v[92:95], a[248:251], v[200:203]
 buffer_load_dwordx4 v4, s[20:23], s54 offen offset:1024 lds
 v_max_f32 v62, 0, v62
 v_mfma_f32_16x16x32_bf16 v[204:207], v[92:95], a[252:255], v[204:207]
 s_waitcnt lgkmcnt(4)
 v_mfma_f32_16x16x32_bf16 v[144:147], v[80:83], v[112:115], v[144:147]
 ds_read_b64_tr_b16 v[92:93], v15 offset:33792
 v_mfma_f32_16x16x32_bf16 v[148:151], v[80:83], v[116:119], v[148:151]
 ds_read_b64_tr_b16 v[94:95], v15 offset:34304
 v_mfma_f32_16x16x32_bf16 v[152:155], v[80:83], v[120:123], v[152:155]
 s_add_u32 m0, s53, 147456
 v_max_f32 v63, 0, v63
 v_mfma_f32_16x16x32_bf16 v[156:159], v[80:83], v[124:127], v[156:159]
 s_waitcnt lgkmcnt(4)
 v_mfma_f32_16x16x32_bf16 v[160:163], v[84:87], v[112:115], v[160:163]
 v_add_u32 v14, 0x20000, v14
 ds_read_b64_tr_b16 v[80:81], v14 offset:24576
 v_mfma_f32_16x16x32_bf16 v[164:167], v[84:87], v[116:119], v[164:167]
 ds_read_b64_tr_b16 v[82:83], v14 offset:25088
 v_mfma_f32_16x16x32_bf16 v[168:171], v[84:87], v[120:123], v[168:171]
 s_mov_b32 s54, 1769728
 v_mul_f32 v60, v60, v76
 v_mfma_f32_16x16x32_bf16 v[172:175], v[84:87], v[124:127], v[172:175]
 s_waitcnt lgkmcnt(4)
 v_mfma_f32_16x16x32_bf16 v[176:179], v[88:91], v[112:115], v[176:179]
 ds_read_b64_tr_b16 v[84:85], v14 offset:25600
 v_mfma_f32_16x16x32_bf16 v[180:183], v[88:91], v[116:119], v[180:183]
 ds_read_b64_tr_b16 v[86:87], v14 offset:26112
 v_mfma_f32_16x16x32_bf16 v[184:187], v[88:91], v[120:123], v[184:187]
 buffer_load_dwordx4 v4, s[16:19], s54 offen lds
 v_mul_f32 v61, v61, v77
 v_mfma_f32_16x16x32_bf16 v[188:191], v[88:91], v[124:127], v[188:191]
 s_waitcnt lgkmcnt(4)
 v_mfma_f32_16x16x32_bf16 v[192:195], v[92:95], v[112:115], v[192:195]
 v_add_u32 v15, 0x20000, v15
 ds_read_b64_tr_b16 v[88:89], v15 offset:24576
 v_mfma_f32_16x16x32_bf16 v[196:199], v[92:95], v[116:119], v[196:199]
 ds_read_b64_tr_b16 v[90:91], v15 offset:25088
 v_mfma_f32_16x16x32_bf16 v[200:203], v[92:95], v[120:123], v[200:203]
 buffer_load_dwordx4 v4, s[20:23], s54 offen offset:1024 lds
 v_mul_f32 v62, v62, v78
 v_mfma_f32_16x16x32_bf16 v[204:207], v[92:95], v[124:127], v[204:207]
 s_waitcnt lgkmcnt(4)
 v_mfma_f32_16x16x32_bf16 v[144:147], v[80:83], v[128:131], v[144:147]
 ds_read_b64_tr_b16 v[92:93], v15 offset:25600
 v_mfma_f32_16x16x32_bf16 v[148:151], v[80:83], v[132:135], v[148:151]
 ds_read_b64_tr_b16 v[94:95], v15 offset:26112
 v_mfma_f32_16x16x32_bf16 v[152:155], v[80:83], v[136:139], v[152:155]
 s_add_u32 m0, s53, 16384
 v_mul_f32 v63, v63, v79
 v_mfma_f32_16x16x32_bf16 v[156:159], v[80:83], v[140:143], v[156:159]
 s_waitcnt vmcnt(8)
 s_barrier
 s_waitcnt lgkmcnt(4)
 v_mfma_f32_16x16x32_bf16 v[160:163], v[84:87], v[128:131], v[160:163]
 v_add_u32 v14, 0xfffe0000, v14
 ds_read_b64_tr_b16 v[80:81], v14 offset:0
 v_mfma_f32_16x16x32_bf16 v[164:167], v[84:87], v[132:135], v[164:167]
 ds_read_b64_tr_b16 v[82:83], v14 offset:512
 v_mfma_f32_16x16x32_bf16 v[168:171], v[84:87], v[136:139], v[168:171]
 s_mov_b32 s54, 2064640
 v_cvt_pk_bf16_f32 v214, v60, v61
 v_mfma_f32_16x16x32_bf16 v[172:175], v[84:87], v[140:143], v[172:175]
 s_waitcnt lgkmcnt(4)
 v_mfma_f32_16x16x32_bf16 v[176:179], v[88:91], v[128:131], v[176:179]
 ds_read_b64_tr_b16 v[84:85], v14 offset:1024
 v_mfma_f32_16x16x32_bf16 v[180:183], v[88:91], v[132:135], v[180:183]
 ds_read_b64_tr_b16 v[86:87], v14 offset:1536
 v_mfma_f32_16x16x32_bf16 v[184:187], v[88:91], v[136:139], v[184:187]
 buffer_load_dwordx4 v4, s[16:19], s54 offen lds
 v_cvt_pk_bf16_f32 v215, v62, v63
 v_mfma_f32_16x16x32_bf16 v[188:191], v[88:91], v[140:143], v[188:191]
 s_waitcnt lgkmcnt(4)
 v_mfma_f32_16x16x32_bf16 v[192:195], v[92:95], v[128:131], v[192:195]
 v_add_u32 v15, 0xfffe0000, v15
 ds_read_b64_tr_b16 v[88:89], v15 offset:0
 v_mfma_f32_16x16x32_bf16 v[196:199], v[92:95], v[132:135], v[196:199]
 ds_read_b64_tr_b16 v[90:91], v15 offset:512
 v_mfma_f32_16x16x32_bf16 v[200:203], v[92:95], v[136:139], v[200:203]
 buffer_load_dwordx4 v4, s[20:23], s54 offen offset:1024 lds
 ds_write_b128 v99, v[212:215] offset:3072
 v_mfma_f32_16x16x32_bf16 v[204:207], v[92:95], v[140:143], v[204:207]
 s_waitcnt lgkmcnt(5)
 v_mfma_f32_16x16x32_bf16 v[16:19], v[80:83], a[0:3], 0
 ds_read_b64_tr_b16 v[92:93], v15 offset:1024
 v_mfma_f32_16x16x32_bf16 v[20:23], v[80:83], a[4:7], 0
 ds_read_b64_tr_b16 v[94:95], v15 offset:1536
 v_mfma_f32_16x16x32_bf16 v[24:27], v[80:83], a[8:11], 0
 s_add_u32 m0, s53, 24576
 v_max_f32 v144, 0, v144
 v_mfma_f32_16x16x32_bf16 v[28:31], v[80:83], a[12:15], 0
 v_max_f32 v145, 0, v145
 s_waitcnt lgkmcnt(5)
 v_mfma_f32_16x16x32_bf16 v[32:35], v[84:87], a[0:3], 0
 ds_read_b64_tr_b16 v[80:81], v14 offset:40960
 v_mfma_f32_16x16x32_bf16 v[36:39], v[84:87], a[4:7], 0
 ds_read_b64_tr_b16 v[82:83], v14 offset:41472
 v_mfma_f32_16x16x32_bf16 v[40:43], v[84:87], a[8:11], 0
 s_mov_b32 s54, 2359552
 v_max_f32 v146, 0, v146
 v_mfma_f32_16x16x32_bf16 v[44:47], v[84:87], a[12:15], 0
 v_max_f32 v147, 0, v147
 s_waitcnt lgkmcnt(5)
 v_mfma_f32_16x16x32_bf16 v[48:51], v[88:91], a[0:3], 0
 ds_read_b64_tr_b16 v[84:85], v14 offset:41984
 v_mfma_f32_16x16x32_bf16 v[52:55], v[88:91], a[4:7], 0
 ds_read_b64_tr_b16 v[86:87], v14 offset:42496
 v_mfma_f32_16x16x32_bf16 v[56:59], v[88:91], a[8:11], 0
 buffer_load_dwordx4 v4, s[16:19], s54 offen lds
 v_mul_f32 v144, v144, v160
 v_mfma_f32_16x16x32_bf16 v[60:63], v[88:91], a[12:15], 0
 v_mul_f32 v145, v145, v161
 s_waitcnt lgkmcnt(4)
 v_mfma_f32_16x16x32_bf16 v[64:67], v[92:95], a[0:3], 0
 ds_read_b64_tr_b16 v[88:89], v15 offset:40960
 v_mfma_f32_16x16x32_bf16 v[68:71], v[92:95], a[4:7], 0
 ds_read_b64_tr_b16 v[90:91], v15 offset:41472
 v_mfma_f32_16x16x32_bf16 v[72:75], v[92:95], a[8:11], 0
 buffer_load_dwordx4 v4, s[20:23], s54 offen offset:1024 lds
 v_mul_f32 v146, v146, v162
 v_mfma_f32_16x16x32_bf16 v[76:79], v[92:95], a[12:15], 0
 v_mul_f32 v147, v147, v163
 s_waitcnt lgkmcnt(4)
 v_mfma_f32_16x16x32_bf16 v[16:19], v[80:83], a[16:19], v[16:19]
 ds_read_b64_tr_b16 v[92:93], v15 offset:41984
 v_mfma_f32_16x16x32_bf16 v[20:23], v[80:83], a[20:23], v[20:23]
 ds_read_b64_tr_b16 v[94:95], v15 offset:42496
 v_mfma_f32_16x16x32_bf16 v[24:27], v[80:83], a[24:27], v[24:27]
 s_add_u32 m0, s53, 32768
 v_cvt_pk_bf16_f32 v208, v144, v145
 v_mfma_f32_16x16x32_bf16 v[28:31], v[80:83], a[28:31], v[28:31]
 v_cvt_pk_bf16_f32 v209, v146, v147
 s_waitcnt lgkmcnt(4)
 v_mfma_f32_16x16x32_bf16 v[32:35], v[84:87], a[16:19], v[32:35]
 v_add_u32 v14, 0x10000, v14
 ds_read_b64_tr_b16 v[80:81], v14 offset:57344
 v_mfma_f32_16x16x32_bf16 v[36:39], v[84:87], a[20:23], v[36:39]
 ds_read_b64_tr_b16 v[82:83], v14 offset:57856
 v_mfma_f32_16x16x32_bf16 v[40:43], v[84:87], a[24:27], v[40:43]
 s_mov_b32 s54, 2654464
 v_max_f32 v176, 0, v176
 v_mfma_f32_16x16x32_bf16 v[44:47], v[84:87], a[28:31], v[44:47]
 v_max_f32 v177, 0, v177
 s_waitcnt lgkmcnt(4)
 v_mfma_f32_16x16x32_bf16 v[48:51], v[88:91], a[16:19], v[48:51]
 ds_read_b64_tr_b16 v[84:85], v14 offset:58368
 v_mfma_f32_16x16x32_bf16 v[52:55], v[88:91], a[20:23], v[52:55]
 ds_read_b64_tr_b16 v[86:87], v14 offset:58880
 v_mfma_f32_16x16x32_bf16 v[56:59], v[88:91], a[24:27], v[56:59]
 buffer_load_dwordx4 v4, s[16:19], s54 offen lds
 v_max_f32 v178, 0, v178
 v_mfma_f32_16x16x32_bf16 v[60:63], v[88:91], a[28:31], v[60:63]
 v_max_f32 v179, 0, v179
 s_waitcnt lgkmcnt(4)
 v_mfma_f32_16x16x32_bf16 v[64:67], v[92:95], a[16:19], v[64:67]
 v_add_u32 v15, 0x10000, v15
 ds_read_b64_tr_b16 v[88:89], v15 offset:57344
 v_mfma_f32_16x16x32_bf16 v[68:71], v[92:95], a[20:23], v[68:71]
 ds_read_b64_tr_b16 v[90:91], v15 offset:57856
 v_mfma_f32_16x16x32_bf16 v[72:75], v[92:95], a[24:27], v[72:75]
 buffer_load_dwordx4 v4, s[20:23], s54 offen offset:1024 lds
 v_mul_f32 v176, v176, v192
 v_mfma_f32_16x16x32_bf16 v[76:79], v[92:95], a[28:31], v[76:79]
 v_mul_f32 v177, v177, v193
 s_waitcnt lgkmcnt(4)
 v_mfma_f32_16x16x32_bf16 v[16:19], v[80:83], a[32:35], v[16:19]
 ds_read_b64_tr_b16 v[92:93], v15 offset:58368
 v_mfma_f32_16x16x32_bf16 v[20:23], v[80:83], a[36:39], v[20:23]
 ds_read_b64_tr_b16 v[94:95], v15 offset:58880
 v_mfma_f32_16x16x32_bf16 v[24:27], v[80:83], a[40:43], v[24:27]
 s_add_u32 m0, s53, 49152
 v_mul_f32 v178, v178, v194
 v_mfma_f32_16x16x32_bf16 v[28:31], v[80:83], a[44:47], v[28:31]
 v_mul_f32 v179, v179, v195
 s_waitcnt vmcnt(8)
 s_barrier
 s_waitcnt lgkmcnt(4)
 v_mfma_f32_16x16x32_bf16 v[32:35], v[84:87], a[32:35], v[32:35]
 v_add_u32 v14, 0x10000, v14
 ds_read_b64_tr_b16 v[80:81], v14 offset:8192
 v_mfma_f32_16x16x32_bf16 v[36:39], v[84:87], a[36:39], v[36:39]
 ds_read_b64_tr_b16 v[82:83], v14 offset:8704
 v_mfma_f32_16x16x32_bf16 v[40:43], v[84:87], a[40:43], v[40:43]
 s_mov_b32 s54, 2949376
 v_cvt_pk_bf16_f32 v210, v176, v177
 v_mfma_f32_16x16x32_bf16 v[44:47], v[84:87], a[44:47], v[44:47]
 v_cvt_pk_bf16_f32 v211, v178, v179
 s_waitcnt lgkmcnt(4)
 v_mfma_f32_16x16x32_bf16 v[48:51], v[88:91], a[32:35], v[48:51]
 ds_read_b64_tr_b16 v[84:85], v14 offset:9216
 v_mfma_f32_16x16x32_bf16 v[52:55], v[88:91], a[36:39], v[52:55]
 ds_read_b64_tr_b16 v[86:87], v14 offset:9728
 v_mfma_f32_16x16x32_bf16 v[56:59], v[88:91], a[40:43], v[56:59]
 buffer_load_dwordx4 v4, s[16:19], s54 offen lds
 ds_write_b128 v99, v[208:211] offset:16384
 v_mfma_f32_16x16x32_bf16 v[60:63], v[88:91], a[44:47], v[60:63]
 v_max_f32 v148, 0, v148
 s_waitcnt lgkmcnt(5)
 v_mfma_f32_16x16x32_bf16 v[64:67], v[92:95], a[32:35], v[64:67]
 v_add_u32 v15, 0x10000, v15
 ds_read_b64_tr_b16 v[88:89], v15 offset:8192
 v_mfma_f32_16x16x32_bf16 v[68:71], v[92:95], a[36:39], v[68:71]
 ds_read_b64_tr_b16 v[90:91], v15 offset:8704
 v_mfma_f32_16x16x32_bf16 v[72:75], v[92:95], a[40:43], v[72:75]
 buffer_load_dwordx4 v4, s[20:23], s54 offen offset:1024 lds
 v_max_f32 v149, 0, v149
 v_mfma_f32_16x16x32_bf16 v[76:79], v[92:95], a[44:47], v[76:79]
 v_max_f32 v150, 0, v150
 s_waitcnt lgkmcnt(5)
 v_mfma_f32_16x16x32_bf16 v[16:19], v[80:83], a[48:51], v[16:19]
 ds_read_b64_tr_b16 v[92:93], v15 offset:9216
 v_mfma_f32_16x16x32_bf16 v[20:23], v[80:83], a[52:55], v[20:23]
 ds_read_b64_tr_b16 v[94:95], v15 offset:9728
 v_mfma_f32_16x16x32_bf16 v[24:27], v[80:83], a[56:59], v[24:27]
 s_add_u32 m0, s53, 155648
 v_max_f32 v151, 0, v151
 v_mfma_f32_16x16x32_bf16 v[28:31], v[80:83], a[60:63], v[28:31]
 s_waitcnt lgkmcnt(5)
 v_mfma_f32_16x16x32_bf16 v[32:35], v[84:87], a[48:51], v[32:35]
 v_add_u32 v14, 0xfffe0000, v14
 ds_read_b64_tr_b16 v[80:81], v14 offset:8192
 v_mfma_f32_16x16x32_bf16 v[36:39], v[84:87], a[52:55], v[36:39]
 ds_read_b64_tr_b16 v[82:83], v14 offset:8704
 v_mfma_f32_16x16x32_bf16 v[40:43], v[84:87], a[56:59], v[40:43]
 s_mov_b32 s54, 3244288
 v_mul_f32 v148, v148, v164
 v_mfma_f32_16x16x32_bf16 v[44:47], v[84:87], a[60:63], v[44:47]
 s_waitcnt lgkmcnt(4)
 v_mfma_f32_16x16x32_bf16 v[48:51], v[88:91], a[48:51], v[48:51]
 ds_read_b64_tr_b16 v[84:85], v14 offset:9216
 v_mfma_f32_16x16x32_bf16 v[52:55], v[88:91], a[52:55], v[52:55]
 ds_read_b64_tr_b16 v[86:87], v14 offset:9728
 v_mfma_f32_16x16x32_bf16 v[56:59], v[88:91], a[56:59], v[56:59]
 buffer_load_dwordx4 v4, s[16:19], s54 offen lds
 v_mul_f32 v149, v149, v165
 v_mfma_f32_16x16x32_bf16 v[60:63], v[88:91], a[60:63], v[60:63]
 s_waitcnt lgkmcnt(4)
 v_mfma_f32_16x16x32_bf16 v[64:67], v[92:95], a[48:51], v[64:67]
 v_add_u32 v15, 0xfffe0000, v15
 ds_read_b64_tr_b16 v[88:89], v15 offset:8192
 v_mfma_f32_16x16x32_bf16 v[68:71], v[92:95], a[52:55], v[68:71]
 ds_read_b64_tr_b16 v[90:91], v15 offset:8704
 v_mfma_f32_16x16x32_bf16 v[72:75], v[92:95], a[56:59], v[72:75]
 buffer_load_dwordx4 v4, s[20:23], s54 offen offset:1024 lds
 v_mul_f32 v150, v150, v166
 v_mfma_f32_16x16x32_bf16 v[76:79], v[92:95], a[60:63], v[76:79]
 s_waitcnt lgkmcnt(4)
 v_mfma_f32_16x16x32_bf16 v[16:19], v[80:83], a[64:67], v[16:19]
 ds_read_b64_tr_b16 v[92:93], v15 offset:9216
 v_mfma_f32_16x16x32_bf16 v[20:23], v[80:83], a[68:71], v[20:23]
 ds_read_b64_tr_b16 v[94:95], v15 offset:9728
 v_mfma_f32_16x16x32_bf16 v[24:27], v[80:83], a[72:75], v[24:27]
 s_add_u32 m0, s53, 0
 v_mul_f32 v151, v151, v167
 v_mfma_f32_16x16x32_bf16 v[28:31], v[80:83], a[76:79], v[28:31]
 s_waitcnt lgkmcnt(4)
 v_mfma_f32_16x16x32_bf16 v[32:35], v[84:87], a[64:67], v[32:35]
 v_add_u32 v14, 0x20000, v14
 ds_read_b64_tr_b16 v[80:81], v14 offset:0
 v_mfma_f32_16x16x32_bf16 v[36:39], v[84:87], a[68:71], v[36:39]
 ds_read_b64_tr_b16 v[82:83], v14 offset:512
 v_mfma_f32_16x16x32_bf16 v[40:43], v[84:87], a[72:75], v[40:43]
 s_mov_b32 s54, 3539200
 v_cvt_pk_bf16_f32 v212, v148, v149
 v_mfma_f32_16x16x32_bf16 v[44:47], v[84:87], a[76:79], v[44:47]
 s_waitcnt lgkmcnt(4)
 v_mfma_f32_16x16x32_bf16 v[48:51], v[88:91], a[64:67], v[48:51]
 ds_read_b64_tr_b16 v[84:85], v14 offset:1024
 v_mfma_f32_16x16x32_bf16 v[52:55], v[88:91], a[68:71], v[52:55]
 ds_read_b64_tr_b16 v[86:87], v14 offset:1536
 v_mfma_f32_16x16x32_bf16 v[56:59], v[88:91], a[72:75], v[56:59]
 buffer_load_dwordx4 v4, s[16:19], s54 offen lds
 v_cvt_pk_bf16_f32 v213, v150, v151
 v_mfma_f32_16x16x32_bf16 v[60:63], v[88:91], a[76:79], v[60:63]
 s_waitcnt lgkmcnt(4)
 v_mfma_f32_16x16x32_bf16 v[64:67], v[92:95], a[64:67], v[64:67]
 v_add_u32 v15, 0x20000, v15
 ds_read_b64_tr_b16 v[88:89], v15 offset:0
 v_mfma_f32_16x16x32_bf16 v[68:71], v[92:95], a[68:71], v[68:71]
 ds_read_b64_tr_b16 v[90:91], v15 offset:512
 v_mfma_f32_16x16x32_bf16 v[72:75], v[92:95], a[72:75], v[72:75]
 buffer_load_dwordx4 v4, s[20:23], s54 offen offset:1024 lds
 v_max_f32 v180, 0, v180
 v_mfma_f32_16x16x32_bf16 v[76:79], v[92:95], a[76:79], v[76:79]
 s_waitcnt lgkmcnt(4)
 v_mfma_f32_16x16x32_bf16 v[16:19], v[80:83], a[80:83], v[16:19]
 ds_read_b64_tr_b16 v[92:93], v15 offset:1024
 v_mfma_f32_16x16x32_bf16 v[20:23], v[80:83], a[84:87], v[20:23]
 ds_read_b64_tr_b16 v[94:95], v15 offset:1536
 v_mfma_f32_16x16x32_bf16 v[24:27], v[80:83], a[88:91], v[24:27]
 s_add_u32 m0, s53, 40960
 v_max_f32 v181, 0, v181
 v_mfma_f32_16x16x32_bf16 v[28:31], v[80:83], a[92:95], v[28:31]
 s_waitcnt vmcnt(8)
 s_barrier
 s_waitcnt lgkmcnt(4)
 v_mfma_f32_16x16x32_bf16 v[32:35], v[84:87], a[80:83], v[32:35]
 ds_read_b64_tr_b16 v[80:81], v14 offset:16384
 v_mfma_f32_16x16x32_bf16 v[36:39], v[84:87], a[84:87], v[36:39]
 ds_read_b64_tr_b16 v[82:83], v14 offset:16896
 v_mfma_f32_16x16x32_bf16 v[40:43], v[84:87], a[88:91], v[40:43]
 s_mov_b32 s54, 3834112
 v_max_f32 v182, 0, v182
 v_mfma_f32_16x16x32_bf16 v[44:47], v[84:87], a[92:95], v[44:47]
 s_waitcnt lgkmcnt(4)
 v_mfma_f32_16x16x32_bf16 v[48:51], v[88:91], a[80:83], v[48:51]
 ds_read_b64_tr_b16 v[84:85], v14 offset:17408
 v_mfma_f32_16x16x32_bf16 v[52:55], v[88:91], a[84:87], v[52:55]
 ds_read_b64_tr_b16 v[86:87], v14 offset:17920
 v_mfma_f32_16x16x32_bf16 v[56:59], v[88:91], a[88:91], v[56:59]
 buffer_load_dwordx4 v4, s[16:19], s54 offen lds
 v_max_f32 v183, 0, v183
 v_mfma_f32_16x16x32_bf16 v[60:63], v[88:91], a[92:95], v[60:63]
 s_waitcnt lgkmcnt(4)
 v_mfma_f32_16x16x32_bf16 v[64:67], v[92:95], a[80:83], v[64:67]
 ds_read_b64_tr_b16 v[88:89], v15 offset:16384
 v_mfma_f32_16x16x32_bf16 v[68:71], v[92:95], a[84:87], v[68:71]
 ds_read_b64_tr_b16 v[90:91], v15 offset:16896
 v_mfma_f32_16x16x32_bf16 v[72:75], v[92:95], a[88:91], v[72:75]
 buffer_load_dwordx4 v4, s[20:23], s54 offen offset:1024 lds
 v_mul_f32 v180, v180, v196
 v_mfma_f32_16x16x32_bf16 v[76:79], v[92:95], a[92:95], v[76:79]
 s_waitcnt lgkmcnt(4)
 v_mfma_f32_16x16x32_bf16 v[16:19], v[80:83], a[96:99], v[16:19]
 ds_read_b64_tr_b16 v[92:93], v15 offset:17408
 v_mfma_f32_16x16x32_bf16 v[20:23], v[80:83], a[100:103], v[20:23]
 ds_read_b64_tr_b16 v[94:95], v15 offset:17920
 v_mfma_f32_16x16x32_bf16 v[24:27], v[80:83], a[104:107], v[24:27]
 s_add_u32 m0, s53, 122880
 v_mul_f32 v181, v181, v197
 v_mfma_f32_16x16x32_bf16 v[28:31], v[80:83], a[108:111], v[28:31]
 s_waitcnt lgkmcnt(4)
 v_mfma_f32_16x16x32_bf16 v[32:35], v[84:87], a[96:99], v[32:35]
 v_add_u32 v14, 0xfffe0000, v14
 ds_read_b64_tr_b16 v[80:81], v14 offset:16384
 v_mfma_f32_16x16x32_bf16 v[36:39], v[84:87], a[100:103], v[36:39]
 ds_read_b64_tr_b16 v[82:83], v14 offset:16896
 v_mfma_f32_16x16x32_bf16 v[40:43], v[84:87], a[104:107], v[40:43]
 s_mov_b32 s54, 4129024
 v_mul_f32 v182, v182, v198
 v_mfma_f32_16x16x32_bf16 v[44:47], v[84:87], a[108:111], v[44:47]
 s_waitcnt lgkmcnt(4)
 v_mfma_f32_16x16x32_bf16 v[48:51], v[88:91], a[96:99], v[48:51]
 ds_read_b64_tr_b16 v[84:85], v14 offset:17408
 v_mfma_f32_16x16x32_bf16 v[52:55], v[88:91], a[100:103], v[52:55]
 ds_read_b64_tr_b16 v[86:87], v14 offset:17920
 v_mfma_f32_16x16x32_bf16 v[56:59], v[88:91], a[104:107], v[56:59]
 buffer_load_dwordx4 v4, s[16:19], s54 offen lds
 v_mul_f32 v183, v183, v199
 v_mfma_f32_16x16x32_bf16 v[60:63], v[88:91], a[108:111], v[60:63]
 s_waitcnt lgkmcnt(4)
 v_mfma_f32_16x16x32_bf16 v[64:67], v[92:95], a[96:99], v[64:67]
 v_add_u32 v15, 0xfffe0000, v15
 ds_read_b64_tr_b16 v[88:89], v15 offset:16384
 v_mfma_f32_16x16x32_bf16 v[68:71], v[92:95], a[100:103], v[68:71]
 ds_read_b64_tr_b16 v[90:91], v15 offset:16896
 v_mfma_f32_16x16x32_bf16 v[72:75], v[92:95], a[104:107], v[72:75]
 buffer_load_dwordx4 v4, s[20:23], s54 offen offset:1024 lds
 v_cvt_pk_bf16_f32 v214, v180, v181
 v_mfma_f32_16x16x32_bf16 v[76:79], v[92:95], a[108:111], v[76:79]
 s_waitcnt lgkmcnt(4)
 v_mfma_f32_16x16x32_bf16 v[16:19], v[80:83], a[112:115], v[16:19]
 ds_read_b64_tr_b16 v[92:93], v15 offset:17408
 v_mfma_f32_16x16x32_bf16 v[20:23], v[80:83], a[116:119], v[20:23]
 ds_read_b64_tr_b16 v[94:95], v15 offset:17920
 v_mfma_f32_16x16x32_bf16 v[24:27], v[80:83], a[120:123], v[24:27]
 s_add_u32 m0, s53, 139264
 v_cvt_pk_bf16_f32 v215, v182, v183
 v_mfma_f32_16x16x32_bf16 v[28:31], v[80:83], a[124:127], v[28:31]
 s_waitcnt lgkmcnt(4)
 v_mfma_f32_16x16x32_bf16 v[32:35], v[84:87], a[112:115], v[32:35]
 ds_read_b64_tr_b16 v[80:81], v14 offset:24576
 v_mfma_f32_16x16x32_bf16 v[36:39], v[84:87], a[116:119], v[36:39]
 ds_read_b64_tr_b16 v[82:83], v14 offset:25088
 v_mfma_f32_16x16x32_bf16 v[40:43], v[84:87], a[120:123], v[40:43]
 s_mov_b32 s54, 4423936
 ds_write_b128 v99, v[212:215] offset:17408
 v_mfma_f32_16x16x32_bf16 v[44:47], v[84:87], a[124:127], v[44:47]
 s_waitcnt lgkmcnt(5)
 v_mfma_f32_16x16x32_bf16 v[48:51], v[88:91], a[112:115], v[48:51]
 ds_read_b64_tr_b16 v[84:85], v14 offset:25600
 v_mfma_f32_16x16x32_bf16 v[52:55], v[88:91], a[116:119], v[52:55]
 ds_read_b64_tr_b16 v[86:87], v14 offset:26112
 v_mfma_f32_16x16x32_bf16 v[56:59], v[88:91], a[120:123], v[56:59]
 buffer_load_dwordx4 v4, s[16:19], s54 offen lds
 v_max_f32 v152, 0, v152
 v_mfma_f32_16x16x32_bf16 v[60:63], v[88:91], a[124:127], v[60:63]
 s_waitcnt lgkmcnt(5)
 v_mfma_f32_16x16x32_bf16 v[64:67], v[92:95], a[112:115], v[64:67]
 ds_read_b64_tr_b16 v[88:89], v15 offset:24576
 v_mfma_f32_16x16x32_bf16 v[68:71], v[92:95], a[116:119], v[68:71]
 ds_read_b64_tr_b16 v[90:91], v15 offset:25088
 v_mfma_f32_16x16x32_bf16 v[72:75], v[92:95], a[120:123], v[72:75]
 buffer_load_dwordx4 v4, s[20:23], s54 offen offset:1024 lds
 v_max_f32 v153, 0, v153
 v_mfma_f32_16x16x32_bf16 v[76:79], v[92:95], a[124:127], v[76:79]
 s_waitcnt lgkmcnt(5)
 v_mfma_f32_16x16x32_bf16 v[16:19], v[80:83], a[128:131], v[16:19]
 ds_read_b64_tr_b16 v[92:93], v15 offset:25600
 v_mfma_f32_16x16x32_bf16 v[20:23], v[80:83], a[132:135], v[20:23]
 ds_read_b64_tr_b16 v[94:95], v15 offset:26112
 v_mfma_f32_16x16x32_bf16 v[24:27], v[80:83], a[136:139], v[24:27]
 s_add_u32 m0, s53, 8192
 v_max_f32 v154, 0, v154
 v_mfma_f32_16x16x32_bf16 v[28:31], v[80:83], a[140:143], v[28:31]
 s_waitcnt vmcnt(8)
 s_barrier
 s_waitcnt lgkmcnt(4)
 v_mfma_f32_16x16x32_bf16 v[32:35], v[84:87], a[128:131], v[32:35]
 ds_read_b64_tr_b16 v[80:81], v14 offset:32768
 v_mfma_f32_16x16x32_bf16 v[36:39], v[84:87], a[132:135], v[36:39]
 ds_read_b64_tr_b16 v[82:83], v14 offset:33280
 v_mfma_f32_16x16x32_bf16 v[40:43], v[84:87], a[136:139], v[40:43]
 s_mov_b32 s54, 4718848
 v_max_f32 v155, 0, v155
 v_mfma_f32_16x16x32_bf16 v[44:47], v[84:87], a[140:143], v[44:47]
 s_waitcnt lgkmcnt(4)
 v_mfma_f32_16x16x32_bf16 v[48:51], v[88:91], a[128:131], v[48:51]
 ds_read_b64_tr_b16 v[84:85], v14 offset:33792
 v_mfma_f32_16x16x32_bf16 v[52:55], v[88:91], a[132:135], v[52:55]
 ds_read_b64_tr_b16 v[86:87], v14 offset:34304
 v_mfma_f32_16x16x32_bf16 v[56:59], v[88:91], a[136:139], v[56:59]
 buffer_load_dwordx4 v4, s[16:19], s54 offen lds
 v_mul_f32 v152, v152, v168
 v_mfma_f32_16x16x32_bf16 v[60:63], v[88:91], a[140:143], v[60:63]
 s_waitcnt lgkmcnt(4)
 v_mfma_f32_16x16x32_bf16 v[64:67], v[92:95], a[128:131], v[64:67]
 ds_read_b64_tr_b16 v[88:89], v15 offset:32768
 v_mfma_f32_16x16x32_bf16 v[68:71], v[92:95], a[132:135], v[68:71]
 ds_read_b64_tr_b16 v[90:91], v15 offset:33280
 v_mfma_f32_16x16x32_bf16 v[72:75], v[92:95], a[136:139], v[72:75]
 buffer_load_dwordx4 v4, s[20:23], s54 offen offset:1024 lds
 v_mul_f32 v153, v153, v169
 v_mfma_f32_16x16x32_bf16 v[76:79], v[92:95], a[140:143], v[76:79]
 s_waitcnt lgkmcnt(4)
 v_mfma_f32_16x16x32_bf16 v[16:19], v[80:83], a[144:147], v[16:19]
 ds_read_b64_tr_b16 v[92:93], v15 offset:33792
 v_mfma_f32_16x16x32_bf16 v[20:23], v[80:83], a[148:151], v[20:23]
 ds_read_b64_tr_b16 v[94:95], v15 offset:34304
 v_mfma_f32_16x16x32_bf16 v[24:27], v[80:83], a[152:155], v[24:27]
 s_add_u32 m0, s53, 147456
 v_mul_f32 v154, v154, v170
 v_mfma_f32_16x16x32_bf16 v[28:31], v[80:83], a[156:159], v[28:31]
 s_waitcnt lgkmcnt(4)
 v_mfma_f32_16x16x32_bf16 v[32:35], v[84:87], a[144:147], v[32:35]
 ds_read_b64_tr_b16 v[80:81], v14 offset:49152
 v_mfma_f32_16x16x32_bf16 v[36:39], v[84:87], a[148:151], v[36:39]
 ds_read_b64_tr_b16 v[82:83], v14 offset:49664
 v_mfma_f32_16x16x32_bf16 v[40:43], v[84:87], a[152:155], v[40:43]
 s_mov_b32 s54, 5013760
 v_mul_f32 v155, v155, v171
 v_mfma_f32_16x16x32_bf16 v[44:47], v[84:87], a[156:159], v[44:47]
 s_waitcnt lgkmcnt(4)
 v_mfma_f32_16x16x32_bf16 v[48:51], v[88:91], a[144:147], v[48:51]
 ds_read_b64_tr_b16 v[84:85], v14 offset:50176
 v_mfma_f32_16x16x32_bf16 v[52:55], v[88:91], a[148:151], v[52:55]
 ds_read_b64_tr_b16 v[86:87], v14 offset:50688
 v_mfma_f32_16x16x32_bf16 v[56:59], v[88:91], a[152:155], v[56:59]
 buffer_load_dwordx4 v4, s[16:19], s54 offen lds
 v_cvt_pk_bf16_f32 v208, v152, v153
 v_mfma_f32_16x16x32_bf16 v[60:63], v[88:91], a[156:159], v[60:63]
 s_waitcnt lgkmcnt(4)
 v_mfma_f32_16x16x32_bf16 v[64:67], v[92:95], a[144:147], v[64:67]
 ds_read_b64_tr_b16 v[88:89], v15 offset:49152
 v_mfma_f32_16x16x32_bf16 v[68:71], v[92:95], a[148:151], v[68:71]
 ds_read_b64_tr_b16 v[90:91], v15 offset:49664
 v_mfma_f32_16x16x32_bf16 v[72:75], v[92:95], a[152:155], v[72:75]
 buffer_load_dwordx4 v4, s[20:23], s54 offen offset:1024 lds
 v_cvt_pk_bf16_f32 v209, v154, v155
 v_mfma_f32_16x16x32_bf16 v[76:79], v[92:95], a[156:159], v[76:79]
 s_waitcnt lgkmcnt(4)
 v_mfma_f32_16x16x32_bf16 v[16:19], v[80:83], a[160:163], v[16:19]
 ds_read_b64_tr_b16 v[92:93], v15 offset:50176
 v_mfma_f32_16x16x32_bf16 v[20:23], v[80:83], a[164:167], v[20:23]
 ds_read_b64_tr_b16 v[94:95], v15 offset:50688
 v_mfma_f32_16x16x32_bf16 v[24:27], v[80:83], a[168:171], v[24:27]
 s_add_u32 m0, s53, 16384
 v_max_f32 v184, 0, v184
 v_mfma_f32_16x16x32_bf16 v[28:31], v[80:83], a[172:175], v[28:31]
 s_waitcnt lgkmcnt(4)
 v_mfma_f32_16x16x32_bf16 v[32:35], v[84:87], a[160:163], v[32:35]
 v_add_u32 v14, 0x20000, v14
 ds_read_b64_tr_b16 v[80:81], v14 offset:24576
 v_mfma_f32_16x16x32_bf16 v[36:39], v[84:87], a[164:167], v[36:39]
 ds_read_b64_tr_b16 v[82:83], v14 offset:25088
 v_mfma_f32_16x16x32_bf16 v[40:43], v[84:87], a[168:171], v[40:43]
 s_mov_b32 s54, 384
 v_max_f32 v185, 0, v185
 v_mfma_f32_16x16x32_bf16 v[44:47], v[84:87], a[172:175], v[44:47]
 s_waitcnt lgkmcnt(4)
 v_mfma_f32_16x16x32_bf16 v[48:51], v[88:91], a[160:163], v[48:51]
 ds_read_b64_tr_b16 v[84:85], v14 offset:25600
 v_mfma_f32_16x16x32_bf16 v[52:55], v[88:91], a[164:167], v[52:55]
 ds_read_b64_tr_b16 v[86:87], v14 offset:26112
 v_mfma_f32_16x16x32_bf16 v[56:59], v[88:91], a[168:171], v[56:59]
 buffer_load_dwordx4 v4, s[16:19], s54 offen lds
 v_max_f32 v186, 0, v186
 v_mfma_f32_16x16x32_bf16 v[60:63], v[88:91], a[172:175], v[60:63]
 s_waitcnt lgkmcnt(4)
 v_mfma_f32_16x16x32_bf16 v[64:67], v[92:95], a[160:163], v[64:67]
 v_add_u32 v15, 0x20000, v15
 ds_read_b64_tr_b16 v[88:89], v15 offset:24576
 v_mfma_f32_16x16x32_bf16 v[68:71], v[92:95], a[164:167], v[68:71]
 ds_read_b64_tr_b16 v[90:91], v15 offset:25088
 v_mfma_f32_16x16x32_bf16 v[72:75], v[92:95], a[168:171], v[72:75]
 buffer_load_dwordx4 v4, s[20:23], s54 offen offset:1024 lds
 v_max_f32 v187, 0, v187
 v_mfma_f32_16x16x32_bf16 v[76:79], v[92:95], a[172:175], v[76:79]
 s_waitcnt lgkmcnt(4)
 v_mfma_f32_16x16x32_bf16 v[16:19], v[80:83], a[176:179], v[16:19]
 ds_read_b64_tr_b16 v[92:93], v15 offset:25600
 v_mfma_f32_16x16x32_bf16 v[20:23], v[80:83], a[180:183], v[20:23]
 ds_read_b64_tr_b16 v[94:95], v15 offset:26112
 v_mfma_f32_16x16x32_bf16 v[24:27], v[80:83], a[184:187], v[24:27]
 s_add_u32 m0, s53, 57344
 v_mul_f32 v184, v184, v200
 v_mfma_f32_16x16x32_bf16 v[28:31], v[80:83], a[188:191], v[28:31]
 s_waitcnt vmcnt(8)
 s_barrier
 s_waitcnt lgkmcnt(4)
 v_mfma_f32_16x16x32_bf16 v[32:35], v[84:87], a[176:179], v[32:35]
 v_add_u32 v14, 0xfffe0000, v14
 ds_read_b64_tr_b16 v[80:81], v14 offset:0
 v_mfma_f32_16x16x32_bf16 v[36:39], v[84:87], a[180:183], v[36:39]
 ds_read_b64_tr_b16 v[82:83], v14 offset:512
 v_mfma_f32_16x16x32_bf16 v[40:43], v[84:87], a[184:187], v[40:43]
 s_mov_b32 s54, 295296
 v_mul_f32 v185, v185, v201
 v_mfma_f32_16x16x32_bf16 v[44:47], v[84:87], a[188:191], v[44:47]
 s_waitcnt lgkmcnt(4)
 v_mfma_f32_16x16x32_bf16 v[48:51], v[88:91], a[176:179], v[48:51]
 ds_read_b64_tr_b16 v[84:85], v14 offset:1024
 v_mfma_f32_16x16x32_bf16 v[52:55], v[88:91], a[180:183], v[52:55]
 ds_read_b64_tr_b16 v[86:87], v14 offset:1536
 v_mfma_f32_16x16x32_bf16 v[56:59], v[88:91], a[184:187], v[56:59]
 buffer_load_dwordx4 v4, s[16:19], s54 offen lds
 v_mul_f32 v186, v186, v202
 v_mfma_f32_16x16x32_bf16 v[60:63], v[88:91], a[188:191], v[60:63]
 s_waitcnt lgkmcnt(4)
 v_mfma_f32_16x16x32_bf16 v[64:67], v[92:95], a[176:179], v[64:67]
 v_add_u32 v15, 0xfffe0000, v15
 ds_read_b64_tr_b16 v[88:89], v15 offset:0
 v_mfma_f32_16x16x32_bf16 v[68:71], v[92:95], a[180:183], v[68:71]
 ds_read_b64_tr_b16 v[90:91], v15 offset:512
 v_mfma_f32_16x16x32_bf16 v[72:75], v[92:95], a[184:187], v[72:75]
 buffer_load_dwordx4 v4, s[20:23], s54 offen offset:1024 lds
 v_mul_f32 v187, v187, v203
 v_mfma_f32_16x16x32_bf16 v[76:79], v[92:95], a[188:191], v[76:79]
 s_waitcnt lgkmcnt(4)
 v_mfma_f32_16x16x32_bf16 v[16:19], v[80:83], a[192:195], v[16:19]
 ds_read_b64_tr_b16 v[92:93], v15 offset:1024
 v_mfma_f32_16x16x32_bf16 v[20:23], v[80:83], a[196:199], v[20:23]
 ds_read_b64_tr_b16 v[94:95], v15 offset:1536
 v_mfma_f32_16x16x32_bf16 v[24:27], v[80:83], a[200:203], v[24:27]
 s_add_u32 m0, s53, 24576
 v_cvt_pk_bf16_f32 v210, v184, v185
 v_mfma_f32_16x16x32_bf16 v[28:31], v[80:83], a[204:207], v[28:31]
 s_waitcnt lgkmcnt(4)
 v_mfma_f32_16x16x32_bf16 v[32:35], v[84:87], a[192:195], v[32:35]
 ds_read_b64_tr_b16 v[80:81], v14 offset:40960
 v_mfma_f32_16x16x32_bf16 v[36:39], v[84:87], a[196:199], v[36:39]
 ds_read_b64_tr_b16 v[82:83], v14 offset:41472
 v_mfma_f32_16x16x32_bf16 v[40:43], v[84:87], a[200:203], v[40:43]
 s_mov_b32 s54, 590208
 v_cvt_pk_bf16_f32 v211, v186, v187
 v_mfma_f32_16x16x32_bf16 v[44:47], v[84:87], a[204:207], v[44:47]
 s_waitcnt lgkmcnt(4)
 v_mfma_f32_16x16x32_bf16 v[48:51], v[88:91], a[192:195], v[48:51]
 ds_read_b64_tr_b16 v[84:85], v14 offset:41984
 v_mfma_f32_16x16x32_bf16 v[52:55], v[88:91], a[196:199], v[52:55]
 ds_read_b64_tr_b16 v[86:87], v14 offset:42496
 v_mfma_f32_16x16x32_bf16 v[56:59], v[88:91], a[200:203], v[56:59]
 buffer_load_dwordx4 v4, s[16:19], s54 offen lds
 ds_write_b128 v99, v[208:211] offset:18432
 v_mfma_f32_16x16x32_bf16 v[60:63], v[88:91], a[204:207], v[60:63]
 s_waitcnt lgkmcnt(5)
 v_mfma_f32_16x16x32_bf16 v[64:67], v[92:95], a[192:195], v[64:67]
 ds_read_b64_tr_b16 v[88:89], v15 offset:40960
 v_mfma_f32_16x16x32_bf16 v[68:71], v[92:95], a[196:199], v[68:71]
 ds_read_b64_tr_b16 v[90:91], v15 offset:41472
 v_mfma_f32_16x16x32_bf16 v[72:75], v[92:95], a[200:203], v[72:75]
 buffer_load_dwordx4 v4, s[20:23], s54 offen offset:1024 lds
 v_max_f32 v156, 0, v156
 v_mfma_f32_16x16x32_bf16 v[76:79], v[92:95], a[204:207], v[76:79]
 s_waitcnt lgkmcnt(5)
 v_mfma_f32_16x16x32_bf16 v[16:19], v[80:83], a[208:211], v[16:19]
 ds_read_b64_tr_b16 v[92:93], v15 offset:41984
 v_mfma_f32_16x16x32_bf16 v[20:23], v[80:83], a[212:215], v[20:23]
 ds_read_b64_tr_b16 v[94:95], v15 offset:42496
 v_mfma_f32_16x16x32_bf16 v[24:27], v[80:83], a[216:219], v[24:27]
 s_add_u32 m0, s53, 32768
 v_max_f32 v157, 0, v157
 v_mfma_f32_16x16x32_bf16 v[28:31], v[80:83], a[220:223], v[28:31]
 s_waitcnt lgkmcnt(5)
 v_mfma_f32_16x16x32_bf16 v[32:35], v[84:87], a[208:211], v[32:35]
 v_add_u32 v14, 0x10000, v14
 ds_read_b64_tr_b16 v[80:81], v14 offset:57344
 v_mfma_f32_16x16x32_bf16 v[36:39], v[84:87], a[212:215], v[36:39]
 ds_read_b64_tr_b16 v[82:83], v14 offset:57856
 v_mfma_f32_16x16x32_bf16 v[40:43], v[84:87], a[216:219], v[40:43]
 s_mov_b32 s54, 885120
 v_max_f32 v158, 0, v158
 v_mfma_f32_16x16x32_bf16 v[44:47], v[84:87], a[220:223], v[44:47]
 s_waitcnt lgkmcnt(4)
 v_mfma_f32_16x16x32_bf16 v[48:51], v[88:91], a[208:211], v[48:51]
 ds_read_b64_tr_b16 v[84:85], v14 offset:58368
 v_mfma_f32_16x16x32_bf16 v[52:55], v[88:91], a[212:215], v[52:55]
 ds_read_b64_tr_b16 v[86:87], v14 offset:58880
 v_mfma_f32_16x16x32_bf16 v[56:59], v[88:91], a[216:219], v[56:59]
 buffer_load_dwordx4 v4, s[16:19], s54 offen lds
 v_max_f32 v159, 0, v159
 v_mfma_f32_16x16x32_bf16 v[60:63], v[88:91], a[220:223], v[60:63]
 s_waitcnt lgkmcnt(4)
 v_mfma_f32_16x16x32_bf16 v[64:67], v[92:95], a[208:211], v[64:67]
 v_add_u32 v15, 0x10000, v15
 ds_read_b64_tr_b16 v[88:89], v15 offset:57344
 v_mfma_f32_16x16x32_bf16 v[68:71], v[92:95], a[212:215], v[68:71]
 ds_read_b64_tr_b16 v[90:91], v15 offset:57856
 v_mfma_f32_16x16x32_bf16 v[72:75], v[92:95], a[216:219], v[72:75]
 buffer_load_dwordx4 v4, s[20:23], s54 offen offset:1024 lds
 v_mul_f32 v156, v156, v172
 v_mfma_f32_16x16x32_bf16 v[76:79], v[92:95], a[220:223], v[76:79]
 s_waitcnt lgkmcnt(4)
 v_mfma_f32_16x16x32_bf16 v[16:19], v[80:83], a[224:227], v[16:19]
 ds_read_b64_tr_b16 v[92:93], v15 offset:58368
 v_mfma_f32_16x16x32_bf16 v[20:23], v[80:83], a[228:231], v[20:23]
 ds_read_b64_tr_b16 v[94:95], v15 offset:58880
 v_mfma_f32_16x16x32_bf16 v[24:27], v[80:83], a[232:235], v[24:27]
 s_add_u32 m0, s53, 49152
 v_mul_f32 v157, v157, v173
 v_mfma_f32_16x16x32_bf16 v[28:31], v[80:83], a[236:239], v[28:31]
 s_waitcnt vmcnt(8)
 s_barrier
 s_waitcnt lgkmcnt(4)
 v_mfma_f32_16x16x32_bf16 v[32:35], v[84:87], a[224:227], v[32:35]
 v_add_u32 v14, 0x10000, v14
 ds_read_b64_tr_b16 v[80:81], v14 offset:8192
 v_mfma_f32_16x16x32_bf16 v[36:39], v[84:87], a[228:231], v[36:39]
 ds_read_b64_tr_b16 v[82:83], v14 offset:8704
 v_mfma_f32_16x16x32_bf16 v[40:43], v[84:87], a[232:235], v[40:43]
 s_mov_b32 s54, 1180032
 v_mul_f32 v158, v158, v174
 v_mfma_f32_16x16x32_bf16 v[44:47], v[84:87], a[236:239], v[44:47]
 s_waitcnt lgkmcnt(4)
 v_mfma_f32_16x16x32_bf16 v[48:51], v[88:91], a[224:227], v[48:51]
 ds_read_b64_tr_b16 v[84:85], v14 offset:9216
 v_mfma_f32_16x16x32_bf16 v[52:55], v[88:91], a[228:231], v[52:55]
 ds_read_b64_tr_b16 v[86:87], v14 offset:9728
 v_mfma_f32_16x16x32_bf16 v[56:59], v[88:91], a[232:235], v[56:59]
 buffer_load_dwordx4 v4, s[16:19], s54 offen lds
 v_mul_f32 v159, v159, v175
 v_mfma_f32_16x16x32_bf16 v[60:63], v[88:91], a[236:239], v[60:63]
 s_waitcnt lgkmcnt(4)
 v_mfma_f32_16x16x32_bf16 v[64:67], v[92:95], a[224:227], v[64:67]
 v_add_u32 v15, 0x10000, v15
 ds_read_b64_tr_b16 v[88:89], v15 offset:8192
 v_mfma_f32_16x16x32_bf16 v[68:71], v[92:95], a[228:231], v[68:71]
 ds_read_b64_tr_b16 v[90:91], v15 offset:8704
 v_mfma_f32_16x16x32_bf16 v[72:75], v[92:95], a[232:235], v[72:75]
 buffer_load_dwordx4 v4, s[20:23], s54 offen offset:1024 lds
 v_cvt_pk_bf16_f32 v212, v156, v157
 v_mfma_f32_16x16x32_bf16 v[76:79], v[92:95], a[236:239], v[76:79]
 s_waitcnt lgkmcnt(4)
 v_mfma_f32_16x16x32_bf16 v[16:19], v[80:83], a[240:243], v[16:19]
 ds_read_b64_tr_b16 v[92:93], v15 offset:9216
 v_mfma_f32_16x16x32_bf16 v[20:23], v[80:83], a[244:247], v[20:23]
 ds_read_b64_tr_b16 v[94:95], v15 offset:9728
 v_mfma_f32_16x16x32_bf16 v[24:27], v[80:83], a[248:251], v[24:27]
 s_add_u32 m0, s53, 155648
 v_cvt_pk_bf16_f32 v213, v158, v159
 v_mfma_f32_16x16x32_bf16 v[28:31], v[80:83], a[252:255], v[28:31]
 s_waitcnt lgkmcnt(4)
 v_mfma_f32_16x16x32_bf16 v[32:35], v[84:87], a[240:243], v[32:35]
 v_add_u32 v14, 0xfffe0000, v14
 ds_read_b64_tr_b16 v[80:81], v14 offset:8192
 v_mfma_f32_16x16x32_bf16 v[36:39], v[84:87], a[244:247], v[36:39]
 ds_read_b64_tr_b16 v[82:83], v14 offset:8704
 v_mfma_f32_16x16x32_bf16 v[40:43], v[84:87], a[248:251], v[40:43]
 s_mov_b32 s54, 1474944
 v_max_f32 v188, 0, v188
 v_mfma_f32_16x16x32_bf16 v[44:47], v[84:87], a[252:255], v[44:47]
 s_waitcnt lgkmcnt(4)
 v_mfma_f32_16x16x32_bf16 v[48:51], v[88:91], a[240:243], v[48:51]
 ds_read_b64_tr_b16 v[84:85], v14 offset:9216
 v_mfma_f32_16x16x32_bf16 v[52:55], v[88:91], a[244:247], v[52:55]
 ds_read_b64_tr_b16 v[86:87], v14 offset:9728
 v_mfma_f32_16x16x32_bf16 v[56:59], v[88:91], a[248:251], v[56:59]
 buffer_load_dwordx4 v4, s[16:19], s54 offen lds
 v_max_f32 v189, 0, v189
 v_mfma_f32_16x16x32_bf16 v[60:63], v[88:91], a[252:255], v[60:63]
 s_waitcnt lgkmcnt(4)
 v_mfma_f32_16x16x32_bf16 v[64:67], v[92:95], a[240:243], v[64:67]
 v_add_u32 v15, 0xfffe0000, v15
 ds_read_b64_tr_b16 v[88:89], v15 offset:8192
 v_mfma_f32_16x16x32_bf16 v[68:71], v[92:95], a[244:247], v[68:71]
 ds_read_b64_tr_b16 v[90:91], v15 offset:8704
 v_mfma_f32_16x16x32_bf16 v[72:75], v[92:95], a[248:251], v[72:75]
 buffer_load_dwordx4 v4, s[20:23], s54 offen offset:1024 lds
 v_max_f32 v190, 0, v190
 v_mfma_f32_16x16x32_bf16 v[76:79], v[92:95], a[252:255], v[76:79]
 s_waitcnt lgkmcnt(4)
 v_mfma_f32_16x16x32_bf16 v[16:19], v[80:83], v[112:115], v[16:19]
 ds_read_b64_tr_b16 v[92:93], v15 offset:9216
 v_mfma_f32_16x16x32_bf16 v[20:23], v[80:83], v[116:119], v[20:23]
 ds_read_b64_tr_b16 v[94:95], v15 offset:9728
 v_mfma_f32_16x16x32_bf16 v[24:27], v[80:83], v[120:123], v[24:27]
 s_add_u32 m0, s53, 0
 v_max_f32 v191, 0, v191
 v_mfma_f32_16x16x32_bf16 v[28:31], v[80:83], v[124:127], v[28:31]
 s_waitcnt lgkmcnt(4)
 v_mfma_f32_16x16x32_bf16 v[32:35], v[84:87], v[112:115], v[32:35]
 v_add_u32 v14, 0x20000, v14
 ds_read_b64_tr_b16 v[80:81], v14 offset:16384
 v_mfma_f32_16x16x32_bf16 v[36:39], v[84:87], v[116:119], v[36:39]
 ds_read_b64_tr_b16 v[82:83], v14 offset:16896
 v_mfma_f32_16x16x32_bf16 v[40:43], v[84:87], v[120:123], v[40:43]
 s_mov_b32 s54, 1769856
 v_mul_f32 v188, v188, v204
 v_mfma_f32_16x16x32_bf16 v[44:47], v[84:87], v[124:127], v[44:47]
 s_waitcnt lgkmcnt(4)
 v_mfma_f32_16x16x32_bf16 v[48:51], v[88:91], v[112:115], v[48:51]
 ds_read_b64_tr_b16 v[84:85], v14 offset:17408
 v_mfma_f32_16x16x32_bf16 v[52:55], v[88:91], v[116:119], v[52:55]
 ds_read_b64_tr_b16 v[86:87], v14 offset:17920
 v_mfma_f32_16x16x32_bf16 v[56:59], v[88:91], v[120:123], v[56:59]
 buffer_load_dwordx4 v4, s[16:19], s54 offen lds
 v_mul_f32 v189, v189, v205
 v_mfma_f32_16x16x32_bf16 v[60:63], v[88:91], v[124:127], v[60:63]
 s_waitcnt lgkmcnt(4)
 v_mfma_f32_16x16x32_bf16 v[64:67], v[92:95], v[112:115], v[64:67]
 v_add_u32 v15, 0x20000, v15
 ds_read_b64_tr_b16 v[88:89], v15 offset:16384
 v_mfma_f32_16x16x32_bf16 v[68:71], v[92:95], v[116:119], v[68:71]
 ds_read_b64_tr_b16 v[90:91], v15 offset:16896
 v_mfma_f32_16x16x32_bf16 v[72:75], v[92:95], v[120:123], v[72:75]
 buffer_load_dwordx4 v4, s[20:23], s54 offen offset:1024 lds
 v_mul_f32 v190, v190, v206
 v_mfma_f32_16x16x32_bf16 v[76:79], v[92:95], v[124:127], v[76:79]
 s_waitcnt lgkmcnt(4)
 v_mfma_f32_16x16x32_bf16 v[16:19], v[80:83], v[128:131], v[16:19]
 ds_read_b64_tr_b16 v[92:93], v15 offset:17408
 v_mfma_f32_16x16x32_bf16 v[20:23], v[80:83], v[132:135], v[20:23]
 ds_read_b64_tr_b16 v[94:95], v15 offset:17920
 v_mfma_f32_16x16x32_bf16 v[24:27], v[80:83], v[136:139], v[24:27]
 s_add_u32 m0, s53, 40960
 v_mul_f32 v191, v191, v207
 v_mfma_f32_16x16x32_bf16 v[28:31], v[80:83], v[140:143], v[28:31]
 s_waitcnt vmcnt(8)
 s_barrier
 s_waitcnt lgkmcnt(4)
 v_mfma_f32_16x16x32_bf16 v[32:35], v[84:87], v[128:131], v[32:35]
 v_add_u32 v14, 0xfffe0000, v14
 ds_read_b64_tr_b16 v[80:81], v14 offset:16384
 v_mfma_f32_16x16x32_bf16 v[36:39], v[84:87], v[132:135], v[36:39]
 ds_read_b64_tr_b16 v[82:83], v14 offset:16896
 v_mfma_f32_16x16x32_bf16 v[40:43], v[84:87], v[136:139], v[40:43]
 s_mov_b32 s54, 2064768
 v_cvt_pk_bf16_f32 v214, v188, v189
 v_mfma_f32_16x16x32_bf16 v[44:47], v[84:87], v[140:143], v[44:47]
 s_waitcnt lgkmcnt(4)
 v_mfma_f32_16x16x32_bf16 v[48:51], v[88:91], v[128:131], v[48:51]
 ds_read_b64_tr_b16 v[84:85], v14 offset:17408
 v_mfma_f32_16x16x32_bf16 v[52:55], v[88:91], v[132:135], v[52:55]
 ds_read_b64_tr_b16 v[86:87], v14 offset:17920
 v_mfma_f32_16x16x32_bf16 v[56:59], v[88:91], v[136:139], v[56:59]
 buffer_load_dwordx4 v4, s[16:19], s54 offen lds
 v_cvt_pk_bf16_f32 v215, v190, v191
 v_mfma_f32_16x16x32_bf16 v[60:63], v[88:91], v[140:143], v[60:63]
 s_waitcnt lgkmcnt(4)
 v_mfma_f32_16x16x32_bf16 v[64:67], v[92:95], v[128:131], v[64:67]
 v_add_u32 v15, 0xfffe0000, v15
 ds_read_b64_tr_b16 v[88:89], v15 offset:16384
 v_mfma_f32_16x16x32_bf16 v[68:71], v[92:95], v[132:135], v[68:71]
 ds_read_b64_tr_b16 v[90:91], v15 offset:16896
 v_mfma_f32_16x16x32_bf16 v[72:75], v[92:95], v[136:139], v[72:75]
 buffer_load_dwordx4 v4, s[20:23], s54 offen offset:1024 lds
 ds_write_b128 v99, v[212:215] offset:19456
 v_mfma_f32_16x16x32_bf16 v[76:79], v[92:95], v[140:143], v[76:79]
 s_waitcnt lgkmcnt(5)
 v_mfma_f32_16x16x32_bf16 v[144:147], v[80:83], a[0:3], 0
 ds_read_b64_tr_b16 v[92:93], v15 offset:17408
 v_mfma_f32_16x16x32_bf16 v[148:151], v[80:83], a[4:7], 0
 ds_read_b64_tr_b16 v[94:95], v15 offset:17920
 v_mfma_f32_16x16x32_bf16 v[152:155], v[80:83], a[8:11], 0
 s_add_u32 m0, s53, 139264
 v_max_f32 v16, 0, v16
 v_mfma_f32_16x16x32_bf16 v[156:159], v[80:83], a[12:15], 0
 v_max_f32 v17, 0, v17
 s_waitcnt lgkmcnt(5)
 v_mfma_f32_16x16x32_bf16 v[160:163], v[84:87], a[0:3], 0
 ds_read_b64_tr_b16 v[80:81], v14 offset:57344
 v_mfma_f32_16x16x32_bf16 v[164:167], v[84:87], a[4:7], 0
 ds_read_b64_tr_b16 v[82:83], v14 offset:57856
 v_mfma_f32_16x16x32_bf16 v[168:171], v[84:87], a[8:11], 0
 s_mov_b32 s54, 2359680
 v_max_f32 v18, 0, v18
 v_mfma_f32_16x16x32_bf16 v[172:175], v[84:87], a[12:15], 0
 v_max_f32 v19, 0, v19
 s_waitcnt lgkmcnt(5)
 v_mfma_f32_16x16x32_bf16 v[176:179], v[88:91], a[0:3], 0
 ds_read_b64_tr_b16 v[84:85], v14 offset:58368
 v_mfma_f32_16x16x32_bf16 v[180:183], v[88:91], a[4:7], 0
 ds_read_b64_tr_b16 v[86:87], v14 offset:58880
 v_mfma_f32_16x16x32_bf16 v[184:187], v[88:91], a[8:11], 0
 buffer_load_dwordx4 v4, s[16:19], s54 offen lds
 v_mul_f32 v16, v16, v32
 v_mfma_f32_16x16x32_bf16 v[188:191], v[88:91], a[12:15], 0
 v_mul_f32 v17, v17, v33
 s_waitcnt lgkmcnt(4)
 v_mfma_f32_16x16x32_bf16 v[192:195], v[92:95], a[0:3], 0
 ds_read_b64_tr_b16 v[88:89], v15 offset:57344
 v_mfma_f32_16x16x32_bf16 v[196:199], v[92:95], a[4:7], 0
 ds_read_b64_tr_b16 v[90:91], v15 offset:57856
 v_mfma_f32_16x16x32_bf16 v[200:203], v[92:95], a[8:11], 0
 buffer_load_dwordx4 v4, s[20:23], s54 offen offset:1024 lds
 v_mul_f32 v18, v18, v34
 v_mfma_f32_16x16x32_bf16 v[204:207], v[92:95], a[12:15], 0
 v_mul_f32 v19, v19, v35
 s_waitcnt lgkmcnt(4)
 v_mfma_f32_16x16x32_bf16 v[144:147], v[80:83], a[16:19], v[144:147]
 ds_read_b64_tr_b16 v[92:93], v15 offset:58368
 v_mfma_f32_16x16x32_bf16 v[148:151], v[80:83], a[20:23], v[148:151]
 ds_read_b64_tr_b16 v[94:95], v15 offset:58880
 v_mfma_f32_16x16x32_bf16 v[152:155], v[80:83], a[24:27], v[152:155]
 s_add_u32 m0, s53, 8192
 v_cvt_pk_bf16_f32 v208, v16, v17
 v_mfma_f32_16x16x32_bf16 v[156:159], v[80:83], a[28:31], v[156:159]
 v_cvt_pk_bf16_f32 v209, v18, v19
 s_waitcnt lgkmcnt(4)
 v_mfma_f32_16x16x32_bf16 v[160:163], v[84:87], a[16:19], v[160:163]
 ds_read_b64_tr_b16 v[80:81], v14 offset:24576
 v_mfma_f32_16x16x32_bf16 v[164:167], v[84:87], a[20:23], v[164:167]
 ds_read_b64_tr_b16 v[82:83], v14 offset:25088
 v_mfma_f32_16x16x32_bf16 v[168:171], v[84:87], a[24:27], v[168:171]
 s_mov_b32 s54, 2654592
 v_max_f32 v48, 0, v48
 v_mfma_f32_16x16x32_bf16 v[172:175], v[84:87], a[28:31], v[172:175]
 v_max_f32 v49, 0, v49
 s_waitcnt lgkmcnt(4)
 v_mfma_f32_16x16x32_bf16 v[176:179], v[88:91], a[16:19], v[176:179]
 ds_read_b64_tr_b16 v[84:85], v14 offset:25600
 v_mfma_f32_16x16x32_bf16 v[180:183], v[88:91], a[20:23], v[180:183]
 ds_read_b64_tr_b16 v[86:87], v14 offset:26112
 v_mfma_f32_16x16x32_bf16 v[184:187], v[88:91], a[24:27], v[184:187]
 buffer_load_dwordx4 v4, s[16:19], s54 offen lds
 v_max_f32 v50, 0, v50
 v_mfma_f32_16x16x32_bf16 v[188:191], v[88:91], a[28:31], v[188:191]
 v_max_f32 v51, 0, v51
 s_waitcnt lgkmcnt(4)
 v_mfma_f32_16x16x32_bf16 v[192:195], v[92:95], a[16:19], v[192:195]
 ds_read_b64_tr_b16 v[88:89], v15 offset:24576
 v_mfma_f32_16x16x32_bf16 v[196:199], v[92:95], a[20:23], v[196:199]
 ds_read_b64_tr_b16 v[90:91], v15 offset:25088
 v_mfma_f32_16x16x32_bf16 v[200:203], v[92:95], a[24:27], v[200:203]
 buffer_load_dwordx4 v4, s[20:23], s54 offen offset:1024 lds
 v_mul_f32 v48, v48, v64
 v_mfma_f32_16x16x32_bf16 v[204:207], v[92:95], a[28:31], v[204:207]
 v_mul_f32 v49, v49, v65
 s_waitcnt lgkmcnt(4)
 v_mfma_f32_16x16x32_bf16 v[144:147], v[80:83], a[32:35], v[144:147]
 ds_read_b64_tr_b16 v[92:93], v15 offset:25600
 v_mfma_f32_16x16x32_bf16 v[148:151], v[80:83], a[36:39], v[148:151]
 ds_read_b64_tr_b16 v[94:95], v15 offset:26112
 v_mfma_f32_16x16x32_bf16 v[152:155], v[80:83], a[40:43], v[152:155]
 s_add_u32 m0, s53, 65536
 v_mul_f32 v50, v50, v66
 v_mfma_f32_16x16x32_bf16 v[156:159], v[80:83], a[44:47], v[156:159]
 v_mul_f32 v51, v51, v67
 s_waitcnt vmcnt(8)
 s_barrier
 s_waitcnt lgkmcnt(4)
 v_mfma_f32_16x16x32_bf16 v[160:163], v[84:87], a[32:35], v[160:163]
 ds_read_b64_tr_b16 v[80:81], v14 offset:32768
 v_mfma_f32_16x16x32_bf16 v[164:167], v[84:87], a[36:39], v[164:167]
 ds_read_b64_tr_b16 v[82:83], v14 offset:33280
 v_mfma_f32_16x16x32_bf16 v[168:171], v[84:87], a[40:43], v[168:171]
 s_mov_b32 s54, 2949504
 v_cvt_pk_bf16_f32 v210, v48, v49
 v_mfma_f32_16x16x32_bf16 v[172:175], v[84:87], a[44:47], v[172:175]
 v_cvt_pk_bf16_f32 v211, v50, v51
 s_waitcnt lgkmcnt(4)
 v_mfma_f32_16x16x32_bf16 v[176:179], v[88:91], a[32:35], v[176:179]
 ds_read_b64_tr_b16 v[84:85], v14 offset:33792
 v_mfma_f32_16x16x32_bf16 v[180:183], v[88:91], a[36:39], v[180:183]
 ds_read_b64_tr_b16 v[86:87], v14 offset:34304
 v_mfma_f32_16x16x32_bf16 v[184:187], v[88:91], a[40:43], v[184:187]
 buffer_load_dwordx4 v4, s[16:19], s54 offen lds
 ds_write_b128 v99, v[208:211] offset:32768
 v_mfma_f32_16x16x32_bf16 v[188:191], v[88:91], a[44:47], v[188:191]
 v_max_f32 v20, 0, v20
 s_waitcnt lgkmcnt(5)
 v_mfma_f32_16x16x32_bf16 v[192:195], v[92:95], a[32:35], v[192:195]
 ds_read_b64_tr_b16 v[88:89], v15 offset:32768
 v_mfma_f32_16x16x32_bf16 v[196:199], v[92:95], a[36:39], v[196:199]
 ds_read_b64_tr_b16 v[90:91], v15 offset:33280
 v_mfma_f32_16x16x32_bf16 v[200:203], v[92:95], a[40:43], v[200:203]
 buffer_load_dwordx4 v4, s[20:23], s54 offen offset:1024 lds
 v_max_f32 v21, 0, v21
 v_mfma_f32_16x16x32_bf16 v[204:207], v[92:95], a[44:47], v[204:207]
 v_max_f32 v22, 0, v22
 s_waitcnt lgkmcnt(5)
 v_mfma_f32_16x16x32_bf16 v[144:147], v[80:83], a[48:51], v[144:147]
 ds_read_b64_tr_b16 v[92:93], v15 offset:33792
 v_mfma_f32_16x16x32_bf16 v[148:151], v[80:83], a[52:55], v[148:151]
 ds_read_b64_tr_b16 v[94:95], v15 offset:34304
 v_mfma_f32_16x16x32_bf16 v[152:155], v[80:83], a[56:59], v[152:155]
 s_add_u32 m0, s53, 147456
 v_max_f32 v23, 0, v23
 v_mfma_f32_16x16x32_bf16 v[156:159], v[80:83], a[60:63], v[156:159]
 s_waitcnt lgkmcnt(5)
 v_mfma_f32_16x16x32_bf16 v[160:163], v[84:87], a[48:51], v[160:163]
 ds_read_b64_tr_b16 v[80:81], v14 offset:49152
 v_mfma_f32_16x16x32_bf16 v[164:167], v[84:87], a[52:55], v[164:167]
 ds_read_b64_tr_b16 v[82:83], v14 offset:49664
 v_mfma_f32_16x16x32_bf16 v[168:171], v[84:87], a[56:59], v[168:171]
 s_mov_b32 s54, 3244416
 v_mul_f32 v20, v20, v36
 v_mfma_f32_16x16x32_bf16 v[172:175], v[84:87], a[60:63], v[172:175]
 s_waitcnt lgkmcnt(4)
 v_mfma_f32_16x16x32_bf16 v[176:179], v[88:91], a[48:51], v[176:179]
 ds_read_b64_tr_b16 v[84:85], v14 offset:50176
 v_mfma_f32_16x16x32_bf16 v[180:183], v[88:91], a[52:55], v[180:183]
 ds_read_b64_tr_b16 v[86:87], v14 offset:50688
 v_mfma_f32_16x16x32_bf16 v[184:187], v[88:91], a[56:59], v[184:187]
 buffer_load_dwordx4 v4, s[16:19], s54 offen lds
 v_mul_f32 v21, v21, v37
 v_mfma_f32_16x16x32_bf16 v[188:191], v[88:91], a[60:63], v[188:191]
 s_waitcnt lgkmcnt(4)
 v_mfma_f32_16x16x32_bf16 v[192:195], v[92:95], a[48:51], v[192:195]
 ds_read_b64_tr_b16 v[88:89], v15 offset:49152
 v_mfma_f32_16x16x32_bf16 v[196:199], v[92:95], a[52:55], v[196:199]
 ds_read_b64_tr_b16 v[90:91], v15 offset:49664
 v_mfma_f32_16x16x32_bf16 v[200:203], v[92:95], a[56:59], v[200:203]
 buffer_load_dwordx4 v4, s[20:23], s54 offen offset:1024 lds
 v_mul_f32 v22, v22, v38
 v_mfma_f32_16x16x32_bf16 v[204:207], v[92:95], a[60:63], v[204:207]
 s_waitcnt lgkmcnt(4)
 v_mfma_f32_16x16x32_bf16 v[144:147], v[80:83], a[64:67], v[144:147]
 ds_read_b64_tr_b16 v[92:93], v15 offset:50176
 v_mfma_f32_16x16x32_bf16 v[148:151], v[80:83], a[68:71], v[148:151]
 ds_read_b64_tr_b16 v[94:95], v15 offset:50688
 v_mfma_f32_16x16x32_bf16 v[152:155], v[80:83], a[72:75], v[152:155]
 s_add_u32 m0, s53, 16384
 v_mul_f32 v23, v23, v39
 v_mfma_f32_16x16x32_bf16 v[156:159], v[80:83], a[76:79], v[156:159]
 s_waitcnt lgkmcnt(4)
 v_mfma_f32_16x16x32_bf16 v[160:163], v[84:87], a[64:67], v[160:163]
 v_add_u32 v14, 0x20000, v14
 ds_read_b64_tr_b16 v[80:81], v14 offset:24576
 v_mfma_f32_16x16x32_bf16 v[164:167], v[84:87], a[68:71], v[164:167]
 ds_read_b64_tr_b16 v[82:83], v14 offset:25088
 v_mfma_f32_16x16x32_bf16 v[168:171], v[84:87], a[72:75], v[168:171]
 s_mov_b32 s54, 3539328
 v_cvt_pk_bf16_f32 v212, v20, v21
 v_mfma_f32_16x16x32_bf16 v[172:175], v[84:87], a[76:79], v[172:175]
 s_waitcnt lgkmcnt(4)
 v_mfma_f32_16x16x32_bf16 v[176:179], v[88:91], a[64:67], v[176:179]
 ds_read_b64_tr_b16 v[84:85], v14 offset:25600
 v_mfma_f32_16x16x32_bf16 v[180:183], v[88:91], a[68:71], v[180:183]
 ds_read_b64_tr_b16 v[86:87], v14 offset:26112
 v_mfma_f32_16x16x32_bf16 v[184:187], v[88:91], a[72:75], v[184:187]
 buffer_load_dwordx4 v4, s[16:19], s54 offen lds
 v_cvt_pk_bf16_f32 v213, v22, v23
 v_mfma_f32_16x16x32_bf16 v[188:191], v[88:91], a[76:79], v[188:191]
 s_waitcnt lgkmcnt(4)
 v_mfma_f32_16x16x32_bf16 v[192:195], v[92:95], a[64:67], v[192:195]
 v_add_u32 v15, 0x20000, v15
 ds_read_b64_tr_b16 v[88:89], v15 offset:24576
 v_mfma_f32_16x16x32_bf16 v[196:199], v[92:95], a[68:71], v[196:199]
 ds_read_b64_tr_b16 v[90:91], v15 offset:25088
 v_mfma_f32_16x16x32_bf16 v[200:203], v[92:95], a[72:75], v[200:203]
 buffer_load_dwordx4 v4, s[20:23], s54 offen offset:1024 lds
 v_max_f32 v52, 0, v52
 v_mfma_f32_16x16x32_bf16 v[204:207], v[92:95], a[76:79], v[204:207]
 s_waitcnt lgkmcnt(4)
 v_mfma_f32_16x16x32_bf16 v[144:147], v[80:83], a[80:83], v[144:147]
 ds_read_b64_tr_b16 v[92:93], v15 offset:25600
 v_mfma_f32_16x16x32_bf16 v[148:151], v[80:83], a[84:87], v[148:151]
 ds_read_b64_tr_b16 v[94:95], v15 offset:26112
 v_mfma_f32_16x16x32_bf16 v[152:155], v[80:83], a[88:91], v[152:155]
 s_add_u32 m0, s53, 57344
 v_max_f32 v53, 0, v53
 v_mfma_f32_16x16x32_bf16 v[156:159], v[80:83], a[92:95], v[156:159]
 s_waitcnt vmcnt(8)
 s_barrier
 s_waitcnt lgkmcnt(4)
 v_mfma_f32_16x16x32_bf16 v[160:163], v[84:87], a[80:83], v[160:163]
 v_add_u32 v14, 0xfffe0000, v14
 ds_read_b64_tr_b16 v[80:81], v14 offset:0
 v_mfma_f32_16x16x32_bf16 v[164:167], v[84:87], a[84:87], v[164:167]
 ds_read_b64_tr_b16 v[82:83], v14 offset:512
 v_mfma_f32_16x16x32_bf16 v[168:171], v[84:87], a[88:91], v[168:171]
 s_mov_b32 s54, 3834240
 v_max_f32 v54, 0, v54
 v_mfma_f32_16x16x32_bf16 v[172:175], v[84:87], a[92:95], v[172:175]
 s_waitcnt lgkmcnt(4)
 v_mfma_f32_16x16x32_bf16 v[176:179], v[88:91], a[80:83], v[176:179]
 ds_read_b64_tr_b16 v[84:85], v14 offset:1024
 v_mfma_f32_16x16x32_bf16 v[180:183], v[88:91], a[84:87], v[180:183]
 ds_read_b64_tr_b16 v[86:87], v14 offset:1536
 v_mfma_f32_16x16x32_bf16 v[184:187], v[88:91], a[88:91], v[184:187]
 buffer_load_dwordx4 v4, s[16:19], s54 offen lds
 v_max_f32 v55, 0, v55
 v_mfma_f32_16x16x32_bf16 v[188:191], v[88:91], a[92:95], v[188:191]
 s_waitcnt lgkmcnt(4)
 v_mfma_f32_16x16x32_bf16 v[192:195], v[92:95], a[80:83], v[192:195]
 v_add_u32 v15, 0xfffe0000, v15
 ds_read_b64_tr_b16 v[88:89], v15 offset:0
 v_mfma_f32_16x16x32_bf16 v[196:199], v[92:95], a[84:87], v[196:199]
 ds_read_b64_tr_b16 v[90:91], v15 offset:512
 v_mfma_f32_16x16x32_bf16 v[200:203], v[92:95], a[88:91], v[200:203]
 buffer_load_dwordx4 v4, s[20:23], s54 offen offset:1024 lds
 v_mul_f32 v52, v52, v68
 v_mfma_f32_16x16x32_bf16 v[204:207], v[92:95], a[92:95], v[204:207]
 s_waitcnt lgkmcnt(4)
 v_mfma_f32_16x16x32_bf16 v[144:147], v[80:83], a[96:99], v[144:147]
 ds_read_b64_tr_b16 v[92:93], v15 offset:1024
 v_mfma_f32_16x16x32_bf16 v[148:151], v[80:83], a[100:103], v[148:151]
 ds_read_b64_tr_b16 v[94:95], v15 offset:1536
 v_mfma_f32_16x16x32_bf16 v[152:155], v[80:83], a[104:107], v[152:155]
 s_add_u32 m0, s53, 24576
 v_mul_f32 v53, v53, v69
 v_mfma_f32_16x16x32_bf16 v[156:159], v[80:83], a[108:111], v[156:159]
 s_waitcnt lgkmcnt(4)
 v_mfma_f32_16x16x32_bf16 v[160:163], v[84:87], a[96:99], v[160:163]
 ds_read_b64_tr_b16 v[80:81], v14 offset:40960
 v_mfma_f32_16x16x32_bf16 v[164:167], v[84:87], a[100:103], v[164:167]
 ds_read_b64_tr_b16 v[82:83], v14 offset:41472
 v_mfma_f32_16x16x32_bf16 v[168:171], v[84:87], a[104:107], v[168:171]
 s_mov_b32 s54, 4129152
 v_mul_f32 v54, v54, v70
 v_mfma_f32_16x16x32_bf16 v[172:175], v[84:87], a[108:111], v[172:175]
 s_waitcnt lgkmcnt(4)
 v_mfma_f32_16x16x32_bf16 v[176:179], v[88:91], a[96:99], v[176:179]
 ds_read_b64_tr_b16 v[84:85], v14 offset:41984
 v_mfma_f32_16x16x32_bf16 v[180:183], v[88:91], a[100:103], v[180:183]
 ds_read_b64_tr_b16 v[86:87], v14 offset:42496
 v_mfma_f32_16x16x32_bf16 v[184:187], v[88:91], a[104:107], v[184:187]
 buffer_load_dwordx4 v4, s[16:19], s54 offen lds
 v_mul_f32 v55, v55, v71
 v_mfma_f32_16x16x32_bf16 v[188:191], v[88:91], a[108:111], v[188:191]
 s_waitcnt lgkmcnt(4)
 v_mfma_f32_16x16x32_bf16 v[192:195], v[92:95], a[96:99], v[192:195]
 ds_read_b64_tr_b16 v[88:89], v15 offset:40960
 v_mfma_f32_16x16x32_bf16 v[196:199], v[92:95], a[100:103], v[196:199]
 ds_read_b64_tr_b16 v[90:91], v15 offset:41472
 v_mfma_f32_16x16x32_bf16 v[200:203], v[92:95], a[104:107], v[200:203]
 buffer_load_dwordx4 v4, s[20:23], s54 offen offset:1024 lds
 v_cvt_pk_bf16_f32 v214, v52, v53
 v_mfma_f32_16x16x32_bf16 v[204:207], v[92:95], a[108:111], v[204:207]
 s_waitcnt lgkmcnt(4)
 v_mfma_f32_16x16x32_bf16 v[144:147], v[80:83], a[112:115], v[144:147]
 ds_read_b64_tr_b16 v[92:93], v15 offset:41984
 v_mfma_f32_16x16x32_bf16 v[148:151], v[80:83], a[116:119], v[148:151]
 ds_read_b64_tr_b16 v[94:95], v15 offset:42496
 v_mfma_f32_16x16x32_bf16 v[152:155], v[80:83], a[120:123], v[152:155]
 s_add_u32 m0, s53, 32768
 v_cvt_pk_bf16_f32 v215, v54, v55
 v_mfma_f32_16x16x32_bf16 v[156:159], v[80:83], a[124:127], v[156:159]
 s_waitcnt lgkmcnt(4)
 v_mfma_f32_16x16x32_bf16 v[160:163], v[84:87], a[112:115], v[160:163]
 v_add_u32 v14, 0x20000, v14
 ds_read_b64_tr_b16 v[80:81], v14 offset:8192
 v_mfma_f32_16x16x32_bf16 v[164:167], v[84:87], a[116:119], v[164:167]
 ds_read_b64_tr_b16 v[82:83], v14 offset:8704
 v_mfma_f32_16x16x32_bf16 v[168:171], v[84:87], a[120:123], v[168:171]
 s_mov_b32 s54, 4424064
 ds_write_b128 v99, v[212:215] offset:33792
 v_mfma_f32_16x16x32_bf16 v[172:175], v[84:87], a[124:127], v[172:175]
 s_waitcnt lgkmcnt(5)
 v_mfma_f32_16x16x32_bf16 v[176:179], v[88:91], a[112:115], v[176:179]
 ds_read_b64_tr_b16 v[84:85], v14 offset:9216
 v_mfma_f32_16x16x32_bf16 v[180:183], v[88:91], a[116:119], v[180:183]
 ds_read_b64_tr_b16 v[86:87], v14 offset:9728
 v_mfma_f32_16x16x32_bf16 v[184:187], v[88:91], a[120:123], v[184:187]
 buffer_load_dwordx4 v4, s[16:19], s54 offen lds
 v_max_f32 v24, 0, v24
 v_mfma_f32_16x16x32_bf16 v[188:191], v[88:91], a[124:127], v[188:191]
 s_waitcnt lgkmcnt(5)
 v_mfma_f32_16x16x32_bf16 v[192:195], v[92:95], a[112:115], v[192:195]
 v_add_u32 v15, 0x20000, v15
 ds_read_b64_tr_b16 v[88:89], v15 offset:8192
 v_mfma_f32_16x16x32_bf16 v[196:199], v[92:95], a[116:119], v[196:199]
 ds_read_b64_tr_b16 v[90:91], v15 offset:8704
 v_mfma_f32_16x16x32_bf16 v[200:203], v[92:95], a[120:123], v[200:203]
 buffer_load_dwordx4 v4, s[20:23], s54 offen offset:1024 lds
 v_max_f32 v25, 0, v25
 v_mfma_f32_16x16x32_bf16 v[204:207], v[92:95], a[124:127], v[204:207]
 s_waitcnt lgkmcnt(5)
 v_mfma_f32_16x16x32_bf16 v[144:147], v[80:83], a[128:131], v[144:147]
 ds_read_b64_tr_b16 v[92:93], v15 offset:9216
 v_mfma_f32_16x16x32_bf16 v[148:151], v[80:83], a[132:135], v[148:151]
 ds_read_b64_tr_b16 v[94:95], v15 offset:9728
 v_mfma_f32_16x16x32_bf16 v[152:155], v[80:83], a[136:139], v[152:155]
 s_add_u32 m0, s53, 49152
 v_max_f32 v26, 0, v26
 v_mfma_f32_16x16x32_bf16 v[156:159], v[80:83], a[140:143], v[156:159]
 s_waitcnt vmcnt(8)
 s_barrier
 s_waitcnt lgkmcnt(4)
 v_mfma_f32_16x16x32_bf16 v[160:163], v[84:87], a[128:131], v[160:163]
 v_add_u32 v14, 0xfffe0000, v14
 ds_read_b64_tr_b16 v[80:81], v14 offset:8192
 v_mfma_f32_16x16x32_bf16 v[164:167], v[84:87], a[132:135], v[164:167]
 ds_read_b64_tr_b16 v[82:83], v14 offset:8704
 v_mfma_f32_16x16x32_bf16 v[168:171], v[84:87], a[136:139], v[168:171]
 s_mov_b32 s54, 4718976
 v_max_f32 v27, 0, v27
 v_mfma_f32_16x16x32_bf16 v[172:175], v[84:87], a[140:143], v[172:175]
 s_waitcnt lgkmcnt(4)
 v_mfma_f32_16x16x32_bf16 v[176:179], v[88:91], a[128:131], v[176:179]
 ds_read_b64_tr_b16 v[84:85], v14 offset:9216
 v_mfma_f32_16x16x32_bf16 v[180:183], v[88:91], a[132:135], v[180:183]
 ds_read_b64_tr_b16 v[86:87], v14 offset:9728
 v_mfma_f32_16x16x32_bf16 v[184:187], v[88:91], a[136:139], v[184:187]
 buffer_load_dwordx4 v4, s[16:19], s54 offen lds
 v_mul_f32 v24, v24, v40
 v_mfma_f32_16x16x32_bf16 v[188:191], v[88:91], a[140:143], v[188:191]
 s_waitcnt lgkmcnt(4)
 v_mfma_f32_16x16x32_bf16 v[192:195], v[92:95], a[128:131], v[192:195]
 v_add_u32 v15, 0xfffe0000, v15
 ds_read_b64_tr_b16 v[88:89], v15 offset:8192
 v_mfma_f32_16x16x32_bf16 v[196:199], v[92:95], a[132:135], v[196:199]
 ds_read_b64_tr_b16 v[90:91], v15 offset:8704
 v_mfma_f32_16x16x32_bf16 v[200:203], v[92:95], a[136:139], v[200:203]
 buffer_load_dwordx4 v4, s[20:23], s54 offen offset:1024 lds
 v_mul_f32 v25, v25, v41
 v_mfma_f32_16x16x32_bf16 v[204:207], v[92:95], a[140:143], v[204:207]
 s_waitcnt lgkmcnt(4)
 v_mfma_f32_16x16x32_bf16 v[144:147], v[80:83], a[144:147], v[144:147]
 ds_read_b64_tr_b16 v[92:93], v15 offset:9216
 v_mfma_f32_16x16x32_bf16 v[148:151], v[80:83], a[148:151], v[148:151]
 ds_read_b64_tr_b16 v[94:95], v15 offset:9728
 v_mfma_f32_16x16x32_bf16 v[152:155], v[80:83], a[152:155], v[152:155]
 s_add_u32 m0, s53, 155648
 v_mul_f32 v26, v26, v42
 v_mfma_f32_16x16x32_bf16 v[156:159], v[80:83], a[156:159], v[156:159]
 s_waitcnt lgkmcnt(4)
 v_mfma_f32_16x16x32_bf16 v[160:163], v[84:87], a[144:147], v[160:163]
 v_add_u32 v14, 0x10000, v14
 ds_read_b64_tr_b16 v[80:81], v14 offset:0
 v_mfma_f32_16x16x32_bf16 v[164:167], v[84:87], a[148:151], v[164:167]
 ds_read_b64_tr_b16 v[82:83], v14 offset:512
 v_mfma_f32_16x16x32_bf16 v[168:171], v[84:87], a[152:155], v[168:171]
 s_mov_b32 s54, 5013888
 v_mul_f32 v27, v27, v43
 v_mfma_f32_16x16x32_bf16 v[172:175], v[84:87], a[156:159], v[172:175]
 s_waitcnt lgkmcnt(4)
 v_mfma_f32_16x16x32_bf16 v[176:179], v[88:91], a[144:147], v[176:179]
 ds_read_b64_tr_b16 v[84:85], v14 offset:1024
 v_mfma_f32_16x16x32_bf16 v[180:183], v[88:91], a[148:151], v[180:183]
 ds_read_b64_tr_b16 v[86:87], v14 offset:1536
 v_mfma_f32_16x16x32_bf16 v[184:187], v[88:91], a[152:155], v[184:187]
 buffer_load_dwordx4 v4, s[16:19], s54 offen lds
 v_cvt_pk_bf16_f32 v208, v24, v25
 v_mfma_f32_16x16x32_bf16 v[188:191], v[88:91], a[156:159], v[188:191]
 s_waitcnt lgkmcnt(4)
 v_mfma_f32_16x16x32_bf16 v[192:195], v[92:95], a[144:147], v[192:195]
 v_add_u32 v15, 0x10000, v15
 ds_read_b64_tr_b16 v[88:89], v15 offset:0
 v_mfma_f32_16x16x32_bf16 v[196:199], v[92:95], a[148:151], v[196:199]
 ds_read_b64_tr_b16 v[90:91], v15 offset:512
 v_mfma_f32_16x16x32_bf16 v[200:203], v[92:95], a[152:155], v[200:203]
 buffer_load_dwordx4 v4, s[20:23], s54 offen offset:1024 lds
 v_cvt_pk_bf16_f32 v209, v26, v27
 v_mfma_f32_16x16x32_bf16 v[204:207], v[92:95], a[156:159], v[204:207]
 s_waitcnt lgkmcnt(4)
 v_mfma_f32_16x16x32_bf16 v[144:147], v[80:83], a[160:163], v[144:147]
 ds_read_b64_tr_b16 v[92:93], v15 offset:1024
 v_mfma_f32_16x16x32_bf16 v[148:151], v[80:83], a[164:167], v[148:151]
 ds_read_b64_tr_b16 v[94:95], v15 offset:1536
 v_mfma_f32_16x16x32_bf16 v[152:155], v[80:83], a[168:171], v[152:155]
 s_add_u32 m0, s53, 0
 v_max_f32 v56, 0, v56
 v_mfma_f32_16x16x32_bf16 v[156:159], v[80:83], a[172:175], v[156:159]
 s_waitcnt lgkmcnt(4)
 v_mfma_f32_16x16x32_bf16 v[160:163], v[84:87], a[160:163], v[160:163]
 v_add_u32 v14, 0x10000, v14
 ds_read_b64_tr_b16 v[80:81], v14 offset:16384
 v_mfma_f32_16x16x32_bf16 v[164:167], v[84:87], a[164:167], v[164:167]
 ds_read_b64_tr_b16 v[82:83], v14 offset:16896
 v_mfma_f32_16x16x32_bf16 v[168:171], v[84:87], a[168:171], v[168:171]
 s_mov_b32 s54, 0
 v_max_f32 v57, 0, v57
 v_mfma_f32_16x16x32_bf16 v[172:175], v[84:87], a[172:175], v[172:175]
 s_waitcnt lgkmcnt(4)
 v_mfma_f32_16x16x32_bf16 v[176:179], v[88:91], a[160:163], v[176:179]
 ds_read_b64_tr_b16 v[84:85], v14 offset:17408
 v_mfma_f32_16x16x32_bf16 v[180:183], v[88:91], a[164:167], v[180:183]
 ds_read_b64_tr_b16 v[86:87], v14 offset:17920
 v_mfma_f32_16x16x32_bf16 v[184:187], v[88:91], a[168:171], v[184:187]
 buffer_load_dwordx4 v5, s[16:19], s54 offen lds
 v_max_f32 v58, 0, v58
 v_mfma_f32_16x16x32_bf16 v[188:191], v[88:91], a[172:175], v[188:191]
 s_waitcnt lgkmcnt(4)
 v_mfma_f32_16x16x32_bf16 v[192:195], v[92:95], a[160:163], v[192:195]
 v_add_u32 v15, 0x10000, v15
 ds_read_b64_tr_b16 v[88:89], v15 offset:16384
 v_mfma_f32_16x16x32_bf16 v[196:199], v[92:95], a[164:167], v[196:199]
 ds_read_b64_tr_b16 v[90:91], v15 offset:16896
 v_mfma_f32_16x16x32_bf16 v[200:203], v[92:95], a[168:171], v[200:203]
 buffer_load_dwordx4 v5, s[20:23], s54 offen offset:1024 lds
 v_max_f32 v59, 0, v59
 v_mfma_f32_16x16x32_bf16 v[204:207], v[92:95], a[172:175], v[204:207]
 s_waitcnt lgkmcnt(4)
 v_mfma_f32_16x16x32_bf16 v[144:147], v[80:83], a[176:179], v[144:147]
 ds_read_b64_tr_b16 v[92:93], v15 offset:17408
 v_mfma_f32_16x16x32_bf16 v[148:151], v[80:83], a[180:183], v[148:151]
 ds_read_b64_tr_b16 v[94:95], v15 offset:17920
 v_mfma_f32_16x16x32_bf16 v[152:155], v[80:83], a[184:187], v[152:155]
 s_add_u32 m0, s53, 40960
 v_mul_f32 v56, v56, v72
 v_mfma_f32_16x16x32_bf16 v[156:159], v[80:83], a[188:191], v[156:159]
 s_waitcnt vmcnt(8)
 s_barrier
 s_waitcnt lgkmcnt(4)
 v_mfma_f32_16x16x32_bf16 v[160:163], v[84:87], a[176:179], v[160:163]
 v_add_u32 v14, 0xfffe0000, v14
 ds_read_b64_tr_b16 v[80:81], v14 offset:16384
 v_mfma_f32_16x16x32_bf16 v[164:167], v[84:87], a[180:183], v[164:167]
 ds_read_b64_tr_b16 v[82:83], v14 offset:16896
 v_mfma_f32_16x16x32_bf16 v[168:171], v[84:87], a[184:187], v[168:171]
 s_mov_b32 s54, 589824
 v_mul_f32 v57, v57, v73
 v_mfma_f32_16x16x32_bf16 v[172:175], v[84:87], a[188:191], v[172:175]
 s_waitcnt lgkmcnt(4)
 v_mfma_f32_16x16x32_bf16 v[176:179], v[88:91], a[176:179], v[176:179]
 ds_read_b64_tr_b16 v[84:85], v14 offset:17408
 v_mfma_f32_16x16x32_bf16 v[180:183], v[88:91], a[180:183], v[180:183]
 ds_read_b64_tr_b16 v[86:87], v14 offset:17920
 v_mfma_f32_16x16x32_bf16 v[184:187], v[88:91], a[184:187], v[184:187]
 buffer_load_dwordx4 v5, s[16:19], s54 offen lds
 v_mul_f32 v58, v58, v74
 v_mfma_f32_16x16x32_bf16 v[188:191], v[88:91], a[188:191], v[188:191]
 s_waitcnt lgkmcnt(4)
 v_mfma_f32_16x16x32_bf16 v[192:195], v[92:95], a[176:179], v[192:195]
 v_add_u32 v15, 0xfffe0000, v15
 ds_read_b64_tr_b16 v[88:89], v15 offset:16384
 v_mfma_f32_16x16x32_bf16 v[196:199], v[92:95], a[180:183], v[196:199]
 ds_read_b64_tr_b16 v[90:91], v15 offset:16896
 v_mfma_f32_16x16x32_bf16 v[200:203], v[92:95], a[184:187], v[200:203]
 buffer_load_dwordx4 v5, s[20:23], s54 offen offset:1024 lds
 v_mul_f32 v59, v59, v75
 v_mfma_f32_16x16x32_bf16 v[204:207], v[92:95], a[188:191], v[204:207]
 s_waitcnt lgkmcnt(4)
 v_mfma_f32_16x16x32_bf16 v[144:147], v[80:83], a[192:195], v[144:147]
 ds_read_b64_tr_b16 v[92:93], v15 offset:17408
 v_mfma_f32_16x16x32_bf16 v[148:151], v[80:83], a[196:199], v[148:151]
 ds_read_b64_tr_b16 v[94:95], v15 offset:17920
 v_mfma_f32_16x16x32_bf16 v[152:155], v[80:83], a[200:203], v[152:155]
 s_add_u32 m0, s53, 8192
 v_cvt_pk_bf16_f32 v210, v56, v57
 v_mfma_f32_16x16x32_bf16 v[156:159], v[80:83], a[204:207], v[156:159]
 s_waitcnt lgkmcnt(4)
 v_mfma_f32_16x16x32_bf16 v[160:163], v[84:87], a[192:195], v[160:163]
 ds_read_b64_tr_b16 v[80:81], v14 offset:57344
 v_mfma_f32_16x16x32_bf16 v[164:167], v[84:87], a[196:199], v[164:167]
 ds_read_b64_tr_b16 v[82:83], v14 offset:57856
 v_mfma_f32_16x16x32_bf16 v[168:171], v[84:87], a[200:203], v[168:171]
 s_mov_b32 s54, 1179648
 v_cvt_pk_bf16_f32 v211, v58, v59
 v_mfma_f32_16x16x32_bf16 v[172:175], v[84:87], a[204:207], v[172:175]
 s_waitcnt lgkmcnt(4)
 v_mfma_f32_16x16x32_bf16 v[176:179], v[88:91], a[192:195], v[176:179]
 ds_read_b64_tr_b16 v[84:85], v14 offset:58368
 v_mfma_f32_16x16x32_bf16 v[180:183], v[88:91], a[196:199], v[180:183]
 ds_read_b64_tr_b16 v[86:87], v14 offset:58880
 v_mfma_f32_16x16x32_bf16 v[184:187], v[88:91], a[200:203], v[184:187]
 buffer_load_dwordx4 v5, s[16:19], s54 offen lds
 ds_write_b128 v99, v[208:211] offset:34816
 v_mfma_f32_16x16x32_bf16 v[188:191], v[88:91], a[204:207], v[188:191]
 s_waitcnt lgkmcnt(5)
 v_mfma_f32_16x16x32_bf16 v[192:195], v[92:95], a[192:195], v[192:195]
 ds_read_b64_tr_b16 v[88:89], v15 offset:57344
 v_mfma_f32_16x16x32_bf16 v[196:199], v[92:95], a[196:199], v[196:199]
 ds_read_b64_tr_b16 v[90:91], v15 offset:57856
 v_mfma_f32_16x16x32_bf16 v[200:203], v[92:95], a[200:203], v[200:203]
 buffer_load_dwordx4 v5, s[20:23], s54 offen offset:1024 lds
 v_max_f32 v28, 0, v28
 v_mfma_f32_16x16x32_bf16 v[204:207], v[92:95], a[204:207], v[204:207]
 s_waitcnt lgkmcnt(5)
 v_mfma_f32_16x16x32_bf16 v[144:147], v[80:83], a[208:211], v[144:147]
 ds_read_b64_tr_b16 v[92:93], v15 offset:58368
 v_mfma_f32_16x16x32_bf16 v[148:151], v[80:83], a[212:215], v[148:151]
 ds_read_b64_tr_b16 v[94:95], v15 offset:58880
 v_mfma_f32_16x16x32_bf16 v[152:155], v[80:83], a[216:219], v[152:155]
 s_add_u32 m0, s53, 65536
 v_max_f32 v29, 0, v29
 v_mfma_f32_16x16x32_bf16 v[156:159], v[80:83], a[220:223], v[156:159]
 s_waitcnt lgkmcnt(5)
 v_mfma_f32_16x16x32_bf16 v[160:163], v[84:87], a[208:211], v[160:163]
 ds_read_b64_tr_b16 v[80:81], v14 offset:24576
 v_mfma_f32_16x16x32_bf16 v[164:167], v[84:87], a[212:215], v[164:167]
 ds_read_b64_tr_b16 v[82:83], v14 offset:25088
 v_mfma_f32_16x16x32_bf16 v[168:171], v[84:87], a[216:219], v[168:171]
 s_mov_b32 s54, 1769472
 v_max_f32 v30, 0, v30
 v_mfma_f32_16x16x32_bf16 v[172:175], v[84:87], a[220:223], v[172:175]
 s_waitcnt lgkmcnt(4)
 v_mfma_f32_16x16x32_bf16 v[176:179], v[88:91], a[208:211], v[176:179]
 ds_read_b64_tr_b16 v[84:85], v14 offset:25600
 v_mfma_f32_16x16x32_bf16 v[180:183], v[88:91], a[212:215], v[180:183]
 ds_read_b64_tr_b16 v[86:87], v14 offset:26112
 v_mfma_f32_16x16x32_bf16 v[184:187], v[88:91], a[216:219], v[184:187]
 buffer_load_dwordx4 v5, s[16:19], s54 offen lds
 v_max_f32 v31, 0, v31
 v_mfma_f32_16x16x32_bf16 v[188:191], v[88:91], a[220:223], v[188:191]
 s_waitcnt lgkmcnt(4)
 v_mfma_f32_16x16x32_bf16 v[192:195], v[92:95], a[208:211], v[192:195]
 ds_read_b64_tr_b16 v[88:89], v15 offset:24576
 v_mfma_f32_16x16x32_bf16 v[196:199], v[92:95], a[212:215], v[196:199]
 ds_read_b64_tr_b16 v[90:91], v15 offset:25088
 v_mfma_f32_16x16x32_bf16 v[200:203], v[92:95], a[216:219], v[200:203]
 buffer_load_dwordx4 v5, s[20:23], s54 offen offset:1024 lds
 v_mul_f32 v28, v28, v44
 v_mfma_f32_16x16x32_bf16 v[204:207], v[92:95], a[220:223], v[204:207]
 s_waitcnt lgkmcnt(4)
 v_mfma_f32_16x16x32_bf16 v[144:147], v[80:83], a[224:227], v[144:147]
 ds_read_b64_tr_b16 v[92:93], v15 offset:25600
 v_mfma_f32_16x16x32_bf16 v[148:151], v[80:83], a[228:231], v[148:151]
 ds_read_b64_tr_b16 v[94:95], v15 offset:26112
 v_mfma_f32_16x16x32_bf16 v[152:155], v[80:83], a[232:235], v[152:155]
 s_add_u32 m0, s53, 73728
 v_mul_f32 v29, v29, v45
 v_mfma_f32_16x16x32_bf16 v[156:159], v[80:83], a[236:239], v[156:159]
 s_waitcnt vmcnt(8)
 s_barrier
 s_waitcnt lgkmcnt(4)
 v_mfma_f32_16x16x32_bf16 v[160:163], v[84:87], a[224:227], v[160:163]
 ds_read_b64_tr_b16 v[80:81], v14 offset:32768
 v_mfma_f32_16x16x32_bf16 v[164:167], v[84:87], a[228:231], v[164:167]
 ds_read_b64_tr_b16 v[82:83], v14 offset:33280
 v_mfma_f32_16x16x32_bf16 v[168:171], v[84:87], a[232:235], v[168:171]
 s_mov_b32 s54, 2359296
 v_mul_f32 v30, v30, v46
 v_mfma_f32_16x16x32_bf16 v[172:175], v[84:87], a[236:239], v[172:175]
 s_waitcnt lgkmcnt(4)
 v_mfma_f32_16x16x32_bf16 v[176:179], v[88:91], a[224:227], v[176:179]
 ds_read_b64_tr_b16 v[84:85], v14 offset:33792
 v_mfma_f32_16x16x32_bf16 v[180:183], v[88:91], a[228:231], v[180:183]
 ds_read_b64_tr_b16 v[86:87], v14 offset:34304
 v_mfma_f32_16x16x32_bf16 v[184:187], v[88:91], a[232:235], v[184:187]
 buffer_load_dwordx4 v5, s[16:19], s54 offen lds
 v_mul_f32 v31, v31, v47
 v_mfma_f32_16x16x32_bf16 v[188:191], v[88:91], a[236:239], v[188:191]
 s_waitcnt lgkmcnt(4)
 v_mfma_f32_16x16x32_bf16 v[192:195], v[92:95], a[224:227], v[192:195]
 ds_read_b64_tr_b16 v[88:89], v15 offset:32768
 v_mfma_f32_16x16x32_bf16 v[196:199], v[92:95], a[228:231], v[196:199]
 ds_read_b64_tr_b16 v[90:91], v15 offset:33280
 v_mfma_f32_16x16x32_bf16 v[200:203], v[92:95], a[232:235], v[200:203]
 buffer_load_dwordx4 v5, s[20:23], s54 offen offset:1024 lds
 v_cvt_pk_bf16_f32 v212, v28, v29
 v_mfma_f32_16x16x32_bf16 v[204:207], v[92:95], a[236:239], v[204:207]
 s_waitcnt lgkmcnt(4)
 v_mfma_f32_16x16x32_bf16 v[144:147], v[80:83], a[240:243], v[144:147]
 ds_read_b64_tr_b16 v[92:93], v15 offset:33792
 v_mfma_f32_16x16x32_bf16 v[148:151], v[80:83], a[244:247], v[148:151]
 ds_read_b64_tr_b16 v[94:95], v15 offset:34304
 v_mfma_f32_16x16x32_bf16 v[152:155], v[80:83], a[248:251], v[152:155]
 s_add_u32 m0, s53, 16384
 v_cvt_pk_bf16_f32 v213, v30, v31
 v_mfma_f32_16x16x32_bf16 v[156:159], v[80:83], a[252:255], v[156:159]
 s_waitcnt lgkmcnt(4)
 v_mfma_f32_16x16x32_bf16 v[160:163], v[84:87], a[240:243], v[160:163]
 ds_read_b64_tr_b16 v[80:81], v14 offset:49152
 v_mfma_f32_16x16x32_bf16 v[164:167], v[84:87], a[244:247], v[164:167]
 ds_read_b64_tr_b16 v[82:83], v14 offset:49664
 v_mfma_f32_16x16x32_bf16 v[168:171], v[84:87], a[248:251], v[168:171]
 s_mov_b32 s54, 2949120
 v_max_f32 v60, 0, v60
 v_mfma_f32_16x16x32_bf16 v[172:175], v[84:87], a[252:255], v[172:175]
 s_waitcnt lgkmcnt(4)
 v_mfma_f32_16x16x32_bf16 v[176:179], v[88:91], a[240:243], v[176:179]
 ds_read_b64_tr_b16 v[84:85], v14 offset:50176
 v_mfma_f32_16x16x32_bf16 v[180:183], v[88:91], a[244:247], v[180:183]
 ds_read_b64_tr_b16 v[86:87], v14 offset:50688
 v_mfma_f32_16x16x32_bf16 v[184:187], v[88:91], a[248:251], v[184:187]
 buffer_load_dwordx4 v5, s[16:19], s54 offen lds
 v_max_f32 v61, 0, v61
 v_mfma_f32_16x16x32_bf16 v[188:191], v[88:91], a[252:255], v[188:191]
 s_waitcnt lgkmcnt(4)
 v_mfma_f32_16x16x32_bf16 v[192:195], v[92:95], a[240:243], v[192:195]
 ds_read_b64_tr_b16 v[88:89], v15 offset:49152
 v_mfma_f32_16x16x32_bf16 v[196:199], v[92:95], a[244:247], v[196:199]
 ds_read_b64_tr_b16 v[90:91], v15 offset:49664
 v_mfma_f32_16x16x32_bf16 v[200:203], v[92:95], a[248:251], v[200:203]
 buffer_load_dwordx4 v5, s[20:23], s54 offen offset:1024 lds
 v_max_f32 v62, 0, v62
 v_mfma_f32_16x16x32_bf16 v[204:207], v[92:95], a[252:255], v[204:207]
 s_waitcnt lgkmcnt(4)
 v_mfma_f32_16x16x32_bf16 v[144:147], v[80:83], v[112:115], v[144:147]
 ds_read_b64_tr_b16 v[92:93], v15 offset:50176
 v_mfma_f32_16x16x32_bf16 v[148:151], v[80:83], v[116:119], v[148:151]
 ds_read_b64_tr_b16 v[94:95], v15 offset:50688
 v_mfma_f32_16x16x32_bf16 v[152:155], v[80:83], v[120:123], v[152:155]
 s_add_u32 m0, s53, 57344
 v_max_f32 v63, 0, v63
 v_mfma_f32_16x16x32_bf16 v[156:159], v[80:83], v[124:127], v[156:159]
 s_waitcnt lgkmcnt(4)
 v_mfma_f32_16x16x32_bf16 v[160:163], v[84:87], v[112:115], v[160:163]
 v_add_u32 v14, 0x20000, v14
 ds_read_b64_tr_b16 v[80:81], v14 offset:24576
 v_mfma_f32_16x16x32_bf16 v[164:167], v[84:87], v[116:119], v[164:167]
 ds_read_b64_tr_b16 v[82:83], v14 offset:25088
 v_mfma_f32_16x16x32_bf16 v[168:171], v[84:87], v[120:123], v[168:171]
 s_mov_b32 s54, 3538944
 v_mul_f32 v60, v60, v76
 v_mfma_f32_16x16x32_bf16 v[172:175], v[84:87], v[124:127], v[172:175]
 s_waitcnt lgkmcnt(4)
 v_mfma_f32_16x16x32_bf16 v[176:179], v[88:91], v[112:115], v[176:179]
 ds_read_b64_tr_b16 v[84:85], v14 offset:25600
 v_mfma_f32_16x16x32_bf16 v[180:183], v[88:91], v[116:119], v[180:183]
 ds_read_b64_tr_b16 v[86:87], v14 offset:26112
 v_mfma_f32_16x16x32_bf16 v[184:187], v[88:91], v[120:123], v[184:187]
 buffer_load_dwordx4 v5, s[16:19], s54 offen lds
 v_mul_f32 v61, v61, v77
 v_mfma_f32_16x16x32_bf16 v[188:191], v[88:91], v[124:127], v[188:191]
 s_waitcnt lgkmcnt(4)
 v_mfma_f32_16x16x32_bf16 v[192:195], v[92:95], v[112:115], v[192:195]
 v_add_u32 v15, 0x20000, v15
 ds_read_b64_tr_b16 v[88:89], v15 offset:24576
 v_mfma_f32_16x16x32_bf16 v[196:199], v[92:95], v[116:119], v[196:199]
 ds_read_b64_tr_b16 v[90:91], v15 offset:25088
 v_mfma_f32_16x16x32_bf16 v[200:203], v[92:95], v[120:123], v[200:203]
 buffer_load_dwordx4 v5, s[20:23], s54 offen offset:1024 lds
 v_mul_f32 v62, v62, v78
 v_mfma_f32_16x16x32_bf16 v[204:207], v[92:95], v[124:127], v[204:207]
 s_waitcnt lgkmcnt(4)
 v_mfma_f32_16x16x32_bf16 v[144:147], v[80:83], v[128:131], v[144:147]
 ds_read_b64_tr_b16 v[92:93], v15 offset:25600
 v_mfma_f32_16x16x32_bf16 v[148:151], v[80:83], v[132:135], v[148:151]
 ds_read_b64_tr_b16 v[94:95], v15 offset:26112
 v_mfma_f32_16x16x32_bf16 v[152:155], v[80:83], v[136:139], v[152:155]
 s_add_u32 m0, s53, 81920
 v_mul_f32 v63, v63, v79
 v_mfma_f32_16x16x32_bf16 v[156:159], v[80:83], v[140:143], v[156:159]
 s_waitcnt vmcnt(8)
 s_barrier
 s_waitcnt lgkmcnt(4)
 v_mfma_f32_16x16x32_bf16 v[160:163], v[84:87], v[128:131], v[160:163]
 ds_read_b64_tr_b16 v[80:81], v96 offset:0
 v_mfma_f32_16x16x32_bf16 v[164:167], v[84:87], v[132:135], v[164:167]
 ds_read_b64_tr_b16 v[82:83], v96 offset:256
 v_mfma_f32_16x16x32_bf16 v[168:171], v[84:87], v[136:139], v[168:171]
 s_mov_b32 s54, 4128768
 v_cvt_pk_bf16_f32 v214, v60, v61
 v_mfma_f32_16x16x32_bf16 v[172:175], v[84:87], v[140:143], v[172:175]
 s_waitcnt lgkmcnt(4)
 v_mfma_f32_16x16x32_bf16 v[176:179], v[88:91], v[128:131], v[176:179]
 ds_read_b64_tr_b16 v[84:85], v96 offset:1024
 v_mfma_f32_16x16x32_bf16 v[180:183], v[88:91], v[132:135], v[180:183]
 ds_read_b64_tr_b16 v[86:87], v96 offset:1280
 v_mfma_f32_16x16x32_bf16 v[184:187], v[88:91], v[136:139], v[184:187]
 buffer_load_dwordx4 v5, s[16:19], s54 offen lds
 v_cvt_pk_bf16_f32 v215, v62, v63
 v_mfma_f32_16x16x32_bf16 v[188:191], v[88:91], v[140:143], v[188:191]
 s_waitcnt lgkmcnt(4)
 v_mfma_f32_16x16x32_bf16 v[192:195], v[92:95], v[128:131], v[192:195]
 ds_read_b64_tr_b16 v[88:89], v96 offset:4096
 v_mfma_f32_16x16x32_bf16 v[196:199], v[92:95], v[132:135], v[196:199]
 ds_read_b64_tr_b16 v[90:91], v96 offset:4352
 v_mfma_f32_16x16x32_bf16 v[200:203], v[92:95], v[136:139], v[200:203]
 buffer_load_dwordx4 v5, s[20:23], s54 offen offset:1024 lds
 ds_write_b128 v99, v[212:215] offset:35840
 v_mfma_f32_16x16x32_bf16 v[204:207], v[92:95], v[140:143], v[204:207]
 s_waitcnt lgkmcnt(5)
 v_mfma_f32_16x16x32_bf16 v[16:19], v[80:83], a[0:3], 0
 ds_read_b64_tr_b16 v[92:93], v96 offset:5120
 v_max_f32 v144, 0, v144
 v_mfma_f32_16x16x32_bf16 v[20:23], v[80:83], a[4:7], 0
 ds_read_b64_tr_b16 v[94:95], v96 offset:5376
 v_mfma_f32_16x16x32_bf16 v[24:27], v[80:83], a[8:11], 0
 s_add_u32 m0, s53, 24576
 v_max_f32 v145, 0, v145
 v_mfma_f32_16x16x32_bf16 v[28:31], v[80:83], a[12:15], 0
 v_max_f32 v146, 0, v146
 s_waitcnt lgkmcnt(5)
 v_mfma_f32_16x16x32_bf16 v[32:35], v[84:87], a[0:3], 0
 ds_read_b64_tr_b16 v[80:81], v96 offset:40960
 v_max_f32 v147, 0, v147
 v_mfma_f32_16x16x32_bf16 v[36:39], v[84:87], a[4:7], 0
 ds_read_b64_tr_b16 v[82:83], v96 offset:41216
 v_mfma_f32_16x16x32_bf16 v[40:43], v[84:87], a[8:11], 0
 s_mov_b32 s54, 4718592
 v_mul_f32 v144, v144, v160
 v_mfma_f32_16x16x32_bf16 v[44:47], v[84:87], a[12:15], 0
 v_mul_f32 v145, v145, v161
 s_waitcnt lgkmcnt(5)
 v_mfma_f32_16x16x32_bf16 v[16:19], v[88:91], a[16:19], v[16:19]
 ds_read_b64_tr_b16 v[84:85], v96 offset:41984
 v_mul_f32 v146, v146, v162
 v_mfma_f32_16x16x32_bf16 v[20:23], v[88:91], a[20:23], v[20:23]
 ds_read_b64_tr_b16 v[86:87], v96 offset:42240
 v_mfma_f32_16x16x32_bf16 v[24:27], v[88:91], a[24:27], v[24:27]
 buffer_load_dwordx4 v5, s[16:19], s54 offen lds
 v_mul_f32 v147, v147, v163
 v_mfma_f32_16x16x32_bf16 v[28:31], v[88:91], a[28:31], v[28:31]
 v_cvt_pk_bf16_f32 v208, v144, v145
 s_waitcnt lgkmcnt(4)
 v_mfma_f32_16x16x32_bf16 v[32:35], v[92:95], a[16:19], v[32:35]
 ds_read_b64_tr_b16 v[88:89], v96 offset:45056
 v_cvt_pk_bf16_f32 v209, v146, v147
 v_mfma_f32_16x16x32_bf16 v[36:39], v[92:95], a[20:23], v[36:39]
 ds_read_b64_tr_b16 v[90:91], v96 offset:45312
 v_mfma_f32_16x16x32_bf16 v[40:43], v[92:95], a[24:27], v[40:43]
 buffer_load_dwordx4 v5, s[20:23], s54 offen offset:1024 lds
 v_max_f32 v176, 0, v176
 v_mfma_f32_16x16x32_bf16 v[44:47], v[92:95], a[28:31], v[44:47]
 v_max_f32 v177, 0, v177
 s_waitcnt lgkmcnt(4)
 v_mfma_f32_16x16x32_bf16 v[16:19], v[80:83], a[32:35], v[16:19]
 ds_read_b64_tr_b16 v[92:93], v96 offset:46080
 v_max_f32 v178, 0, v178
 v_mfma_f32_16x16x32_bf16 v[20:23], v[80:83], a[36:39], v[20:23]
 ds_read_b64_tr_b16 v[94:95], v96 offset:46336
 v_mfma_f32_16x16x32_bf16 v[24:27], v[80:83], a[40:43], v[24:27]
 s_add_u32 m0, s53, 32768
 v_max_f32 v179, 0, v179
 v_mfma_f32_16x16x32_bf16 v[28:31], v[80:83], a[44:47], v[28:31]
 v_mul_f32 v176, v176, v192
 s_waitcnt lgkmcnt(4)
 v_mfma_f32_16x16x32_bf16 v[32:35], v[84:87], a[32:35], v[32:35]
 ds_read_b64_tr_b16 v[80:81], v96 offset:8192
 v_mul_f32 v177, v177, v193
 v_mfma_f32_16x16x32_bf16 v[36:39], v[84:87], a[36:39], v[36:39]
 ds_read_b64_tr_b16 v[82:83], v96 offset:8448
 v_mfma_f32_16x16x32_bf16 v[40:43], v[84:87], a[40:43], v[40:43]
 s_add_u32 s54, s55, 0
 v_mul_f32 v178, v178, v194
 v_mfma_f32_16x16x32_bf16 v[44:47], v[84:87], a[44:47], v[44:47]
 v_mul_f32 v179, v179, v195
 s_waitcnt lgkmcnt(4)
 v_mfma_f32_16x16x32_bf16 v[16:19], v[88:91], a[48:51], v[16:19]
 ds_read_b64_tr_b16 v[84:85], v96 offset:9216
 v_cvt_pk_bf16_f32 v210, v176, v177
 v_mfma_f32_16x16x32_bf16 v[20:23], v[88:91], a[52:55], v[20:23]
 ds_read_b64_tr_b16 v[86:87], v96 offset:9472
 v_mfma_f32_16x16x32_bf16 v[24:27], v[88:91], a[56:59], v[24:27]
 buffer_load_dwordx4 v6, s[24:27], s54 offen lds
 v_cvt_pk_bf16_f32 v211, v178, v179
 v_mfma_f32_16x16x32_bf16 v[28:31], v[88:91], a[60:63], v[28:31]
 ds_write_b128 v99, v[208:211] offset:49152
 s_waitcnt lgkmcnt(5)
 v_mfma_f32_16x16x32_bf16 v[32:35], v[92:95], a[48:51], v[32:35]
 ds_read_b64_tr_b16 v[88:89], v96 offset:12288
 v_max_f32 v148, 0, v148
 v_mfma_f32_16x16x32_bf16 v[36:39], v[92:95], a[52:55], v[36:39]
 ds_read_b64_tr_b16 v[90:91], v96 offset:12544
 v_mfma_f32_16x16x32_bf16 v[40:43], v[92:95], a[56:59], v[40:43]
 buffer_load_dwordx4 v7, s[24:27], s54 offen offset:1024 lds
 v_max_f32 v149, 0, v149
 v_mfma_f32_16x16x32_bf16 v[44:47], v[92:95], a[60:63], v[44:47]
 v_max_f32 v150, 0, v150
 s_waitcnt lgkmcnt(5)
 v_mfma_f32_16x16x32_bf16 v[16:19], v[80:83], a[64:67], v[16:19]
 ds_read_b64_tr_b16 v[92:93], v96 offset:13312
 v_max_f32 v151, 0, v151
 v_mfma_f32_16x16x32_bf16 v[20:23], v[80:83], a[68:71], v[20:23]
 ds_read_b64_tr_b16 v[94:95], v96 offset:13568
 v_mfma_f32_16x16x32_bf16 v[24:27], v[80:83], a[72:75], v[24:27]
 s_add_u32 m0, s53, 49152
 v_mul_f32 v148, v148, v164
 v_mfma_f32_16x16x32_bf16 v[28:31], v[80:83], a[76:79], v[28:31]
 v_mul_f32 v149, v149, v165
 s_waitcnt vmcnt(8)
 s_barrier
 s_waitcnt lgkmcnt(5)
 v_mfma_f32_16x16x32_bf16 v[32:35], v[84:87], a[64:67], v[32:35]
 v_add_u32 v96, 0x10000, v96
 ds_read_b64_tr_b16 v[80:81], v96 offset:0
 v_mul_f32 v150, v150, v166
 v_mfma_f32_16x16x32_bf16 v[36:39], v[84:87], a[68:71], v[36:39]
 ds_read_b64_tr_b16 v[82:83], v96 offset:256
 v_mfma_f32_16x16x32_bf16 v[40:43], v[84:87], a[72:75], v[40:43]
 s_add_u32 s54, s55, 36864
 v_mul_f32 v151, v151, v167
 v_mfma_f32_16x16x32_bf16 v[44:47], v[84:87], a[76:79], v[44:47]
 v_cvt_pk_bf16_f32 v212, v148, v149
 s_waitcnt lgkmcnt(4)
 v_mfma_f32_16x16x32_bf16 v[16:19], v[88:91], a[80:83], v[16:19]
 ds_read_b64_tr_b16 v[84:85], v96 offset:1024
 v_cvt_pk_bf16_f32 v213, v150, v151
 v_mfma_f32_16x16x32_bf16 v[20:23], v[88:91], a[84:87], v[20:23]
 ds_read_b64_tr_b16 v[86:87], v96 offset:1280
 v_mfma_f32_16x16x32_bf16 v[24:27], v[88:91], a[88:91], v[24:27]
 buffer_load_dwordx4 v6, s[24:27], s54 offen lds
 v_max_f32 v180, 0, v180
 v_mfma_f32_16x16x32_bf16 v[28:31], v[88:91], a[92:95], v[28:31]
 v_max_f32 v181, 0, v181
 s_waitcnt lgkmcnt(4)
 v_mfma_f32_16x16x32_bf16 v[32:35], v[92:95], a[80:83], v[32:35]
 ds_read_b64_tr_b16 v[88:89], v96 offset:4096
 v_max_f32 v182, 0, v182
 v_mfma_f32_16x16x32_bf16 v[36:39], v[92:95], a[84:87], v[36:39]
 ds_read_b64_tr_b16 v[90:91], v96 offset:4352
 v_mfma_f32_16x16x32_bf16 v[40:43], v[92:95], a[88:91], v[40:43]
 buffer_load_dwordx4 v7, s[24:27], s54 offen offset:1024 lds
 v_max_f32 v183, 0, v183
 v_mfma_f32_16x16x32_bf16 v[44:47], v[92:95], a[92:95], v[44:47]
 v_mul_f32 v180, v180, v196
 s_waitcnt lgkmcnt(4)
 v_mfma_f32_16x16x32_bf16 v[16:19], v[80:83], a[96:99], v[16:19]
 ds_read_b64_tr_b16 v[92:93], v96 offset:5120
 v_mul_f32 v181, v181, v197
 v_mfma_f32_16x16x32_bf16 v[20:23], v[80:83], a[100:103], v[20:23]
 ds_read_b64_tr_b16 v[94:95], v96 offset:5376
 v_mfma_f32_16x16x32_bf16 v[24:27], v[80:83], a[104:107], v[24:27]
 s_add_u32 m0, s53, 0
 v_mul_f32 v182, v182, v198
 v_mfma_f32_16x16x32_bf16 v[28:31], v[80:83], a[108:111], v[28:31]
 v_mul_f32 v183, v183, v199
 s_waitcnt lgkmcnt(4)
 v_mfma_f32_16x16x32_bf16 v[32:35], v[84:87], a[96:99], v[32:35]
 ds_read_b64_tr_b16 v[80:81], v96 offset:8192
 v_cvt_pk_bf16_f32 v214, v180, v181
 v_mfma_f32_16x16x32_bf16 v[36:39], v[84:87], a[100:103], v[36:39]
 ds_read_b64_tr_b16 v[82:83], v96 offset:8448
 v_mfma_f32_16x16x32_bf16 v[40:43], v[84:87], a[104:107], v[40:43]
 s_add_u32 s54, s55, 73728
 v_cvt_pk_bf16_f32 v215, v182, v183
 v_mfma_f32_16x16x32_bf16 v[44:47], v[84:87], a[108:111], v[44:47]
 ds_write_b128 v99, v[212:215] offset:50176
 s_waitcnt lgkmcnt(5)
 v_mfma_f32_16x16x32_bf16 v[16:19], v[88:91], a[112:115], v[16:19]
 ds_read_b64_tr_b16 v[84:85], v96 offset:9216
 v_max_f32 v152, 0, v152
 v_mfma_f32_16x16x32_bf16 v[20:23], v[88:91], a[116:119], v[20:23]
 ds_read_b64_tr_b16 v[86:87], v96 offset:9472
 v_mfma_f32_16x16x32_bf16 v[24:27], v[88:91], a[120:123], v[24:27]
 buffer_load_dwordx4 v6, s[24:27], s54 offen lds
 v_max_f32 v153, 0, v153
 v_mfma_f32_16x16x32_bf16 v[28:31], v[88:91], a[124:127], v[28:31]
 v_max_f32 v154, 0, v154
 s_waitcnt lgkmcnt(5)
 v_mfma_f32_16x16x32_bf16 v[32:35], v[92:95], a[112:115], v[32:35]
 ds_read_b64_tr_b16 v[88:89], v96 offset:12288
 v_max_f32 v155, 0, v155
 v_mfma_f32_16x16x32_bf16 v[36:39], v[92:95], a[116:119], v[36:39]
 ds_read_b64_tr_b16 v[90:91], v96 offset:12544
 v_mfma_f32_16x16x32_bf16 v[40:43], v[92:95], a[120:123], v[40:43]
 buffer_load_dwordx4 v7, s[24:27], s54 offen offset:1024 lds
 v_mul_f32 v152, v152, v168
 v_mfma_f32_16x16x32_bf16 v[44:47], v[92:95], a[124:127], v[44:47]
 v_mul_f32 v153, v153, v169
 s_waitcnt lgkmcnt(5)
 v_mfma_f32_16x16x32_bf16 v[16:19], v[80:83], a[128:131], v[16:19]
 ds_read_b64_tr_b16 v[92:93], v96 offset:13312
 v_mul_f32 v154, v154, v170
 v_mfma_f32_16x16x32_bf16 v[20:23], v[80:83], a[132:135], v[20:23]
 ds_read_b64_tr_b16 v[94:95], v96 offset:13568
 v_mfma_f32_16x16x32_bf16 v[24:27], v[80:83], a[136:139], v[24:27]
 s_add_u32 m0, s53, 40960
 v_mul_f32 v155, v155, v171
 v_mfma_f32_16x16x32_bf16 v[28:31], v[80:83], a[140:143], v[28:31]
 v_cvt_pk_bf16_f32 v208, v152, v153
 s_waitcnt lgkmcnt(4)
 v_mfma_f32_16x16x32_bf16 v[32:35], v[84:87], a[128:131], v[32:35]
 v_add_u32 v96, 0xffff0000, v96
 ds_read_b64_tr_b16 v[80:81], v96 offset:16384
 v_cvt_pk_bf16_f32 v209, v154, v155
 v_mfma_f32_16x16x32_bf16 v[36:39], v[84:87], a[132:135], v[36:39]
 ds_read_b64_tr_b16 v[82:83], v96 offset:16640
 v_mfma_f32_16x16x32_bf16 v[40:43], v[84:87], a[136:139], v[40:43]
 s_add_u32 s54, s55, 110592
 v_max_f32 v184, 0, v184
 v_mfma_f32_16x16x32_bf16 v[44:47], v[84:87], a[140:143], v[44:47]
 v_max_f32 v185, 0, v185
 s_waitcnt lgkmcnt(4)
 v_mfma_f32_16x16x32_bf16 v[16:19], v[88:91], a[144:147], v[16:19]
 ds_read_b64_tr_b16 v[84:85], v96 offset:17408
 v_max_f32 v186, 0, v186
 v_mfma_f32_16x16x32_bf16 v[20:23], v[88:91], a[148:151], v[20:23]
 ds_read_b64_tr_b16 v[86:87], v96 offset:17664
 v_mfma_f32_16x16x32_bf16 v[24:27], v[88:91], a[152:155], v[24:27]
 buffer_load_dwordx4 v6, s[24:27], s54 offen lds
 v_max_f32 v187, 0, v187
 v_mfma_f32_16x16x32_bf16 v[28:31], v[88:91], a[156:159], v[28:31]
 v_mul_f32 v184, v184, v200
 s_waitcnt lgkmcnt(4)
 v_mfma_f32_16x16x32_bf16 v[32:35], v[92:95], a[144:147], v[32:35]
 ds_read_b64_tr_b16 v[88:89], v96 offset:20480
 v_mul_f32 v185, v185, v201
 v_mfma_f32_16x16x32_bf16 v[36:39], v[92:95], a[148:151], v[36:39]
 ds_read_b64_tr_b16 v[90:91], v96 offset:20736
 v_mfma_f32_16x16x32_bf16 v[40:43], v[92:95], a[152:155], v[40:43]
 buffer_load_dwordx4 v7, s[24:27], s54 offen offset:1024 lds
 v_mul_f32 v186, v186, v202
 v_mfma_f32_16x16x32_bf16 v[44:47], v[92:95], a[156:159], v[44:47]
 v_mul_f32 v187, v187, v203
 s_waitcnt lgkmcnt(4)
 v_mfma_f32_16x16x32_bf16 v[16:19], v[80:83], a[160:163], v[16:19]
 ds_read_b64_tr_b16 v[92:93], v96 offset:21504
 v_mfma_f32_16x16x32_bf16 v[20:23], v[80:83], a[164:167], v[20:23]
 ds_read_b64_tr_b16 v[94:95], v96 offset:21760
 v_mfma_f32_16x16x32_bf16 v[24:27], v[80:83], a[168:171], v[24:27]
 v_cvt_pk_bf16_f32 v210, v184, v185
 v_mfma_f32_16x16x32_bf16 v[28:31], v[80:83], a[172:175], v[28:31]
 v_cvt_pk_bf16_f32 v211, v186, v187
 s_waitcnt vmcnt(8)
 s_barrier
 s_waitcnt lgkmcnt(4)
 v_mfma_f32_16x16x32_bf16 v[32:35], v[84:87], a[160:163], v[32:35]
 ds_read_b64_tr_b16 v[80:81], v96 offset:57344
 v_mfma_f32_16x16x32_bf16 v[36:39], v[84:87], a[164:167], v[36:39]
 ds_read_b64_tr_b16 v[82:83], v96 offset:57600
 v_mfma_f32_16x16x32_bf16 v[40:43], v[84:87], a[168:171], v[40:43]
 ds_write_b128 v99, v[208:211] offset:51200
 v_mfma_f32_16x16x32_bf16 v[44:47], v[84:87], a[172:175], v[44:47]
 v_max_f32 v156, 0, v156
 s_waitcnt lgkmcnt(5)
 v_mfma_f32_16x16x32_bf16 v[16:19], v[88:91], a[176:179], v[16:19]
 ds_read_b64_tr_b16 v[84:85], v96 offset:58368
 v_mfma_f32_16x16x32_bf16 v[20:23], v[88:91], a[180:183], v[20:23]
 ds_read_b64_tr_b16 v[86:87], v96 offset:58624
 v_mfma_f32_16x16x32_bf16 v[24:27], v[88:91], a[184:187], v[24:27]
 v_max_f32 v157, 0, v157
 v_mfma_f32_16x16x32_bf16 v[28:31], v[88:91], a[188:191], v[28:31]
 v_max_f32 v158, 0, v158
 s_waitcnt lgkmcnt(5)
 v_mfma_f32_16x16x32_bf16 v[32:35], v[92:95], a[176:179], v[32:35]
 ds_read_b64_tr_b16 v[88:89], v96 offset:61440
 v_mfma_f32_16x16x32_bf16 v[36:39], v[92:95], a[180:183], v[36:39]
 ds_read_b64_tr_b16 v[90:91], v96 offset:61696
 v_mfma_f32_16x16x32_bf16 v[40:43], v[92:95], a[184:187], v[40:43]
 v_max_f32 v159, 0, v159
 v_mfma_f32_16x16x32_bf16 v[44:47], v[92:95], a[188:191], v[44:47]
 v_mul_f32 v156, v156, v172
 s_waitcnt lgkmcnt(5)
 v_mfma_f32_16x16x32_bf16 v[16:19], v[80:83], a[192:195], v[16:19]
 ds_read_b64_tr_b16 v[92:93], v96 offset:62464
 v_mul_f32 v157, v157, v173
 v_mfma_f32_16x16x32_bf16 v[20:23], v[80:83], a[196:199], v[20:23]
 ds_read_b64_tr_b16 v[94:95], v96 offset:62720
 v_mfma_f32_16x16x32_bf16 v[24:27], v[80:83], a[200:203], v[24:27]
 s_add_u32 m0, s53, 8192
 v_mul_f32 v158, v158, v174
 v_mfma_f32_16x16x32_bf16 v[28:31], v[80:83], a[204:207], v[28:31]
 s_add_u32 s54, s55, 147456
 s_waitcnt lgkmcnt(4)
 v_mfma_f32_16x16x32_bf16 v[32:35], v[84:87], a[192:195], v[32:35]
 v_add_u32 v96, 0x10000, v96
 ds_read_b64_tr_b16 v[80:81], v96 offset:16384
 v_mul_f32 v159, v159, v175
 v_mfma_f32_16x16x32_bf16 v[36:39], v[84:87], a[196:199], v[36:39]
 ds_read_b64_tr_b16 v[82:83], v96 offset:16640
 v_mfma_f32_16x16x32_bf16 v[40:43], v[84:87], a[200:203], v[40:43]
 buffer_load_dwordx4 v6, s[24:27], s54 offen lds
 v_cvt_pk_bf16_f32 v212, v156, v157
 v_mfma_f32_16x16x32_bf16 v[44:47], v[84:87], a[204:207], v[44:47]
 buffer_load_dwordx4 v7, s[24:27], s54 offen offset:1024 lds
 s_waitcnt lgkmcnt(4)
 v_mfma_f32_16x16x32_bf16 v[16:19], v[88:91], a[208:211], v[16:19]
 ds_read_b64_tr_b16 v[84:85], v96 offset:17408
 v_cvt_pk_bf16_f32 v213, v158, v159
 v_mfma_f32_16x16x32_bf16 v[20:23], v[88:91], a[212:215], v[20:23]
 ds_read_b64_tr_b16 v[86:87], v96 offset:17664
 v_mfma_f32_16x16x32_bf16 v[24:27], v[88:91], a[216:219], v[24:27]
 s_add_u32 m0, s53, 65536
 v_max_f32 v188, 0, v188
 v_mfma_f32_16x16x32_bf16 v[28:31], v[88:91], a[220:223], v[28:31]
 s_add_u32 s54, s55, 184320
 s_waitcnt lgkmcnt(4)
 v_mfma_f32_16x16x32_bf16 v[32:35], v[92:95], a[208:211], v[32:35]
 ds_read_b64_tr_b16 v[88:89], v96 offset:20480
 v_max_f32 v189, 0, v189
 v_mfma_f32_16x16x32_bf16 v[36:39], v[92:95], a[212:215], v[36:39]
 ds_read_b64_tr_b16 v[90:91], v96 offset:20736
 v_mfma_f32_16x16x32_bf16 v[40:43], v[92:95], a[216:219], v[40:43]
 buffer_load_dwordx4 v6, s[24:27], s54 offen lds
 v_max_f32 v190, 0, v190
 v_mfma_f32_16x16x32_bf16 v[44:47], v[92:95], a[220:223], v[44:47]
 buffer_load_dwordx4 v7, s[24:27], s54 offen offset:1024 lds
 s_waitcnt lgkmcnt(4)
 v_mfma_f32_16x16x32_bf16 v[16:19], v[80:83], a[224:227], v[16:19]
 ds_read_b64_tr_b16 v[92:93], v96 offset:21504
 v_mfma_f32_16x16x32_bf16 v[20:23], v[80:83], a[228:231], v[20:23]
 ds_read_b64_tr_b16 v[94:95], v96 offset:21760
 v_mfma_f32_16x16x32_bf16 v[24:27], v[80:83], a[232:235], v[24:27]
 s_add_u32 m0, s53, 73728
 v_max_f32 v191, 0, v191
 v_mfma_f32_16x16x32_bf16 v[28:31], v[80:83], a[236:239], v[28:31]
 v_mul_f32 v188, v188, v204
 s_waitcnt lgkmcnt(4)
 v_mfma_f32_16x16x32_bf16 v[32:35], v[84:87], a[224:227], v[32:35]
 v_add_u32 v96, 0xffff0000, v96
 ds_read_b64_tr_b16 v[80:81], v96 offset:24576
 v_mfma_f32_16x16x32_bf16 v[36:39], v[84:87], a[228:231], v[36:39]
 ds_read_b64_tr_b16 v[82:83], v96 offset:24832
 v_mfma_f32_16x16x32_bf16 v[40:43], v[84:87], a[232:235], v[40:43]
 s_add_u32 s54, s55, 221184
 v_mul_f32 v189, v189, v205
 v_mfma_f32_16x16x32_bf16 v[44:47], v[84:87], a[236:239], v[44:47]
 v_mul_f32 v190, v190, v206
 s_waitcnt lgkmcnt(4)
 v_mfma_f32_16x16x32_bf16 v[16:19], v[88:91], a[240:243], v[16:19]
 ds_read_b64_tr_b16 v[84:85], v96 offset:25600
 v_mfma_f32_16x16x32_bf16 v[20:23], v[88:91], a[244:247], v[20:23]
 ds_read_b64_tr_b16 v[86:87], v96 offset:25856
 v_mfma_f32_16x16x32_bf16 v[24:27], v[88:91], a[248:251], v[24:27]
 buffer_load_dwordx4 v6, s[24:27], s54 offen lds
 v_mul_f32 v191, v191, v207
 v_mfma_f32_16x16x32_bf16 v[28:31], v[88:91], a[252:255], v[28:31]
 v_cvt_pk_bf16_f32 v214, v188, v189
 s_waitcnt lgkmcnt(4)
 v_mfma_f32_16x16x32_bf16 v[32:35], v[92:95], a[240:243], v[32:35]
 ds_read_b64_tr_b16 v[88:89], v96 offset:28672
 v_mfma_f32_16x16x32_bf16 v[36:39], v[92:95], a[244:247], v[36:39]
 ds_read_b64_tr_b16 v[90:91], v96 offset:28928
 v_mfma_f32_16x16x32_bf16 v[40:43], v[92:95], a[248:251], v[40:43]
 buffer_load_dwordx4 v7, s[24:27], s54 offen offset:1024 lds
 v_cvt_pk_bf16_f32 v215, v190, v191
 v_mfma_f32_16x16x32_bf16 v[44:47], v[92:95], a[252:255], v[44:47]
 ds_write_b128 v99, v[212:215] offset:52224
 s_waitcnt lgkmcnt(5)
 v_mfma_f32_16x16x32_bf16 v[16:19], v[80:83], v[112:115], v[16:19]
 ds_read_b64_tr_b16 v[92:93], v96 offset:29696
 v_mfma_f32_16x16x32_bf16 v[20:23], v[80:83], v[116:119], v[20:23]
 ds_read_b64_tr_b16 v[94:95], v96 offset:29952
 v_mfma_f32_16x16x32_bf16 v[24:27], v[80:83], v[120:123], v[24:27]
 ds_read_b128 a[0:3], v98 offset:0
 v_mfma_f32_16x16x32_bf16 v[28:31], v[80:83], v[124:127], v[28:31]
 ds_read_b128 a[4:7], v98 offset:1024
 s_waitcnt vmcnt(8)
 s_barrier
 s_waitcnt lgkmcnt(7)
 v_mfma_f32_16x16x32_bf16 v[32:35], v[84:87], v[112:115], v[32:35]
 ds_read_b64_tr_b16 v[80:81], v10 offset:32768
 v_mfma_f32_16x16x32_bf16 v[36:39], v[84:87], v[116:119], v[36:39]
 ds_read_b64_tr_b16 v[82:83], v10 offset:36864
 v_mfma_f32_16x16x32_bf16 v[40:43], v[84:87], v[120:123], v[40:43]
 ds_read_b128 a[8:11], v98 offset:2048
 v_mfma_f32_16x16x32_bf16 v[44:47], v[84:87], v[124:127], v[44:47]
 s_waitcnt lgkmcnt(8)
 v_mfma_f32_16x16x32_bf16 v[16:19], v[88:91], v[128:131], v[16:19]
 ds_read_b64_tr_b16 v[84:85], v11 offset:32768
 v_mfma_f32_16x16x32_bf16 v[20:23], v[88:91], v[132:135], v[20:23]
 ds_read_b64_tr_b16 v[86:87], v11 offset:36864
 v_mfma_f32_16x16x32_bf16 v[24:27], v[88:91], v[136:139], v[24:27]
 ds_read_b128 a[12:15], v98 offset:3072
 v_mfma_f32_16x16x32_bf16 v[28:31], v[88:91], v[140:143], v[28:31]
 s_waitcnt lgkmcnt(8)
 v_mfma_f32_16x16x32_bf16 v[32:35], v[92:95], v[128:131], v[32:35]
 ds_read_b64_tr_b16 v[88:89], v12 offset:32768
 v_mfma_f32_16x16x32_bf16 v[36:39], v[92:95], v[132:135], v[36:39]
 ds_read_b64_tr_b16 v[90:91], v12 offset:36864
 v_mfma_f32_16x16x32_bf16 v[40:43], v[92:95], v[136:139], v[40:43]
 v_mfma_f32_16x16x32_bf16 v[44:47], v[92:95], v[140:143], v[44:47]
 s_waitcnt lgkmcnt(2)
 v_mfma_f32_16x16x32_bf16 v[144:147], v[80:83], a[0:3], 0
 ds_read_b64_tr_b16 v[92:93], v13 offset:32768
 ds_read_b128 a[16:19], v98 offset:8192
 v_mfma_f32_16x16x32_bf16 v[148:151], v[80:83], a[4:7], 0
 ds_read_b64_tr_b16 v[94:95], v13 offset:36864
 ds_read_b128 a[20:23], v98 offset:9216
 v_mfma_f32_16x16x32_bf16 v[152:155], v[80:83], a[8:11], 0
 s_add_u32 m0, s53, 16384
 ds_read_b128 a[24:27], v98 offset:10240
 v_mfma_f32_16x16x32_bf16 v[156:159], v[80:83], a[12:15], 0
 s_add_u32 s54, s55, 258048
 v_mfma_f32_16x16x32_bf16 v[160:163], v[84:87], a[0:3], 0
 ds_read_b64_tr_b16 v[80:81], v10 offset:49152
 ds_read_b128 a[28:31], v98 offset:11264
 v_mfma_f32_16x16x32_bf16 v[164:167], v[84:87], a[4:7], 0
 ds_read_b64_tr_b16 v[82:83], v10 offset:53248
 v_max_f32 v16, 0, v16
 v_mfma_f32_16x16x32_bf16 v[168:171], v[84:87], a[8:11], 0
 buffer_load_dwordx4 v6, s[24:27], s54 offen lds
 v_max_f32 v17, 0, v17
 v_mfma_f32_16x16x32_bf16 v[172:175], v[84:87], a[12:15], 0
 buffer_load_dwordx4 v7, s[24:27], s54 offen offset:1024 lds
 s_waitcnt lgkmcnt(8)
 v_mfma_f32_16x16x32_bf16 v[176:179], v[88:91], a[0:3], 0
 ds_read_b64_tr_b16 v[84:85], v11 offset:49152
 v_max_f32 v18, 0, v18
 v_mfma_f32_16x16x32_bf16 v[180:183], v[88:91], a[4:7], 0
 ds_read_b64_tr_b16 v[86:87], v11 offset:53248
 v_max_f32 v19, 0, v19
 v_mfma_f32_16x16x32_bf16 v[184:187], v[88:91], a[8:11], 0
 s_add_u32 m0, s53, 57344
 v_mul_f32 v16, v16, v32
 v_mfma_f32_16x16x32_bf16 v[188:191], v[88:91], a[12:15], 0
 s_add_u32 s54, s56, 0
 s_waitcnt lgkmcnt(7)
 v_mfma_f32_16x16x32_bf16 v[192:195], v[92:95], a[0:3], 0
 ds_read_b64_tr_b16 v[88:89], v12 offset:49152
 v_mul_f32 v17, v17, v33
 v_mfma_f32_16x16x32_bf16 v[196:199], v[92:95], a[4:7], 0
 ds_read_b64_tr_b16 v[90:91], v12 offset:53248
 v_mul_f32 v18, v18, v34
 v_mfma_f32_16x16x32_bf16 v[200:203], v[92:95], a[8:11], 0
 buffer_load_dwordx4 v6, s[24:27], s54 offen lds
 v_mul_f32 v19, v19, v35
 v_mfma_f32_16x16x32_bf16 v[204:207], v[92:95], a[12:15], 0
 buffer_load_dwordx4 v7, s[24:27], s54 offen offset:1024 lds
 s_waitcnt lgkmcnt(5)
 s_waitcnt lgkmcnt(4)
 v_mfma_f32_16x16x32_bf16 v[144:147], v[80:83], a[16:19], v[144:147]
 ds_read_b64_tr_b16 v[92:93], v13 offset:49152
 ds_read_b128 a[32:35], v98 offset:16384
 v_mfma_f32_16x16x32_bf16 v[148:151], v[80:83], a[20:23], v[148:151]
 ds_read_b64_tr_b16 v[94:95], v13 offset:53248
 v_mfma_f32_16x16x32_bf16 v[152:155], v[80:83], a[24:27], v[152:155]
 s_add_u32 m0, s53, 81920
 ds_read_b128 a[36:39], v98 offset:17408
 v_mfma_f32_16x16x32_bf16 v[156:159], v[80:83], a[28:31], v[156:159]
 ds_read_b128 a[40:43], v98 offset:18432
 s_waitcnt lgkmcnt(7)
 v_mfma_f32_16x16x32_bf16 v[160:163], v[84:87], a[16:19], v[160:163]
 ds_read_b64_tr_b16 v[80:81], v10 offset:0
 ds_read_b128 a[44:47], v98 offset:19456
 v_mfma_f32_16x16x32_bf16 v[164:167], v[84:87], a[20:23], v[164:167]
 ds_read_b64_tr_b16 v[82:83], v10 offset:4096
 v_mfma_f32_16x16x32_bf16 v[168:171], v[84:87], a[24:27], v[168:171]
 s_add_u32 s54, s55, 256
 v_cvt_pk_bf16_f32 v216, v16, v17
 v_mfma_f32_16x16x32_bf16 v[172:175], v[84:87], a[28:31], v[172:175]
 v_cvt_pk_bf16_f32 v217, v18, v19
 s_waitcnt lgkmcnt(8)
 v_mfma_f32_16x16x32_bf16 v[176:179], v[88:91], a[16:19], v[176:179]
 ds_read_b64_tr_b16 v[84:85], v11 offset:0
 ds_write_b64 v100, v[216:217] offset:0
 v_mfma_f32_16x16x32_bf16 v[180:183], v[88:91], a[20:23], v[180:183]
 ds_read_b64_tr_b16 v[86:87], v11 offset:4096
 v_mfma_f32_16x16x32_bf16 v[184:187], v[88:91], a[24:27], v[184:187]
 buffer_load_dwordx4 v6, s[24:27], s54 offen lds
 v_max_f32 v20, 0, v20
 v_mfma_f32_16x16x32_bf16 v[188:191], v[88:91], a[28:31], v[188:191]
 v_max_f32 v21, 0, v21
 s_waitcnt lgkmcnt(8)
 v_mfma_f32_16x16x32_bf16 v[192:195], v[92:95], a[16:19], v[192:195]
 ds_read_b64_tr_b16 v[88:89], v12 offset:0
 v_max_f32 v22, 0, v22
 v_mfma_f32_16x16x32_bf16 v[196:199], v[92:95], a[20:23], v[196:199]
 ds_read_b64_tr_b16 v[90:91], v12 offset:4096
 v_mfma_f32_16x16x32_bf16 v[200:203], v[92:95], a[24:27], v[200:203]
 buffer_load_dwordx4 v7, s[24:27], s54 offen offset:1024 lds
 v_max_f32 v23, 0, v23
 v_mfma_f32_16x16x32_bf16 v[204:207], v[92:95], a[28:31], v[204:207]
 v_mul_f32 v20, v20, v36
 s_waitcnt lgkmcnt(6)
 s_waitcnt lgkmcnt(5)
 v_mfma_f32_16x16x32_bf16 v[144:147], v[80:83], a[32:35], v[144:147]
 ds_read_b64_tr_b16 v[92:93], v13 offset:0
 v_mfma_f32_16x16x32_bf16 v[148:151], v[80:83], a[36:39], v[148:151]
 ds_read_b64_tr_b16 v[94:95], v13 offset:4096
 v_mfma_f32_16x16x32_bf16 v[152:155], v[80:83], a[40:43], v[152:155]
 ds_read_b128 a[48:51], v98 offset:24576
 ds_read_b128 a[52:55], v98 offset:25600
 v_mfma_f32_16x16x32_bf16 v[156:159], v[80:83], a[44:47], v[156:159]
 ds_read_b128 a[56:59], v98 offset:26624
 s_waitcnt vmcnt(8)
 s_barrier
 s_waitcnt lgkmcnt(7)
 v_mfma_f32_16x16x32_bf16 v[160:163], v[84:87], a[32:35], v[160:163]
 ds_read_b64_tr_b16 v[80:81], v10 offset:40960
 v_mfma_f32_16x16x32_bf16 v[164:167], v[84:87], a[36:39], v[164:167]
 ds_read_b64_tr_b16 v[82:83], v10 offset:45056
 v_mfma_f32_16x16x32_bf16 v[168:171], v[84:87], a[40:43], v[168:171]
 ds_read_b128 a[60:63], v98 offset:27648
 v_mul_f32 v21, v21, v37
 v_mfma_f32_16x16x32_bf16 v[172:175], v[84:87], a[44:47], v[172:175]
 v_mul_f32 v22, v22, v38
 s_waitcnt lgkmcnt(8)
 v_mfma_f32_16x16x32_bf16 v[176:179], v[88:91], a[32:35], v[176:179]
 ds_read_b64_tr_b16 v[84:85], v11 offset:40960
 v_mfma_f32_16x16x32_bf16 v[180:183], v[88:91], a[36:39], v[180:183]
 ds_read_b64_tr_b16 v[86:87], v11 offset:45056
 v_mfma_f32_16x16x32_bf16 v[184:187], v[88:91], a[40:43], v[184:187]
 v_mul_f32 v23, v23, v39
 v_cvt_pk_bf16_f32 v218, v20, v21
 v_mfma_f32_16x16x32_bf16 v[188:191], v[88:91], a[44:47], v[188:191]
 v_cvt_pk_bf16_f32 v219, v22, v23
 s_waitcnt lgkmcnt(8)
 v_mfma_f32_16x16x32_bf16 v[192:195], v[92:95], a[32:35], v[192:195]
 ds_read_b64_tr_b16 v[88:89], v12 offset:40960
 v_mfma_f32_16x16x32_bf16 v[196:199], v[92:95], a[36:39], v[196:199]
 ds_read_b64_tr_b16 v[90:91], v12 offset:45056
 v_mfma_f32_16x16x32_bf16 v[200:203], v[92:95], a[40:43], v[200:203]
 ds_write_b64 v100, v[218:219] offset:1024
 v_max_f32 v24, 0, v24
 v_mfma_f32_16x16x32_bf16 v[204:207], v[92:95], a[44:47], v[204:207]
 v_max_f32 v25, 0, v25
 s_waitcnt lgkmcnt(5)
 v_mfma_f32_16x16x32_bf16 v[144:147], v[80:83], a[48:51], v[144:147]
 ds_read_b64_tr_b16 v[92:93], v13 offset:40960
 ds_read_b128 a[64:67], v98 offset:32768
 v_mfma_f32_16x16x32_bf16 v[148:151], v[80:83], a[52:55], v[148:151]
 ds_read_b64_tr_b16 v[94:95], v13 offset:45056
 ds_read_b128 a[68:71], v98 offset:33792
 v_mfma_f32_16x16x32_bf16 v[152:155], v[80:83], a[56:59], v[152:155]
 s_add_u32 m0, s53, 24576
 ds_read_b128 a[72:75], v98 offset:34816
 v_mfma_f32_16x16x32_bf16 v[156:159], v[80:83], a[60:63], v[156:159]
 s_add_u32 s54, s55, 37120
 s_waitcnt lgkmcnt(8)
 v_mfma_f32_16x16x32_bf16 v[160:163], v[84:87], a[48:51], v[160:163]
 ds_read_b64_tr_b16 v[80:81], v10 offset:8192
 ds_read_b128 a[76:79], v98 offset:35840
 v_mfma_f32_16x16x32_bf16 v[164:167], v[84:87], a[52:55], v[164:167]
 ds_read_b64_tr_b16 v[82:83], v10 offset:12288
 v_max_f32 v26, 0, v26
 v_mfma_f32_16x16x32_bf16 v[168:171], v[84:87], a[56:59], v[168:171]
 buffer_load_dwordx4 v6, s[24:27], s54 offen lds
 v_max_f32 v27, 0, v27
 v_mfma_f32_16x16x32_bf16 v[172:175], v[84:87], a[60:63], v[172:175]
 buffer_load_dwordx4 v7, s[24:27], s54 offen offset:1024 lds
 s_waitcnt lgkmcnt(9)
 v_mfma_f32_16x16x32_bf16 v[176:179], v[88:91], a[48:51], v[176:179]
 ds_read_b64_tr_b16 v[84:85], v11 offset:8192
 v_mul_f32 v24, v24, v40
 v_mfma_f32_16x16x32_bf16 v[180:183], v[88:91], a[52:55], v[180:183]
 ds_read_b64_tr_b16 v[86:87], v11 offset:12288
 v_mul_f32 v25, v25, v41
 v_mfma_f32_16x16x32_bf16 v[184:187], v[88:91], a[56:59], v[184:187]
 s_add_u32 m0, s53, 32768
 v_mul_f32 v26, v26, v42
 v_mfma_f32_16x16x32_bf16 v[188:191], v[88:91], a[60:63], v[188:191]
 s_add_u32 s54, s55, 73984
 s_waitcnt lgkmcnt(7)
 v_mfma_f32_16x16x32_bf16 v[192:195], v[92:95], a[48:51], v[192:195]
 ds_read_b64_tr_b16 v[88:89], v12 offset:8192
 v_mul_f32 v27, v27, v43
 v_mfma_f32_16x16x32_bf16 v[196:199], v[92:95], a[52:55], v[196:199]
 ds_read_b64_tr_b16 v[90:91], v12 offset:12288
 v_cvt_pk_bf16_f32 v216, v24, v25
 v_mfma_f32_16x16x32_bf16 v[200:203], v[92:95], a[56:59], v[200:203]
 buffer_load_dwordx4 v6, s[24:27], s54 offen lds
 v_cvt_pk_bf16_f32 v217, v26, v27
 v_mfma_f32_16x16x32_bf16 v[204:207], v[92:95], a[60:63], v[204:207]
 buffer_load_dwordx4 v7, s[24:27], s54 offen offset:1024 lds
 s_waitcnt lgkmcnt(5)
 s_waitcnt lgkmcnt(4)
 v_mfma_f32_16x16x32_bf16 v[144:147], v[80:83], a[64:67], v[144:147]
 ds_read_b64_tr_b16 v[92:93], v13 offset:8192
 ds_read_b128 a[80:83], v98 offset:40960
 v_mfma_f32_16x16x32_bf16 v[148:151], v[80:83], a[68:71], v[148:151]
 ds_read_b64_tr_b16 v[94:95], v13 offset:12288
 ds_read_b128 a[84:87], v98 offset:41984
 v_mfma_f32_16x16x32_bf16 v[152:155], v[80:83], a[72:75], v[152:155]
 s_add_u32 m0, s53, 49152
 ds_read_b128 a[88:91], v98 offset:43008
 v_mfma_f32_16x16x32_bf16 v[156:159], v[80:83], a[76:79], v[156:159]
 ds_read_b128 a[92:95], v98 offset:44032
 s_waitcnt lgkmcnt(8)
 v_mfma_f32_16x16x32_bf16 v[160:163], v[84:87], a[64:67], v[160:163]
 v_add_u32 v10, 0x10000, v10
 ds_read_b64_tr_b16 v[80:81], v10 offset:0
 ds_write_b64 v100, v[216:217] offset:2048
 v_mfma_f32_16x16x32_bf16 v[164:167], v[84:87], a[68:71], v[164:167]
 ds_read_b64_tr_b16 v[82:83], v10 offset:4096
 v_max_f32 v28, 0, v28
 v_mfma_f32_16x16x32_bf16 v[168:171], v[84:87], a[72:75], v[168:171]
 s_add_u32 s54, s55, 110848
 v_max_f32 v29, 0, v29
 v_mfma_f32_16x16x32_bf16 v[172:175], v[84:87], a[76:79], v[172:175]
 v_max_f32 v30, 0, v30
 s_waitcnt lgkmcnt(9)
 v_mfma_f32_16x16x32_bf16 v[176:179], v[88:91], a[64:67], v[176:179]
 v_add_u32 v11, 0x10000, v11
 ds_read_b64_tr_b16 v[84:85], v11 offset:0
 v_max_f32 v31, 0, v31
 v_mfma_f32_16x16x32_bf16 v[180:183], v[88:91], a[68:71], v[180:183]
 ds_read_b64_tr_b16 v[86:87], v11 offset:4096
 v_mfma_f32_16x16x32_bf16 v[184:187], v[88:91], a[72:75], v[184:187]
 buffer_load_dwordx4 v6, s[24:27], s54 offen lds
 v_mul_f32 v28, v28, v44
 v_mfma_f32_16x16x32_bf16 v[188:191], v[88:91], a[76:79], v[188:191]
 v_mul_f32 v29, v29, v45
 s_waitcnt lgkmcnt(8)
 v_mfma_f32_16x16x32_bf16 v[192:195], v[92:95], a[64:67], v[192:195]
 v_add_u32 v12, 0x10000, v12
 ds_read_b64_tr_b16 v[88:89], v12 offset:0
 v_mul_f32 v30, v30, v46
 v_mfma_f32_16x16x32_bf16 v[196:199], v[92:95], a[68:71], v[196:199]
 ds_read_b64_tr_b16 v[90:91], v12 offset:4096
 v_mfma_f32_16x16x32_bf16 v[200:203], v[92:95], a[72:75], v[200:203]
 buffer_load_dwordx4 v7, s[24:27], s54 offen offset:1024 lds
 v_mul_f32 v31, v31, v47
 v_mfma_f32_16x16x32_bf16 v[204:207], v[92:95], a[76:79], v[204:207]
 v_cvt_pk_bf16_f32 v218, v28, v29
 s_waitcnt lgkmcnt(7)
 s_waitcnt lgkmcnt(4)
 v_mfma_f32_16x16x32_bf16 v[144:147], v[80:83], a[80:83], v[144:147]
 v_add_u32 v13, 0x10000, v13
 ds_read_b64_tr_b16 v[92:93], v13 offset:0
 v_cvt_pk_bf16_f32 v219, v30, v31
 v_mfma_f32_16x16x32_bf16 v[148:151], v[80:83], a[84:87], v[148:151]
 ds_read_b64_tr_b16 v[94:95], v13 offset:4096
 ds_write_b64 v100, v[218:219] offset:3072
 v_mfma_f32_16x16x32_bf16 v[152:155], v[80:83], a[88:91], v[152:155]
 s_add_u32 m0, s53, 90112
 ds_read_b128 a[96:99], v98 offset:49152
 v_mfma_f32_16x16x32_bf16 v[156:159], v[80:83], a[92:95], v[156:159]
 ds_read_b128 a[100:103], v98 offset:50176
 s_waitcnt vmcnt(8)
 s_waitcnt lgkmcnt(2)
 s_barrier
 v_mfma_f32_16x16x32_bf16 v[160:163], v[84:87], a[80:83], v[160:163]
 ds_read_b64_tr_b16 v[80:81], v10 offset:8192
 ds_read_b128 a[104:107], v98 offset:51200
 v_mfma_f32_16x16x32_bf16 v[164:167], v[84:87], a[84:87], v[164:167]
 ds_read_b64_tr_b16 v[82:83], v10 offset:12288
 ds_read_b128 a[108:111], v98 offset:52224
 v_mfma_f32_16x16x32_bf16 v[168:171], v[84:87], a[88:91], v[168:171]
 s_add_u32 s54, s55, 147712
 v_lshrrev_b32 v248, 2, v0
 v_mfma_f32_16x16x32_bf16 v[172:175], v[84:87], a[92:95], v[172:175]
 v_lshrrev_b32 v249, 2, v248
 v_mfma_f32_16x16x32_bf16 v[176:179], v[88:91], a[80:83], v[176:179]
 ds_read_b64_tr_b16 v[84:85], v11 offset:8192
 v_and_b32 v250, 1, v249
 v_mfma_f32_16x16x32_bf16 v[180:183], v[88:91], a[84:87], v[180:183]
 ds_read_b64_tr_b16 v[86:87], v11 offset:12288
 v_and_b32 v251, 3, v0
 v_mfma_f32_16x16x32_bf16 v[184:187], v[88:91], a[88:91], v[184:187]
 buffer_load_dwordx4 v6, s[24:27], s54 offen lds
 v_lshrrev_b32 v251, 1, v251
 v_mfma_f32_16x16x32_bf16 v[188:191], v[88:91], a[92:95], v[188:191]
 v_xor_b32 v250, v250, v251
 v_mfma_f32_16x16x32_bf16 v[192:195], v[92:95], a[80:83], v[192:195]
 ds_read_b64_tr_b16 v[88:89], v12 offset:8192
 v_lshlrev_b32 v250, 5, v250
 v_mfma_f32_16x16x32_bf16 v[196:199], v[92:95], a[84:87], v[196:199]
 ds_read_b64_tr_b16 v[90:91], v12 offset:12288
 v_and_b32 v251, 1, v0
 v_mfma_f32_16x16x32_bf16 v[200:203], v[92:95], a[88:91], v[200:203]
 buffer_load_dwordx4 v7, s[24:27], s54 offen offset:1024 lds
 v_lshl_add_u32 v250, v251, 4, v250
 v_mfma_f32_16x16x32_bf16 v[204:207], v[92:95], a[92:95], v[204:207]
 s_and_b32 s62, s51, 1
 s_waitcnt lgkmcnt(4)
 v_mfma_f32_16x16x32_bf16 v[144:147], v[80:83], a[96:99], v[144:147]
 ds_read_b64_tr_b16 v[92:93], v13 offset:8192
 ds_read_b128 a[112:115], v98 offset:57344
 v_mfma_f32_16x16x32_bf16 v[148:151], v[80:83], a[100:103], v[148:151]
 ds_read_b64_tr_b16 v[94:95], v13 offset:12288
 ds_read_b128 a[116:119], v98 offset:58368
 v_mfma_f32_16x16x32_bf16 v[152:155], v[80:83], a[104:107], v[152:155]
 s_add_u32 m0, s53, 0
 ds_read_b128 a[120:123], v98 offset:59392
 v_mfma_f32_16x16x32_bf16 v[156:159], v[80:83], a[108:111], v[156:159]
 ds_read_b128 a[124:127], v98 offset:60416
 s_waitcnt lgkmcnt(8)
 v_mfma_f32_16x16x32_bf16 v[160:163], v[84:87], a[96:99], v[160:163]
 v_add_u32 v10, 0xffff0000, v10
 ds_read_b64_tr_b16 v[80:81], v10 offset:16384
 s_add_u32 s62, s62, 16
 v_mfma_f32_16x16x32_bf16 v[164:167], v[84:87], a[100:103], v[164:167]
 ds_read_b64_tr_b16 v[82:83], v10 offset:20480
 s_cmp_eq_u32 s49, 0
 s_cselect_b32 s62, s51, s62
 v_mfma_f32_16x16x32_bf16 v[168:171], v[84:87], a[104:107], v[168:171]
 s_add_u32 s54, s55, 184576
 s_lshl_b32 s62, s62, 6
 v_mfma_f32_16x16x32_bf16 v[172:175], v[84:87], a[108:111], v[172:175]
 v_add_u32 v250, s62, v250
 s_waitcnt lgkmcnt(8)
 v_mfma_f32_16x16x32_bf16 v[176:179], v[88:91], a[96:99], v[176:179]
 v_add_u32 v11, 0xffff0000, v11
 ds_read_b64_tr_b16 v[84:85], v11 offset:16384
 s_mul_i32 s63, s50, 41472
 v_mfma_f32_16x16x32_bf16 v[180:183], v[88:91], a[100:103], v[180:183]
 ds_read_b64_tr_b16 v[86:87], v11 offset:20480
 v_mul_u32_u24 v251, 0x480, v248
 v_mfma_f32_16x16x32_bf16 v[184:187], v[88:91], a[104:107], v[184:187]
 buffer_load_dwordx4 v6, s[24:27], s54 offen lds
 v_add_u32 v251, v251, v250
 v_mfma_f32_16x16x32_bf16 v[188:191], v[88:91], a[108:111], v[188:191]
 v_add_u32 v2, s63, v251
 s_waitcnt lgkmcnt(7)
 v_mfma_f32_16x16x32_bf16 v[192:195], v[92:95], a[96:99], v[192:195]
 v_add_u32 v12, 0xffff0000, v12
 ds_read_b64_tr_b16 v[88:89], v12 offset:16384
 v_add_u32 v3, 22016, v2
 v_mfma_f32_16x16x32_bf16 v[196:199], v[92:95], a[100:103], v[196:199]
 ds_read_b64_tr_b16 v[90:91], v12 offset:20480
 v_mul_u32_u24 v249, 72, v249
 v_mfma_f32_16x16x32_bf16 v[200:203], v[92:95], a[104:107], v[200:203]
 buffer_load_dwordx4 v7, s[24:27], s54 offen offset:1024 lds
 v_and_b32 v251, 3, v248
 v_mfma_f32_16x16x32_bf16 v[204:207], v[92:95], a[108:111], v[204:207]
 v_add_u32 v249, v249, v251
 s_lshl_b32 s57, s52, 4
 v_mov_b32 v253, s57
 v_mov_b32 v254, 0x7ff00000
 s_cmp_eq_u32 s48, 0
 s_cselect_b64 s[86:87], -1, 0
 v_cndmask_b32 v253, v254, v253, s[86:87]
 buffer_load_dword v111, v253, s[32:35], 0 offen sc1
 s_waitcnt lgkmcnt(6)
 s_waitcnt lgkmcnt(4)
 v_mfma_f32_16x16x32_bf16 v[144:147], v[80:83], a[112:115], v[144:147]
 v_add_u32 v13, 0xffff0000, v13
 ds_read_b64_tr_b16 v[92:93], v13 offset:16384
 ds_read_b128 a[128:131], v101 offset:0
 v_mfma_f32_16x16x32_bf16 v[148:151], v[80:83], a[116:119], v[148:151]
 ds_read_b64_tr_b16 v[94:95], v13 offset:20480
 ds_read_b128 a[132:135], v101 offset:1024
 v_mfma_f32_16x16x32_bf16 v[152:155], v[80:83], a[120:123], v[152:155]
 s_add_u32 m0, s53, 8192
 ds_read_b128 a[136:139], v101 offset:2048
 v_mfma_f32_16x16x32_bf16 v[156:159], v[80:83], a[124:127], v[156:159]
 ds_read_b128 a[140:143], v101 offset:3072
 s_waitcnt lgkmcnt(8)
 v_mfma_f32_16x16x32_bf16 v[160:163], v[84:87], a[112:115], v[160:163]
 ds_read_b64_tr_b16 v[80:81], v10 offset:57344
 v_mul_u32_u24 v249, 0x480, v249
 v_mfma_f32_16x16x32_bf16 v[164:167], v[84:87], a[116:119], v[164:167]
 ds_read_b64_tr_b16 v[82:83], v10 offset:61440
 v_add_u32 v249, v249, v250
 v_mfma_f32_16x16x32_bf16 v[168:171], v[84:87], a[120:123], v[168:171]
 s_add_u32 s54, s55, 221440
 s_mul_i32 s63, s50, 331776
 v_mfma_f32_16x16x32_bf16 v[172:175], v[84:87], a[124:127], v[172:175]
 s_add_u32 s63, s63, 18432
 s_waitcnt lgkmcnt(8)
 v_mfma_f32_16x16x32_bf16 v[176:179], v[88:91], a[112:115], v[176:179]
 ds_read_b64_tr_b16 v[84:85], v11 offset:57344
 v_add_u32 v4, s63, v249
 v_mfma_f32_16x16x32_bf16 v[180:183], v[88:91], a[116:119], v[180:183]
 ds_read_b64_tr_b16 v[86:87], v11 offset:61440
 v_add_u32 v5, 40448, v4
 v_mfma_f32_16x16x32_bf16 v[184:187], v[88:91], a[120:123], v[184:187]
 buffer_load_dwordx4 v6, s[24:27], s54 offen lds
 v_lshlrev_b32 v248, 4, v0
 v_mfma_f32_16x16x32_bf16 v[188:191], v[88:91], a[124:127], v[188:191]
 s_lshr_b32 s62, s51, 1
 s_waitcnt lgkmcnt(7)
 v_mfma_f32_16x16x32_bf16 v[192:195], v[92:95], a[112:115], v[192:195]
 ds_read_b64_tr_b16 v[88:89], v12 offset:57344
 s_and_b32 s62, s62, 1
 v_mfma_f32_16x16x32_bf16 v[196:199], v[92:95], a[116:119], v[196:199]
 ds_read_b64_tr_b16 v[90:91], v12 offset:61440
 s_lshl_b32 s63, s48, 1
 v_mfma_f32_16x16x32_bf16 v[200:203], v[92:95], a[120:123], v[200:203]
 buffer_load_dwordx4 v7, s[24:27], s54 offen offset:1024 lds
 s_lshl_b32 s64, s52, 3
 v_mfma_f32_16x16x32_bf16 v[204:207], v[92:95], a[124:127], v[204:207]
 s_add_u32 s63, s63, s64
 s_waitcnt lgkmcnt(6)
 s_waitcnt lgkmcnt(4)
 v_mfma_f32_16x16x32_bf16 v[144:147], v[80:83], a[128:131], v[144:147]
 ds_read_b64_tr_b16 v[92:93], v13 offset:57344
 s_add_u32 s64, s63, 0
 v_mfma_f32_16x16x32_bf16 v[148:151], v[80:83], a[132:135], v[148:151]
 ds_read_b64_tr_b16 v[94:95], v13 offset:61440
 v_mfma_f32_16x16x32_bf16 v[152:155], v[80:83], a[136:139], v[152:155]
 s_add_u32 m0, s53, 40960
 s_xor_b32 s64, s64, s62
 v_mfma_f32_16x16x32_bf16 v[156:159], v[80:83], a[140:143], v[156:159]
 s_mov_b32 s60, s64
 s_waitcnt vmcnt(9)
 s_barrier
 s_waitcnt lgkmcnt(4)
 v_mfma_f32_16x16x32_bf16 v[160:163], v[84:87], a[128:131], v[160:163]
 v_add_u32 v10, 0x10000, v10
 ds_read_b64_tr_b16 v[80:81], v10 offset:16384
 s_mul_i32 s64, s64, 18432
 v_mfma_f32_16x16x32_bf16 v[164:167], v[84:87], a[132:135], v[164:167]
 ds_read_b64_tr_b16 v[82:83], v10 offset:20480
 v_mfma_f32_16x16x32_bf16 v[168:171], v[84:87], a[136:139], v[168:171]
 s_add_u32 s54, s55, 258304
 s_add_u32 s64, s64, 41943040
 v_mfma_f32_16x16x32_bf16 v[172:175], v[84:87], a[140:143], v[172:175]
 v_add_u32 v240, s64, v248
 s_waitcnt lgkmcnt(4)
 v_mfma_f32_16x16x32_bf16 v[176:179], v[88:91], a[128:131], v[176:179]
 v_add_u32 v11, 0x10000, v11
 ds_read_b64_tr_b16 v[84:85], v11 offset:16384
 s_add_u32 s64, s63, 1
 v_mfma_f32_16x16x32_bf16 v[180:183], v[88:91], a[132:135], v[180:183]
 ds_read_b64_tr_b16 v[86:87], v11 offset:20480
 v_mfma_f32_16x16x32_bf16 v[184:187], v[88:91], a[136:139], v[184:187]
 buffer_load_dwordx4 v6, s[24:27], s54 offen lds
 s_xor_b32 s64, s64, s62
 v_mfma_f32_16x16x32_bf16 v[188:191], v[88:91], a[140:143], v[188:191]
 s_mov_b32 s61, s64
 s_waitcnt lgkmcnt(4)
 v_mfma_f32_16x16x32_bf16 v[192:195], v[92:95], a[128:131], v[192:195]
 v_add_u32 v12, 0x10000, v12
 ds_read_b64_tr_b16 v[88:89], v12 offset:16384
 s_mul_i32 s64, s64, 18432
 v_mfma_f32_16x16x32_bf16 v[196:199], v[92:95], a[132:135], v[196:199]
 ds_read_b64_tr_b16 v[90:91], v12 offset:20480
 v_mfma_f32_16x16x32_bf16 v[200:203], v[92:95], a[136:139], v[200:203]
 buffer_load_dwordx4 v7, s[24:27], s54 offen offset:1024 lds
 s_add_u32 s64, s64, 41943040
 v_mfma_f32_16x16x32_bf16 v[204:207], v[92:95], a[140:143], v[204:207]
 v_add_u32 v241, s64, v248
 s_waitcnt lgkmcnt(4)
 v_mfma_f32_16x16x32_bf16 v[16:19], v[80:83], a[0:3], 0
 v_add_u32 v13, 0x10000, v13
 ds_read_b64_tr_b16 v[92:93], v13 offset:16384
 v_mfma_f32_16x16x32_bf16 v[20:23], v[80:83], a[4:7], 0
 ds_read_b64_tr_b16 v[94:95], v13 offset:20480
 v_mfma_f32_16x16x32_bf16 v[24:27], v[80:83], a[8:11], 0
 s_add_u32 m0, s53, 16384
 v_cvt_pk_bf16_f32 v224, v144, v145
 v_mfma_f32_16x16x32_bf16 v[28:31], v[80:83], a[12:15], 0
 v_cvt_pk_bf16_f32 v225, v146, v147
 s_waitcnt lgkmcnt(4)
 v_mfma_f32_16x16x32_bf16 v[32:35], v[84:87], a[0:3], 0
 v_add_u32 v10, 0xffff0000, v10
 ds_read_b64_tr_b16 v[80:81], v10 offset:24576
 v_mfma_f32_16x16x32_bf16 v[36:39], v[84:87], a[4:7], 0
 ds_read_b64_tr_b16 v[82:83], v10 offset:28672
 v_mfma_f32_16x16x32_bf16 v[40:43], v[84:87], a[8:11], 0
 s_add_u32 s54, s56, 256
 v_cvt_pk_bf16_f32 v226, v160, v161
 v_mfma_f32_16x16x32_bf16 v[44:47], v[84:87], a[12:15], 0
 v_cvt_pk_bf16_f32 v227, v162, v163
 s_waitcnt lgkmcnt(4)
 v_mfma_f32_16x16x32_bf16 v[48:51], v[88:91], a[0:3], 0
 v_add_u32 v11, 0xffff0000, v11
 ds_read_b64_tr_b16 v[84:85], v11 offset:24576
 v_mfma_f32_16x16x32_bf16 v[52:55], v[88:91], a[4:7], 0
 ds_read_b64_tr_b16 v[86:87], v11 offset:28672
 v_mfma_f32_16x16x32_bf16 v[56:59], v[88:91], a[8:11], 0
 buffer_load_dwordx4 v6, s[24:27], s54 offen lds
 s_mov_b32 s94, 0
 v_mfma_f32_16x16x32_bf16 v[60:63], v[88:91], a[12:15], 0
 buffer_store_dwordx4 v[224:227], v102, s[28:31], s94 offen sc1
 s_waitcnt lgkmcnt(4)
 v_mfma_f32_16x16x32_bf16 v[64:67], v[92:95], a[0:3], 0
 v_add_u32 v12, 0xffff0000, v12
 ds_read_b64_tr_b16 v[88:89], v12 offset:24576
 v_mfma_f32_16x16x32_bf16 v[68:71], v[92:95], a[4:7], 0
 ds_read_b64_tr_b16 v[90:91], v12 offset:28672
 v_mfma_f32_16x16x32_bf16 v[72:75], v[92:95], a[8:11], 0
 buffer_load_dwordx4 v7, s[24:27], s54 offen offset:1024 lds
 v_cvt_pk_bf16_f32 v228, v176, v177
 v_mfma_f32_16x16x32_bf16 v[76:79], v[92:95], a[12:15], 0
 v_cvt_pk_bf16_f32 v229, v178, v179
 s_waitcnt lgkmcnt(4)
 v_mfma_f32_16x16x32_bf16 v[16:19], v[80:83], a[16:19], v[16:19]
 v_add_u32 v13, 0xffff0000, v13
 ds_read_b64_tr_b16 v[92:93], v13 offset:24576
 v_mfma_f32_16x16x32_bf16 v[20:23], v[80:83], a[20:23], v[20:23]
 ds_read_b64_tr_b16 v[94:95], v13 offset:28672
 v_mfma_f32_16x16x32_bf16 v[24:27], v[80:83], a[24:27], v[24:27]
 s_add_u32 m0, s53, 65536
 v_cvt_pk_bf16_f32 v230, v192, v193
 v_mfma_f32_16x16x32_bf16 v[28:31], v[80:83], a[28:31], v[28:31]
 v_cvt_pk_bf16_f32 v231, v194, v195
 s_waitcnt lgkmcnt(4)
 v_mfma_f32_16x16x32_bf16 v[32:35], v[84:87], a[16:19], v[32:35]
 ds_read_b64_tr_b16 v[80:81], v10 offset:32768
 v_mfma_f32_16x16x32_bf16 v[36:39], v[84:87], a[20:23], v[36:39]
 ds_read_b64_tr_b16 v[82:83], v10 offset:36864
 v_mfma_f32_16x16x32_bf16 v[40:43], v[84:87], a[24:27], v[40:43]
 s_add_u32 s54, s55, 512
 s_mov_b32 s94, 16384
 v_mfma_f32_16x16x32_bf16 v[44:47], v[84:87], a[28:31], v[44:47]
 buffer_store_dwordx4 v[228:231], v102, s[28:31], s94 offen sc1
 s_waitcnt lgkmcnt(4)
 v_mfma_f32_16x16x32_bf16 v[48:51], v[88:91], a[16:19], v[48:51]
 ds_read_b64_tr_b16 v[84:85], v11 offset:32768
 v_mfma_f32_16x16x32_bf16 v[52:55], v[88:91], a[20:23], v[52:55]
 ds_read_b64_tr_b16 v[86:87], v11 offset:36864
 v_mfma_f32_16x16x32_bf16 v[56:59], v[88:91], a[24:27], v[56:59]
 buffer_load_dwordx4 v6, s[24:27], s54 offen lds
 v_cvt_pk_bf16_f32 v232, v148, v149
 v_mfma_f32_16x16x32_bf16 v[60:63], v[88:91], a[28:31], v[60:63]
 v_cvt_pk_bf16_f32 v233, v150, v151
 s_waitcnt lgkmcnt(4)
 v_mfma_f32_16x16x32_bf16 v[64:67], v[92:95], a[16:19], v[64:67]
 ds_read_b64_tr_b16 v[88:89], v12 offset:32768
 v_mfma_f32_16x16x32_bf16 v[68:71], v[92:95], a[20:23], v[68:71]
 ds_read_b64_tr_b16 v[90:91], v12 offset:36864
 v_mfma_f32_16x16x32_bf16 v[72:75], v[92:95], a[24:27], v[72:75]
 buffer_load_dwordx4 v7, s[24:27], s54 offen offset:1024 lds
 v_cvt_pk_bf16_f32 v234, v164, v165
 v_mfma_f32_16x16x32_bf16 v[76:79], v[92:95], a[28:31], v[76:79]
 v_cvt_pk_bf16_f32 v235, v166, v167
 s_waitcnt vmcnt(10)
 v_readfirstlane_b32 s57, v111
 s_nop 0
 s_lshr_b32 s57, s57, 16
 s_cmp_eq_u32 s57, 0xffff
 s_cbranch_scc1 L1_ook
 s_cmp_lg_u32 s48, 0
 s_cbranch_scc1 L1_ook
 s_mov_b32 s95, 0
L1_ospin:
 s_add_u32 s95, s95, 1
 s_cmp_ge_u32 s95, 0x80000
 s_cbranch_scc1 L1_ook
 s_sleep 8
 buffer_load_dword v111, v253, s[32:35], 0 offen sc1
 s_waitcnt vmcnt(0)
 v_readfirstlane_b32 s57, v111
 s_nop 0
 s_lshr_b32 s57, s57, 16
 s_cmp_eq_u32 s57, 0xffff
 s_cbranch_scc0 L1_ospin
L1_ook:
 s_waitcnt lgkmcnt(4)
 v_mfma_f32_16x16x32_bf16 v[16:19], v[80:83], a[32:35], v[16:19]
 ds_read_b64_tr_b16 v[92:93], v13 offset:32768
 v_mfma_f32_16x16x32_bf16 v[20:23], v[80:83], a[36:39], v[20:23]
 ds_read_b64_tr_b16 v[94:95], v13 offset:36864
 v_mfma_f32_16x16x32_bf16 v[24:27], v[80:83], a[40:43], v[24:27]
 s_add_u32 m0, s53, 73728
 s_mov_b32 s94, 294912
 v_mfma_f32_16x16x32_bf16 v[28:31], v[80:83], a[44:47], v[28:31]
 buffer_store_dwordx4 v[232:235], v102, s[28:31], s94 offen sc1
 s_barrier
 s_waitcnt lgkmcnt(4)
 v_mfma_f32_16x16x32_bf16 v[32:35], v[84:87], a[32:35], v[32:35]
 ds_read_b64_tr_b16 v[80:81], v10 offset:49152
 v_mfma_f32_16x16x32_bf16 v[36:39], v[84:87], a[36:39], v[36:39]
 ds_read_b64_tr_b16 v[82:83], v10 offset:53248
 v_mfma_f32_16x16x32_bf16 v[40:43], v[84:87], a[40:43], v[40:43]
 s_add_u32 s54, s55, 37376
 v_cvt_pk_bf16_f32 v236, v180, v181
 v_mfma_f32_16x16x32_bf16 v[44:47], v[84:87], a[44:47], v[44:47]
 v_cvt_pk_bf16_f32 v237, v182, v183
 s_waitcnt lgkmcnt(4)
 v_mfma_f32_16x16x32_bf16 v[48:51], v[88:91], a[32:35], v[48:51]
 ds_read_b64_tr_b16 v[84:85], v11 offset:49152
 v_mfma_f32_16x16x32_bf16 v[52:55], v[88:91], a[36:39], v[52:55]
 ds_read_b64_tr_b16 v[86:87], v11 offset:53248
 v_mfma_f32_16x16x32_bf16 v[56:59], v[88:91], a[40:43], v[56:59]
 buffer_load_dwordx4 v6, s[24:27], s54 offen lds
 v_cvt_pk_bf16_f32 v238, v196, v197
 v_mfma_f32_16x16x32_bf16 v[60:63], v[88:91], a[44:47], v[60:63]
 v_cvt_pk_bf16_f32 v239, v198, v199
 s_waitcnt lgkmcnt(4)
 v_mfma_f32_16x16x32_bf16 v[64:67], v[92:95], a[32:35], v[64:67]
 ds_read_b64_tr_b16 v[88:89], v12 offset:49152
 v_mfma_f32_16x16x32_bf16 v[68:71], v[92:95], a[36:39], v[68:71]
 ds_read_b64_tr_b16 v[90:91], v12 offset:53248
 v_mfma_f32_16x16x32_bf16 v[72:75], v[92:95], a[40:43], v[72:75]
 buffer_load_dwordx4 v7, s[24:27], s54 offen offset:1024 lds
 s_mov_b32 s94, 311296
 v_mfma_f32_16x16x32_bf16 v[76:79], v[92:95], a[44:47], v[76:79]
 buffer_store_dwordx4 v[236:239], v102, s[28:31], s94 offen sc1
 s_waitcnt lgkmcnt(4)
 v_mfma_f32_16x16x32_bf16 v[16:19], v[80:83], a[48:51], v[16:19]
 ds_read_b64_tr_b16 v[92:93], v13 offset:49152
 v_mfma_f32_16x16x32_bf16 v[20:23], v[80:83], a[52:55], v[20:23]
 ds_read_b64_tr_b16 v[94:95], v13 offset:53248
 v_mfma_f32_16x16x32_bf16 v[24:27], v[80:83], a[56:59], v[24:27]
 s_add_u32 m0, s53, 24576
 v_cvt_pk_bf16_f32 v224, v152, v153
 v_mfma_f32_16x16x32_bf16 v[28:31], v[80:83], a[60:63], v[28:31]
 s_waitcnt lgkmcnt(4)
 v_mfma_f32_16x16x32_bf16 v[32:35], v[84:87], a[48:51], v[32:35]
 v_add_u32 v10, 0x10000, v10
 ds_read_b64_tr_b16 v[80:81], v10 offset:24576
 v_mfma_f32_16x16x32_bf16 v[36:39], v[84:87], a[52:55], v[36:39]
 ds_read_b64_tr_b16 v[82:83], v10 offset:28672
 v_mfma_f32_16x16x32_bf16 v[40:43], v[84:87], a[56:59], v[40:43]
 s_add_u32 s54, s55, 74240
 v_cvt_pk_bf16_f32 v225, v154, v155
 v_mfma_f32_16x16x32_bf16 v[44:47], v[84:87], a[60:63], v[44:47]
 s_waitcnt lgkmcnt(4)
 v_mfma_f32_16x16x32_bf16 v[48:51], v[88:91], a[48:51], v[48:51]
 v_add_u32 v11, 0x10000, v11
 ds_read_b64_tr_b16 v[84:85], v11 offset:24576
 v_mfma_f32_16x16x32_bf16 v[52:55], v[88:91], a[52:55], v[52:55]
 ds_read_b64_tr_b16 v[86:87], v11 offset:28672
 v_mfma_f32_16x16x32_bf16 v[56:59], v[88:91], a[56:59], v[56:59]
 buffer_load_dwordx4 v6, s[24:27], s54 offen lds
 v_cvt_pk_bf16_f32 v226, v168, v169
 v_mfma_f32_16x16x32_bf16 v[60:63], v[88:91], a[60:63], v[60:63]
 s_waitcnt lgkmcnt(4)
 v_mfma_f32_16x16x32_bf16 v[64:67], v[92:95], a[48:51], v[64:67]
 v_add_u32 v12, 0x10000, v12
 ds_read_b64_tr_b16 v[88:89], v12 offset:24576
 v_mfma_f32_16x16x32_bf16 v[68:71], v[92:95], a[52:55], v[68:71]
 ds_read_b64_tr_b16 v[90:91], v12 offset:28672
 v_mfma_f32_16x16x32_bf16 v[72:75], v[92:95], a[56:59], v[72:75]
 buffer_load_dwordx4 v7, s[24:27], s54 offen offset:1024 lds
 v_cvt_pk_bf16_f32 v227, v170, v171
 v_mfma_f32_16x16x32_bf16 v[76:79], v[92:95], a[60:63], v[76:79]
 v_lshrrev_b32 v248, 4, v0
 v_lshrrev_b32 v249, 2, v0
 v_and_b32 v249, 3, v249
 v_lshl_add_u32 v250, v248, 2, v249
 v_lshrrev_b32 v251, 1, v250
 v_and_b32 v251, 3, v251
 v_lshlrev_b32 v250, 7, v250
 v_and_b32 v248, 3, v0
 v_lshl_add_u32 v250, v248, 3, v250
 s_lshl_b32 s57, s50, 1
 s_add_u32 s57, s57, 0
 v_xor_b32 v248, s57, v251
 v_lshl_add_u32 v14, v248, 5, v250
 s_lshl_b32 s57, s50, 1
 s_add_u32 s57, s57, 1
 v_xor_b32 v248, s57, v251
 v_lshl_add_u32 v15, v248, 5, v250
 s_waitcnt lgkmcnt(4)
 v_mfma_f32_16x16x32_bf16 v[16:19], v[80:83], a[64:67], v[16:19]
 v_add_u32 v13, 0x10000, v13
 ds_read_b64_tr_b16 v[92:93], v13 offset:24576
 v_mfma_f32_16x16x32_bf16 v[20:23], v[80:83], a[68:71], v[20:23]
 ds_read_b64_tr_b16 v[94:95], v13 offset:28672
 v_mfma_f32_16x16x32_bf16 v[24:27], v[80:83], a[72:75], v[24:27]
 s_add_u32 m0, s53, 57344
 s_mov_b32 s94, 589824
 v_mfma_f32_16x16x32_bf16 v[28:31], v[80:83], a[76:79], v[28:31]
 s_waitcnt lgkmcnt(4)
 v_mfma_f32_16x16x32_bf16 v[32:35], v[84:87], a[64:67], v[32:35]
 v_add_u32 v10, 0xffff0000, v10
 ds_read_b64_tr_b16 v[80:81], v10 offset:0
 v_mfma_f32_16x16x32_bf16 v[36:39], v[84:87], a[68:71], v[36:39]
 ds_read_b64_tr_b16 v[82:83], v10 offset:4096
 v_mfma_f32_16x16x32_bf16 v[40:43], v[84:87], a[72:75], v[40:43]
 s_add_u32 s54, s55, 111104
 buffer_store_dwordx4 v[224:227], v102, s[28:31], s94 offen sc1
 v_mfma_f32_16x16x32_bf16 v[44:47], v[84:87], a[76:79], v[44:47]
 s_waitcnt lgkmcnt(4)
 v_mfma_f32_16x16x32_bf16 v[48:51], v[88:91], a[64:67], v[48:51]
 v_add_u32 v11, 0xffff0000, v11
 ds_read_b64_tr_b16 v[84:85], v11 offset:0
 v_mfma_f32_16x16x32_bf16 v[52:55], v[88:91], a[68:71], v[52:55]
 ds_read_b64_tr_b16 v[86:87], v11 offset:4096
 v_mfma_f32_16x16x32_bf16 v[56:59], v[88:91], a[72:75], v[56:59]
 buffer_load_dwordx4 v6, s[24:27], s54 offen lds
 v_cvt_pk_bf16_f32 v228, v184, v185
 v_mfma_f32_16x16x32_bf16 v[60:63], v[88:91], a[76:79], v[60:63]
 s_waitcnt lgkmcnt(4)
 v_mfma_f32_16x16x32_bf16 v[64:67], v[92:95], a[64:67], v[64:67]
 v_add_u32 v12, 0xffff0000, v12
 ds_read_b64_tr_b16 v[88:89], v12 offset:0
 v_mfma_f32_16x16x32_bf16 v[68:71], v[92:95], a[68:71], v[68:71]
 ds_read_b64_tr_b16 v[90:91], v12 offset:4096
 v_mfma_f32_16x16x32_bf16 v[72:75], v[92:95], a[72:75], v[72:75]
 buffer_load_dwordx4 v7, s[24:27], s54 offen offset:1024 lds
 v_cvt_pk_bf16_f32 v229, v186, v187
 v_mfma_f32_16x16x32_bf16 v[76:79], v[92:95], a[76:79], v[76:79]
 s_waitcnt lgkmcnt(4)
 v_mfma_f32_16x16x32_bf16 v[16:19], v[80:83], a[80:83], v[16:19]
 v_add_u32 v13, 0xffff0000, v13
 ds_read_b64_tr_b16 v[92:93], v13 offset:0
 v_mfma_f32_16x16x32_bf16 v[20:23], v[80:83], a[84:87], v[20:23]
 ds_read_b64_tr_b16 v[94:95], v13 offset:4096
 v_mfma_f32_16x16x32_bf16 v[24:27], v[80:83], a[88:91], v[24:27]
 s_add_u32 m0, s53, 81920
 v_cvt_pk_bf16_f32 v230, v200, v201
 v_mfma_f32_16x16x32_bf16 v[28:31], v[80:83], a[92:95], v[28:31]
 s_waitcnt vmcnt(12)
 s_barrier
 s_waitcnt lgkmcnt(4)
 v_mfma_f32_16x16x32_bf16 v[32:35], v[84:87], a[80:83], v[32:35]
 ds_read_b64_tr_b16 v[80:81], v10 offset:8192
 v_mfma_f32_16x16x32_bf16 v[36:39], v[84:87], a[84:87], v[36:39]
 ds_read_b64_tr_b16 v[82:83], v10 offset:12288
 v_mfma_f32_16x16x32_bf16 v[40:43], v[84:87], a[88:91], v[40:43]
 s_add_u32 s54, s55, 147968
 v_cvt_pk_bf16_f32 v231, v202, v203
 v_mfma_f32_16x16x32_bf16 v[44:47], v[84:87], a[92:95], v[44:47]
 s_waitcnt lgkmcnt(4)
 v_mfma_f32_16x16x32_bf16 v[48:51], v[88:91], a[80:83], v[48:51]
 ds_read_b64_tr_b16 v[84:85], v11 offset:8192
 v_mfma_f32_16x16x32_bf16 v[52:55], v[88:91], a[84:87], v[52:55]
 ds_read_b64_tr_b16 v[86:87], v11 offset:12288
 v_mfma_f32_16x16x32_bf16 v[56:59], v[88:91], a[88:91], v[56:59]
 buffer_load_dwordx4 v6, s[24:27], s54 offen lds
 s_mov_b32 s94, 606208
 v_mfma_f32_16x16x32_bf16 v[60:63], v[88:91], a[92:95], v[60:63]
 s_waitcnt lgkmcnt(4)
 v_mfma_f32_16x16x32_bf16 v[64:67], v[92:95], a[80:83], v[64:67]
 ds_read_b64_tr_b16 v[88:89], v12 offset:8192
 v_mfma_f32_16x16x32_bf16 v[68:71], v[92:95], a[84:87], v[68:71]
 ds_read_b64_tr_b16 v[90:91], v12 offset:12288
 v_mfma_f32_16x16x32_bf16 v[72:75], v[92:95], a[88:91], v[72:75]
 buffer_load_dwordx4 v7, s[24:27], s54 offen offset:1024 lds
 buffer_store_dwordx4 v[228:231], v102, s[28:31], s94 offen sc1
 v_mfma_f32_16x16x32_bf16 v[76:79], v[92:95], a[92:95], v[76:79]
 s_waitcnt lgkmcnt(4)
 v_mfma_f32_16x16x32_bf16 v[16:19], v[80:83], a[96:99], v[16:19]
 ds_read_b64_tr_b16 v[92:93], v13 offset:8192
 v_mfma_f32_16x16x32_bf16 v[20:23], v[80:83], a[100:103], v[20:23]
 ds_read_b64_tr_b16 v[94:95], v13 offset:12288
 v_mfma_f32_16x16x32_bf16 v[24:27], v[80:83], a[104:107], v[24:27]
 s_add_u32 m0, s53, 32768
 v_cvt_pk_bf16_f32 v232, v156, v157
 v_mfma_f32_16x16x32_bf16 v[28:31], v[80:83], a[108:111], v[28:31]
 s_waitcnt lgkmcnt(4)
 v_mfma_f32_16x16x32_bf16 v[32:35], v[84:87], a[96:99], v[32:35]
 ds_read_b64_tr_b16 v[80:81], v10 offset:40960
 v_mfma_f32_16x16x32_bf16 v[36:39], v[84:87], a[100:103], v[36:39]
 ds_read_b64_tr_b16 v[82:83], v10 offset:45056
 v_mfma_f32_16x16x32_bf16 v[40:43], v[84:87], a[104:107], v[40:43]
 s_add_u32 s54, s55, 184832
 v_cvt_pk_bf16_f32 v233, v158, v159
 v_mfma_f32_16x16x32_bf16 v[44:47], v[84:87], a[108:111], v[44:47]
 s_waitcnt lgkmcnt(4)
 v_mfma_f32_16x16x32_bf16 v[48:51], v[88:91], a[96:99], v[48:51]
 ds_read_b64_tr_b16 v[84:85], v11 offset:40960
 v_mfma_f32_16x16x32_bf16 v[52:55], v[88:91], a[100:103], v[52:55]
 ds_read_b64_tr_b16 v[86:87], v11 offset:45056
 v_mfma_f32_16x16x32_bf16 v[56:59], v[88:91], a[104:107], v[56:59]
 buffer_load_dwordx4 v6, s[24:27], s54 offen lds
 v_cvt_pk_bf16_f32 v234, v172, v173
 v_mfma_f32_16x16x32_bf16 v[60:63], v[88:91], a[108:111], v[60:63]
 s_waitcnt lgkmcnt(4)
 v_mfma_f32_16x16x32_bf16 v[64:67], v[92:95], a[96:99], v[64:67]
 ds_read_b64_tr_b16 v[88:89], v12 offset:40960
 v_mfma_f32_16x16x32_bf16 v[68:71], v[92:95], a[100:103], v[68:71]
 ds_read_b64_tr_b16 v[90:91], v12 offset:45056
 v_mfma_f32_16x16x32_bf16 v[72:75], v[92:95], a[104:107], v[72:75]
 buffer_load_dwordx4 v7, s[24:27], s54 offen offset:1024 lds
 v_cvt_pk_bf16_f32 v235, v174, v175
 v_mfma_f32_16x16x32_bf16 v[76:79], v[92:95], a[108:111], v[76:79]
 s_waitcnt lgkmcnt(4)
 v_mfma_f32_16x16x32_bf16 v[16:19], v[80:83], a[112:115], v[16:19]
 ds_read_b64_tr_b16 v[92:93], v13 offset:40960
 v_mfma_f32_16x16x32_bf16 v[20:23], v[80:83], a[116:119], v[20:23]
 ds_read_b64_tr_b16 v[94:95], v13 offset:45056
 v_mfma_f32_16x16x32_bf16 v[24:27], v[80:83], a[120:123], v[24:27]
 s_add_u32 m0, s53, 49152
 s_mov_b32 s94, 884736
 v_mfma_f32_16x16x32_bf16 v[28:31], v[80:83], a[124:127], v[28:31]
 s_waitcnt lgkmcnt(4)
 v_mfma_f32_16x16x32_bf16 v[32:35], v[84:87], a[112:115], v[32:35]
 ds_read_b64_tr_b16 v[80:81], v10 offset:16384
 v_mfma_f32_16x16x32_bf16 v[36:39], v[84:87], a[116:119], v[36:39]
 ds_read_b64_tr_b16 v[82:83], v10 offset:20480
 v_mfma_f32_16x16x32_bf16 v[40:43], v[84:87], a[120:123], v[40:43]
 s_add_u32 s54, s55, 221696
 buffer_store_dwordx4 v[232:235], v102, s[28:31], s94 offen sc1
 v_mfma_f32_16x16x32_bf16 v[44:47], v[84:87], a[124:127], v[44:47]
 s_waitcnt lgkmcnt(4)
 v_mfma_f32_16x16x32_bf16 v[48:51], v[88:91], a[112:115], v[48:51]
 ds_read_b64_tr_b16 v[84:85], v11 offset:16384
 v_mfma_f32_16x16x32_bf16 v[52:55], v[88:91], a[116:119], v[52:55]
 ds_read_b64_tr_b16 v[86:87], v11 offset:20480
 v_mfma_f32_16x16x32_bf16 v[56:59], v[88:91], a[120:123], v[56:59]
 buffer_load_dwordx4 v6, s[24:27], s54 offen lds
 v_cvt_pk_bf16_f32 v236, v188, v189
 v_mfma_f32_16x16x32_bf16 v[60:63], v[88:91], a[124:127], v[60:63]
 s_waitcnt lgkmcnt(4)
 v_mfma_f32_16x16x32_bf16 v[64:67], v[92:95], a[112:115], v[64:67]
 ds_read_b64_tr_b16 v[88:89], v12 offset:16384
 v_mfma_f32_16x16x32_bf16 v[68:71], v[92:95], a[116:119], v[68:71]
 ds_read_b64_tr_b16 v[90:91], v12 offset:20480
 v_mfma_f32_16x16x32_bf16 v[72:75], v[92:95], a[120:123], v[72:75]
 buffer_load_dwordx4 v7, s[24:27], s54 offen offset:1024 lds
 v_cvt_pk_bf16_f32 v237, v190, v191
 v_mfma_f32_16x16x32_bf16 v[76:79], v[92:95], a[124:127], v[76:79]
 s_waitcnt lgkmcnt(4)
 v_mfma_f32_16x16x32_bf16 v[16:19], v[80:83], a[128:131], v[16:19]
 ds_read_b64_tr_b16 v[92:93], v13 offset:16384
 v_mfma_f32_16x16x32_bf16 v[20:23], v[80:83], a[132:135], v[20:23]
 ds_read_b64_tr_b16 v[94:95], v13 offset:20480
 v_mfma_f32_16x16x32_bf16 v[24:27], v[80:83], a[136:139], v[24:27]
 s_add_u32 m0, s53, 90112
 v_cvt_pk_bf16_f32 v238, v204, v205
 v_mfma_f32_16x16x32_bf16 v[28:31], v[80:83], a[140:143], v[28:31]
 s_waitcnt vmcnt(11)
 s_barrier
 s_waitcnt lgkmcnt(4)
 v_mfma_f32_16x16x32_bf16 v[32:35], v[84:87], a[128:131], v[32:35]
 v_add_u32 v10, 0x10000, v10
 ds_read_b64_tr_b16 v[80:81], v10 offset:0
 v_mfma_f32_16x16x32_bf16 v[36:39], v[84:87], a[132:135], v[36:39]
 ds_read_b64_tr_b16 v[82:83], v10 offset:4096
 v_mfma_f32_16x16x32_bf16 v[40:43], v[84:87], a[136:139], v[40:43]
 s_add_u32 s54, s55, 258560
 v_cvt_pk_bf16_f32 v239, v206, v207
 v_mfma_f32_16x16x32_bf16 v[44:47], v[84:87], a[140:143], v[44:47]
 s_waitcnt lgkmcnt(4)
 v_mfma_f32_16x16x32_bf16 v[48:51], v[88:91], a[128:131], v[48:51]
 v_add_u32 v11, 0x10000, v11
 ds_read_b64_tr_b16 v[84:85], v11 offset:0
 v_mfma_f32_16x16x32_bf16 v[52:55], v[88:91], a[132:135], v[52:55]
 ds_read_b64_tr_b16 v[86:87], v11 offset:4096
 v_mfma_f32_16x16x32_bf16 v[56:59], v[88:91], a[136:139], v[56:59]
 buffer_load_dwordx4 v6, s[24:27], s54 offen lds
 s_mov_b32 s94, 901120
 v_mfma_f32_16x16x32_bf16 v[60:63], v[88:91], a[140:143], v[60:63]
 s_waitcnt lgkmcnt(4)
 v_mfma_f32_16x16x32_bf16 v[64:67], v[92:95], a[128:131], v[64:67]
 v_add_u32 v12, 0x10000, v12
 ds_read_b64_tr_b16 v[88:89], v12 offset:0
 v_mfma_f32_16x16x32_bf16 v[68:71], v[92:95], a[132:135], v[68:71]
 ds_read_b64_tr_b16 v[90:91], v12 offset:4096
 v_mfma_f32_16x16x32_bf16 v[72:75], v[92:95], a[136:139], v[72:75]
 buffer_load_dwordx4 v7, s[24:27], s54 offen offset:1024 lds
 buffer_store_dwordx4 v[236:239], v102, s[28:31], s94 offen sc1
 v_mfma_f32_16x16x32_bf16 v[76:79], v[92:95], a[140:143], v[76:79]
 s_waitcnt lgkmcnt(4)
 v_mfma_f32_16x16x32_bf16 v[144:147], v[80:83], a[0:3], 0
 v_add_u32 v13, 0x10000, v13
 ds_read_b64_tr_b16 v[92:93], v13 offset:0
 v_mfma_f32_16x16x32_bf16 v[148:151], v[80:83], a[4:7], 0
 ds_read_b64_tr_b16 v[94:95], v13 offset:4096
 v_mfma_f32_16x16x32_bf16 v[152:155], v[80:83], a[8:11], 0
 s_add_u32 m0, s53, 0
 v_cvt_pk_bf16_f32 v224, v16, v17
 v_mfma_f32_16x16x32_bf16 v[156:159], v[80:83], a[12:15], 0
 v_cvt_pk_bf16_f32 v225, v18, v19
 s_waitcnt lgkmcnt(4)
 v_mfma_f32_16x16x32_bf16 v[160:163], v[84:87], a[0:3], 0
 ds_read_b64_tr_b16 v[80:81], v10 offset:8192
 v_mfma_f32_16x16x32_bf16 v[164:167], v[84:87], a[4:7], 0
 ds_read_b64_tr_b16 v[82:83], v10 offset:12288
 v_mfma_f32_16x16x32_bf16 v[168:171], v[84:87], a[8:11], 0
 s_add_u32 s54, s56, 512
 v_cvt_pk_bf16_f32 v226, v32, v33
 v_mfma_f32_16x16x32_bf16 v[172:175], v[84:87], a[12:15], 0
 v_cvt_pk_bf16_f32 v227, v34, v35
 s_waitcnt lgkmcnt(4)
 v_mfma_f32_16x16x32_bf16 v[176:179], v[88:91], a[0:3], 0
 ds_read_b64_tr_b16 v[84:85], v11 offset:8192
 v_mfma_f32_16x16x32_bf16 v[180:183], v[88:91], a[4:7], 0
 ds_read_b64_tr_b16 v[86:87], v11 offset:12288
 v_mfma_f32_16x16x32_bf16 v[184:187], v[88:91], a[8:11], 0
 buffer_load_dwordx4 v6, s[24:27], s54 offen lds
 s_mov_b32 s94, 65536
 v_mfma_f32_16x16x32_bf16 v[188:191], v[88:91], a[12:15], 0
 buffer_store_dwordx4 v[224:227], v102, s[28:31], s94 offen sc1
 s_waitcnt lgkmcnt(4)
 v_mfma_f32_16x16x32_bf16 v[192:195], v[92:95], a[0:3], 0
 ds_read_b64_tr_b16 v[88:89], v12 offset:8192
 v_mfma_f32_16x16x32_bf16 v[196:199], v[92:95], a[4:7], 0
 ds_read_b64_tr_b16 v[90:91], v12 offset:12288
 v_mfma_f32_16x16x32_bf16 v[200:203], v[92:95], a[8:11], 0
 buffer_load_dwordx4 v7, s[24:27], s54 offen offset:1024 lds
 v_cvt_pk_bf16_f32 v228, v48, v49
 v_mfma_f32_16x16x32_bf16 v[204:207], v[92:95], a[12:15], 0
 v_cvt_pk_bf16_f32 v229, v50, v51
 s_waitcnt lgkmcnt(4)
 v_mfma_f32_16x16x32_bf16 v[144:147], v[80:83], a[16:19], v[144:147]
 ds_read_b64_tr_b16 v[92:93], v13 offset:8192
 v_mfma_f32_16x16x32_bf16 v[148:151], v[80:83], a[20:23], v[148:151]
 ds_read_b64_tr_b16 v[94:95], v13 offset:12288
 v_mfma_f32_16x16x32_bf16 v[152:155], v[80:83], a[24:27], v[152:155]
 s_add_u32 m0, s53, 8192
 v_cvt_pk_bf16_f32 v230, v64, v65
 v_mfma_f32_16x16x32_bf16 v[156:159], v[80:83], a[28:31], v[156:159]
 v_cvt_pk_bf16_f32 v231, v66, v67
 s_waitcnt lgkmcnt(4)
 v_mfma_f32_16x16x32_bf16 v[160:163], v[84:87], a[16:19], v[160:163]
 v_add_u32 v10, 0xffff0000, v10
 ds_read_b64_tr_b16 v[80:81], v10 offset:24576
 v_mfma_f32_16x16x32_bf16 v[164:167], v[84:87], a[20:23], v[164:167]
 ds_read_b64_tr_b16 v[82:83], v10 offset:28672
 v_mfma_f32_16x16x32_bf16 v[168:171], v[84:87], a[24:27], v[168:171]
 s_add_u32 s54, s55, 768
 s_mov_b32 s94, 81920
 v_mfma_f32_16x16x32_bf16 v[172:175], v[84:87], a[28:31], v[172:175]
 buffer_store_dwordx4 v[228:231], v102, s[28:31], s94 offen sc1
 s_waitcnt lgkmcnt(4)
 v_mfma_f32_16x16x32_bf16 v[176:179], v[88:91], a[16:19], v[176:179]
 v_add_u32 v11, 0xffff0000, v11
 ds_read_b64_tr_b16 v[84:85], v11 offset:24576
 v_mfma_f32_16x16x32_bf16 v[180:183], v[88:91], a[20:23], v[180:183]
 ds_read_b64_tr_b16 v[86:87], v11 offset:28672
 v_mfma_f32_16x16x32_bf16 v[184:187], v[88:91], a[24:27], v[184:187]
 buffer_load_dwordx4 v6, s[24:27], s54 offen lds
 v_cvt_pk_bf16_f32 v232, v20, v21
 v_mfma_f32_16x16x32_bf16 v[188:191], v[88:91], a[28:31], v[188:191]
 v_cvt_pk_bf16_f32 v233, v22, v23
 s_waitcnt lgkmcnt(4)
 v_mfma_f32_16x16x32_bf16 v[192:195], v[92:95], a[16:19], v[192:195]
 v_add_u32 v12, 0xffff0000, v12
 ds_read_b64_tr_b16 v[88:89], v12 offset:24576
 v_mfma_f32_16x16x32_bf16 v[196:199], v[92:95], a[20:23], v[196:199]
 ds_read_b64_tr_b16 v[90:91], v12 offset:28672
 v_mfma_f32_16x16x32_bf16 v[200:203], v[92:95], a[24:27], v[200:203]
 buffer_load_dwordx4 v7, s[24:27], s54 offen offset:1024 lds
 v_cvt_pk_bf16_f32 v234, v36, v37
 v_mfma_f32_16x16x32_bf16 v[204:207], v[92:95], a[28:31], v[204:207]
 v_cvt_pk_bf16_f32 v235, v38, v39
 s_waitcnt lgkmcnt(4)
 v_mfma_f32_16x16x32_bf16 v[144:147], v[80:83], a[32:35], v[144:147]
 v_add_u32 v13, 0xffff0000, v13
 ds_read_b64_tr_b16 v[92:93], v13 offset:24576
 v_mfma_f32_16x16x32_bf16 v[148:151], v[80:83], a[36:39], v[148:151]
 ds_read_b64_tr_b16 v[94:95], v13 offset:28672
 v_mfma_f32_16x16x32_bf16 v[152:155], v[80:83], a[40:43], v[152:155]
 s_add_u32 m0, s53, 40960
 s_mov_b32 s94, 360448
 v_mfma_f32_16x16x32_bf16 v[156:159], v[80:83], a[44:47], v[156:159]
 buffer_store_dwordx4 v[232:235], v102, s[28:31], s94 offen sc1
 s_waitcnt vmcnt(13)
 s_barrier
 s_waitcnt lgkmcnt(4)
 v_mfma_f32_16x16x32_bf16 v[160:163], v[84:87], a[32:35], v[160:163]
 ds_read_b64_tr_b16 v[80:81], v10 offset:57344
 v_mfma_f32_16x16x32_bf16 v[164:167], v[84:87], a[36:39], v[164:167]
 ds_read_b64_tr_b16 v[82:83], v10 offset:61440
 v_mfma_f32_16x16x32_bf16 v[168:171], v[84:87], a[40:43], v[168:171]
 s_add_u32 s54, s55, 37632
 v_cvt_pk_bf16_f32 v236, v52, v53
 v_mfma_f32_16x16x32_bf16 v[172:175], v[84:87], a[44:47], v[172:175]
 v_cvt_pk_bf16_f32 v237, v54, v55
 s_waitcnt lgkmcnt(4)
 v_mfma_f32_16x16x32_bf16 v[176:179], v[88:91], a[32:35], v[176:179]
 ds_read_b64_tr_b16 v[84:85], v11 offset:57344
 v_mfma_f32_16x16x32_bf16 v[180:183], v[88:91], a[36:39], v[180:183]
 ds_read_b64_tr_b16 v[86:87], v11 offset:61440
 v_mfma_f32_16x16x32_bf16 v[184:187], v[88:91], a[40:43], v[184:187]
 buffer_load_dwordx4 v6, s[24:27], s54 offen lds
 v_cvt_pk_bf16_f32 v238, v68, v69
 v_mfma_f32_16x16x32_bf16 v[188:191], v[88:91], a[44:47], v[188:191]
 v_cvt_pk_bf16_f32 v239, v70, v71
 s_waitcnt lgkmcnt(4)
 v_mfma_f32_16x16x32_bf16 v[192:195], v[92:95], a[32:35], v[192:195]
 ds_read_b64_tr_b16 v[88:89], v12 offset:57344
 v_mfma_f32_16x16x32_bf16 v[196:199], v[92:95], a[36:39], v[196:199]
 ds_read_b64_tr_b16 v[90:91], v12 offset:61440
 v_mfma_f32_16x16x32_bf16 v[200:203], v[92:95], a[40:43], v[200:203]
 buffer_load_dwordx4 v7, s[24:27], s54 offen offset:1024 lds
 s_mov_b32 s94, 376832
 v_mfma_f32_16x16x32_bf16 v[204:207], v[92:95], a[44:47], v[204:207]
 buffer_store_dwordx4 v[236:239], v102, s[28:31], s94 offen sc1
 s_waitcnt lgkmcnt(4)
 v_mfma_f32_16x16x32_bf16 v[144:147], v[80:83], a[48:51], v[144:147]
 ds_read_b64_tr_b16 v[92:93], v13 offset:57344
 v_mfma_f32_16x16x32_bf16 v[148:151], v[80:83], a[52:55], v[148:151]
 ds_read_b64_tr_b16 v[94:95], v13 offset:61440
 v_mfma_f32_16x16x32_bf16 v[152:155], v[80:83], a[56:59], v[152:155]
 s_add_u32 m0, s53, 16384
 v_cvt_pk_bf16_f32 v224, v24, v25
 v_mfma_f32_16x16x32_bf16 v[156:159], v[80:83], a[60:63], v[156:159]
 s_waitcnt lgkmcnt(4)
 v_mfma_f32_16x16x32_bf16 v[160:163], v[84:87], a[48:51], v[160:163]
 v_add_u32 v10, 0x10000, v10
 ds_read_b64_tr_b16 v[80:81], v10 offset:16384
 v_mfma_f32_16x16x32_bf16 v[164:167], v[84:87], a[52:55], v[164:167]
 ds_read_b64_tr_b16 v[82:83], v10 offset:20480
 v_mfma_f32_16x16x32_bf16 v[168:171], v[84:87], a[56:59], v[168:171]
 s_add_u32 s54, s55, 74496
 v_cvt_pk_bf16_f32 v225, v26, v27
 v_mfma_f32_16x16x32_bf16 v[172:175], v[84:87], a[60:63], v[172:175]
 s_waitcnt lgkmcnt(4)
 v_mfma_f32_16x16x32_bf16 v[176:179], v[88:91], a[48:51], v[176:179]
 v_add_u32 v11, 0x10000, v11
 ds_read_b64_tr_b16 v[84:85], v11 offset:16384
 v_mfma_f32_16x16x32_bf16 v[180:183], v[88:91], a[52:55], v[180:183]
 ds_read_b64_tr_b16 v[86:87], v11 offset:20480
 v_mfma_f32_16x16x32_bf16 v[184:187], v[88:91], a[56:59], v[184:187]
 buffer_load_dwordx4 v6, s[24:27], s54 offen lds
 v_cvt_pk_bf16_f32 v226, v40, v41
 v_mfma_f32_16x16x32_bf16 v[188:191], v[88:91], a[60:63], v[188:191]
 s_waitcnt lgkmcnt(4)
 v_mfma_f32_16x16x32_bf16 v[192:195], v[92:95], a[48:51], v[192:195]
 v_add_u32 v12, 0x10000, v12
 ds_read_b64_tr_b16 v[88:89], v12 offset:16384
 v_mfma_f32_16x16x32_bf16 v[196:199], v[92:95], a[52:55], v[196:199]
 ds_read_b64_tr_b16 v[90:91], v12 offset:20480
 v_mfma_f32_16x16x32_bf16 v[200:203], v[92:95], a[56:59], v[200:203]
 buffer_load_dwordx4 v7, s[24:27], s54 offen offset:1024 lds
 v_cvt_pk_bf16_f32 v227, v42, v43
 v_mfma_f32_16x16x32_bf16 v[204:207], v[92:95], a[60:63], v[204:207]
 s_waitcnt lgkmcnt(4)
 v_mfma_f32_16x16x32_bf16 v[144:147], v[80:83], a[64:67], v[144:147]
 v_add_u32 v13, 0x10000, v13
 ds_read_b64_tr_b16 v[92:93], v13 offset:16384
 v_mfma_f32_16x16x32_bf16 v[148:151], v[80:83], a[68:71], v[148:151]
 ds_read_b64_tr_b16 v[94:95], v13 offset:20480
 v_mfma_f32_16x16x32_bf16 v[152:155], v[80:83], a[72:75], v[152:155]
 s_add_u32 m0, s53, 65536
 s_mov_b32 s94, 655360
 v_mfma_f32_16x16x32_bf16 v[156:159], v[80:83], a[76:79], v[156:159]
 s_waitcnt lgkmcnt(4)
 v_mfma_f32_16x16x32_bf16 v[160:163], v[84:87], a[64:67], v[160:163]
 v_add_u32 v10, 0xffff0000, v10
 ds_read_b64_tr_b16 v[80:81], v10 offset:32768
 v_mfma_f32_16x16x32_bf16 v[164:167], v[84:87], a[68:71], v[164:167]
 ds_read_b64_tr_b16 v[82:83], v10 offset:36864
 v_mfma_f32_16x16x32_bf16 v[168:171], v[84:87], a[72:75], v[168:171]
 s_add_u32 s54, s55, 111360
 buffer_store_dwordx4 v[224:227], v102, s[28:31], s94 offen sc1
 v_mfma_f32_16x16x32_bf16 v[172:175], v[84:87], a[76:79], v[172:175]
 s_waitcnt lgkmcnt(4)
 v_mfma_f32_16x16x32_bf16 v[176:179], v[88:91], a[64:67], v[176:179]
 v_add_u32 v11, 0xffff0000, v11
 ds_read_b64_tr_b16 v[84:85], v11 offset:32768
 v_mfma_f32_16x16x32_bf16 v[180:183], v[88:91], a[68:71], v[180:183]
 ds_read_b64_tr_b16 v[86:87], v11 offset:36864
 v_mfma_f32_16x16x32_bf16 v[184:187], v[88:91], a[72:75], v[184:187]
 buffer_load_dwordx4 v6, s[24:27], s54 offen lds
 v_cvt_pk_bf16_f32 v228, v56, v57
 v_mfma_f32_16x16x32_bf16 v[188:191], v[88:91], a[76:79], v[188:191]
 s_waitcnt lgkmcnt(4)
 v_mfma_f32_16x16x32_bf16 v[192:195], v[92:95], a[64:67], v[192:195]
 v_add_u32 v12, 0xffff0000, v12
 ds_read_b64_tr_b16 v[88:89], v12 offset:32768
 v_mfma_f32_16x16x32_bf16 v[196:199], v[92:95], a[68:71], v[196:199]
 ds_read_b64_tr_b16 v[90:91], v12 offset:36864
 v_mfma_f32_16x16x32_bf16 v[200:203], v[92:95], a[72:75], v[200:203]
 buffer_load_dwordx4 v7, s[24:27], s54 offen offset:1024 lds
 v_cvt_pk_bf16_f32 v229, v58, v59
 v_mfma_f32_16x16x32_bf16 v[204:207], v[92:95], a[76:79], v[204:207]
 s_waitcnt lgkmcnt(4)
 v_mfma_f32_16x16x32_bf16 v[144:147], v[80:83], a[80:83], v[144:147]
 v_add_u32 v13, 0xffff0000, v13
 ds_read_b64_tr_b16 v[92:93], v13 offset:32768
 v_mfma_f32_16x16x32_bf16 v[148:151], v[80:83], a[84:87], v[148:151]
 ds_read_b64_tr_b16 v[94:95], v13 offset:36864
 v_mfma_f32_16x16x32_bf16 v[152:155], v[80:83], a[88:91], v[152:155]
 s_add_u32 m0, s53, 73728
 v_cvt_pk_bf16_f32 v230, v72, v73
 v_mfma_f32_16x16x32_bf16 v[156:159], v[80:83], a[92:95], v[156:159]
 s_waitcnt vmcnt(12)
 s_barrier
 s_waitcnt lgkmcnt(4)
 v_mfma_f32_16x16x32_bf16 v[160:163], v[84:87], a[80:83], v[160:163]
 ds_read_b64_tr_b16 v[80:81], v10 offset:49152
 v_mfma_f32_16x16x32_bf16 v[164:167], v[84:87], a[84:87], v[164:167]
 ds_read_b64_tr_b16 v[82:83], v10 offset:53248
 v_mfma_f32_16x16x32_bf16 v[168:171], v[84:87], a[88:91], v[168:171]
 s_add_u32 s54, s55, 148224
 v_cvt_pk_bf16_f32 v231, v74, v75
 v_mfma_f32_16x16x32_bf16 v[172:175], v[84:87], a[92:95], v[172:175]
 s_waitcnt lgkmcnt(4)
 v_mfma_f32_16x16x32_bf16 v[176:179], v[88:91], a[80:83], v[176:179]
 ds_read_b64_tr_b16 v[84:85], v11 offset:49152
 v_mfma_f32_16x16x32_bf16 v[180:183], v[88:91], a[84:87], v[180:183]
 ds_read_b64_tr_b16 v[86:87], v11 offset:53248
 v_mfma_f32_16x16x32_bf16 v[184:187], v[88:91], a[88:91], v[184:187]
 buffer_load_dwordx4 v6, s[24:27], s54 offen lds
 s_mov_b32 s94, 671744
 v_mfma_f32_16x16x32_bf16 v[188:191], v[88:91], a[92:95], v[188:191]
 s_waitcnt lgkmcnt(4)
 v_mfma_f32_16x16x32_bf16 v[192:195], v[92:95], a[80:83], v[192:195]
 ds_read_b64_tr_b16 v[88:89], v12 offset:49152
 v_mfma_f32_16x16x32_bf16 v[196:199], v[92:95], a[84:87], v[196:199]
 ds_read_b64_tr_b16 v[90:91], v12 offset:53248
 v_mfma_f32_16x16x32_bf16 v[200:203], v[92:95], a[88:91], v[200:203]
 buffer_load_dwordx4 v7, s[24:27], s54 offen offset:1024 lds
 buffer_store_dwordx4 v[228:231], v102, s[28:31], s94 offen sc1
 v_mfma_f32_16x16x32_bf16 v[204:207], v[92:95], a[92:95], v[204:207]
 s_waitcnt lgkmcnt(4)
 v_mfma_f32_16x16x32_bf16 v[144:147], v[80:83], a[96:99], v[144:147]
 ds_read_b64_tr_b16 v[92:93], v13 offset:49152
 v_mfma_f32_16x16x32_bf16 v[148:151], v[80:83], a[100:103], v[148:151]
 ds_read_b64_tr_b16 v[94:95], v13 offset:53248
 v_mfma_f32_16x16x32_bf16 v[152:155], v[80:83], a[104:107], v[152:155]
 s_add_u32 m0, s53, 24576
 v_cvt_pk_bf16_f32 v232, v28, v29
 v_mfma_f32_16x16x32_bf16 v[156:159], v[80:83], a[108:111], v[156:159]
 s_waitcnt lgkmcnt(4)
 v_mfma_f32_16x16x32_bf16 v[160:163], v[84:87], a[96:99], v[160:163]
 v_add_u32 v10, 0x10000, v10
 ds_read_b64_tr_b16 v[80:81], v10 offset:24576
 v_mfma_f32_16x16x32_bf16 v[164:167], v[84:87], a[100:103], v[164:167]
 ds_read_b64_tr_b16 v[82:83], v10 offset:28672
 v_mfma_f32_16x16x32_bf16 v[168:171], v[84:87], a[104:107], v[168:171]
 s_add_u32 s54, s55, 185088
 v_cvt_pk_bf16_f32 v233, v30, v31
 v_mfma_f32_16x16x32_bf16 v[172:175], v[84:87], a[108:111], v[172:175]
 s_waitcnt lgkmcnt(4)
 v_mfma_f32_16x16x32_bf16 v[176:179], v[88:91], a[96:99], v[176:179]
 v_add_u32 v11, 0x10000, v11
 ds_read_b64_tr_b16 v[84:85], v11 offset:24576
 v_mfma_f32_16x16x32_bf16 v[180:183], v[88:91], a[100:103], v[180:183]
 ds_read_b64_tr_b16 v[86:87], v11 offset:28672
 v_mfma_f32_16x16x32_bf16 v[184:187], v[88:91], a[104:107], v[184:187]
 buffer_load_dwordx4 v6, s[24:27], s54 offen lds
 v_cvt_pk_bf16_f32 v234, v44, v45
 v_mfma_f32_16x16x32_bf16 v[188:191], v[88:91], a[108:111], v[188:191]
 s_waitcnt lgkmcnt(4)
 v_mfma_f32_16x16x32_bf16 v[192:195], v[92:95], a[96:99], v[192:195]
 v_add_u32 v12, 0x10000, v12
 ds_read_b64_tr_b16 v[88:89], v12 offset:24576
 v_mfma_f32_16x16x32_bf16 v[196:199], v[92:95], a[100:103], v[196:199]
 ds_read_b64_tr_b16 v[90:91], v12 offset:28672
 v_mfma_f32_16x16x32_bf16 v[200:203], v[92:95], a[104:107], v[200:203]
 buffer_load_dwordx4 v7, s[24:27], s54 offen offset:1024 lds
 v_cvt_pk_bf16_f32 v235, v46, v47
 v_mfma_f32_16x16x32_bf16 v[204:207], v[92:95], a[108:111], v[204:207]
 s_waitcnt lgkmcnt(4)
 v_mfma_f32_16x16x32_bf16 v[144:147], v[80:83], a[112:115], v[144:147]
 v_add_u32 v13, 0x10000, v13
 ds_read_b64_tr_b16 v[92:93], v13 offset:24576
 v_mfma_f32_16x16x32_bf16 v[148:151], v[80:83], a[116:119], v[148:151]
 ds_read_b64_tr_b16 v[94:95], v13 offset:28672
 v_mfma_f32_16x16x32_bf16 v[152:155], v[80:83], a[120:123], v[152:155]
 s_add_u32 m0, s53, 57344
 s_mov_b32 s94, 950272
 v_mfma_f32_16x16x32_bf16 v[156:159], v[80:83], a[124:127], v[156:159]
 s_waitcnt lgkmcnt(4)
 v_mfma_f32_16x16x32_bf16 v[160:163], v[84:87], a[112:115], v[160:163]
 v_add_u32 v10, 0xffff0000, v10
 ds_read_b64_tr_b16 v[80:81], v10 offset:0
 v_mfma_f32_16x16x32_bf16 v[164:167], v[84:87], a[116:119], v[164:167]
 ds_read_b64_tr_b16 v[82:83], v10 offset:4096
 v_mfma_f32_16x16x32_bf16 v[168:171], v[84:87], a[120:123], v[168:171]
 s_add_u32 s54, s55, 221952
 buffer_store_dwordx4 v[232:235], v102, s[28:31], s94 offen sc1
 v_mfma_f32_16x16x32_bf16 v[172:175], v[84:87], a[124:127], v[172:175]
 s_waitcnt lgkmcnt(4)
 v_mfma_f32_16x16x32_bf16 v[176:179], v[88:91], a[112:115], v[176:179]
 v_add_u32 v11, 0xffff0000, v11
 ds_read_b64_tr_b16 v[84:85], v11 offset:0
 v_mfma_f32_16x16x32_bf16 v[180:183], v[88:91], a[116:119], v[180:183]
 ds_read_b64_tr_b16 v[86:87], v11 offset:4096
 v_mfma_f32_16x16x32_bf16 v[184:187], v[88:91], a[120:123], v[184:187]
 buffer_load_dwordx4 v6, s[24:27], s54 offen lds
 v_cvt_pk_bf16_f32 v236, v60, v61
 v_mfma_f32_16x16x32_bf16 v[188:191], v[88:91], a[124:127], v[188:191]
 s_waitcnt lgkmcnt(4)
 v_mfma_f32_16x16x32_bf16 v[192:195], v[92:95], a[112:115], v[192:195]
 v_add_u32 v12, 0xffff0000, v12
 ds_read_b64_tr_b16 v[88:89], v12 offset:0
 v_mfma_f32_16x16x32_bf16 v[196:199], v[92:95], a[116:119], v[196:199]
 ds_read_b64_tr_b16 v[90:91], v12 offset:4096
 v_mfma_f32_16x16x32_bf16 v[200:203], v[92:95], a[120:123], v[200:203]
 buffer_load_dwordx4 v7, s[24:27], s54 offen offset:1024 lds
 v_cvt_pk_bf16_f32 v237, v62, v63
 v_mfma_f32_16x16x32_bf16 v[204:207], v[92:95], a[124:127], v[204:207]
 s_waitcnt lgkmcnt(4)
 v_mfma_f32_16x16x32_bf16 v[144:147], v[80:83], a[128:131], v[144:147]
 v_add_u32 v13, 0xffff0000, v13
 ds_read_b64_tr_b16 v[92:93], v13 offset:0
 v_mfma_f32_16x16x32_bf16 v[148:151], v[80:83], a[132:135], v[148:151]
 ds_read_b64_tr_b16 v[94:95], v13 offset:4096
 v_mfma_f32_16x16x32_bf16 v[152:155], v[80:83], a[136:139], v[152:155]
 s_add_u32 m0, s53, 81920
 v_cvt_pk_bf16_f32 v238, v76, v77
 v_mfma_f32_16x16x32_bf16 v[156:159], v[80:83], a[140:143], v[156:159]
 s_waitcnt vmcnt(11)
 s_barrier
 s_waitcnt lgkmcnt(4)
 v_mfma_f32_16x16x32_bf16 v[160:163], v[84:87], a[128:131], v[160:163]
 ds_read_b64_tr_b16 v[80:81], v10 offset:8192
 v_mfma_f32_16x16x32_bf16 v[164:167], v[84:87], a[132:135], v[164:167]
 ds_read_b64_tr_b16 v[82:83], v10 offset:12288
 v_mfma_f32_16x16x32_bf16 v[168:171], v[84:87], a[136:139], v[168:171]
 s_add_u32 s54, s55, 258816
 v_cvt_pk_bf16_f32 v239, v78, v79
 v_mfma_f32_16x16x32_bf16 v[172:175], v[84:87], a[140:143], v[172:175]
 s_waitcnt lgkmcnt(4)
 v_mfma_f32_16x16x32_bf16 v[176:179], v[88:91], a[128:131], v[176:179]
 ds_read_b64_tr_b16 v[84:85], v11 offset:8192
 v_mfma_f32_16x16x32_bf16 v[180:183], v[88:91], a[132:135], v[180:183]
 ds_read_b64_tr_b16 v[86:87], v11 offset:12288
 v_mfma_f32_16x16x32_bf16 v[184:187], v[88:91], a[136:139], v[184:187]
 buffer_load_dwordx4 v6, s[24:27], s54 offen lds
 s_mov_b32 s94, 966656
 v_mfma_f32_16x16x32_bf16 v[188:191], v[88:91], a[140:143], v[188:191]
 s_waitcnt lgkmcnt(4)
 v_mfma_f32_16x16x32_bf16 v[192:195], v[92:95], a[128:131], v[192:195]
 ds_read_b64_tr_b16 v[88:89], v12 offset:8192
 v_mfma_f32_16x16x32_bf16 v[196:199], v[92:95], a[132:135], v[196:199]
 ds_read_b64_tr_b16 v[90:91], v12 offset:12288
 v_mfma_f32_16x16x32_bf16 v[200:203], v[92:95], a[136:139], v[200:203]
 buffer_load_dwordx4 v7, s[24:27], s54 offen offset:1024 lds
 buffer_store_dwordx4 v[236:239], v102, s[28:31], s94 offen sc1
 v_mfma_f32_16x16x32_bf16 v[204:207], v[92:95], a[140:143], v[204:207]
 s_waitcnt lgkmcnt(4)
 v_mfma_f32_16x16x32_bf16 v[16:19], v[80:83], a[0:3], 0
 ds_read_b64_tr_b16 v[92:93], v13 offset:8192
 v_mfma_f32_16x16x32_bf16 v[20:23], v[80:83], a[4:7], 0
 ds_read_b64_tr_b16 v[94:95], v13 offset:12288
 v_mfma_f32_16x16x32_bf16 v[24:27], v[80:83], a[8:11], 0
 s_add_u32 m0, s53, 32768
 v_cvt_pk_bf16_f32 v224, v144, v145
 v_mfma_f32_16x16x32_bf16 v[28:31], v[80:83], a[12:15], 0
 v_cvt_pk_bf16_f32 v225, v146, v147
 s_waitcnt lgkmcnt(4)
 v_mfma_f32_16x16x32_bf16 v[32:35], v[84:87], a[0:3], 0
 ds_read_b64_tr_b16 v[80:81], v10 offset:40960
 v_mfma_f32_16x16x32_bf16 v[36:39], v[84:87], a[4:7], 0
 ds_read_b64_tr_b16 v[82:83], v10 offset:45056
 v_mfma_f32_16x16x32_bf16 v[40:43], v[84:87], a[8:11], 0
 s_add_u32 s54, s56, 768
 v_cvt_pk_bf16_f32 v226, v160, v161
 v_mfma_f32_16x16x32_bf16 v[44:47], v[84:87], a[12:15], 0
 v_cvt_pk_bf16_f32 v227, v162, v163
 s_waitcnt lgkmcnt(4)
 v_mfma_f32_16x16x32_bf16 v[48:51], v[88:91], a[0:3], 0
 ds_read_b64_tr_b16 v[84:85], v11 offset:40960
 v_mfma_f32_16x16x32_bf16 v[52:55], v[88:91], a[4:7], 0
 ds_read_b64_tr_b16 v[86:87], v11 offset:45056
 v_mfma_f32_16x16x32_bf16 v[56:59], v[88:91], a[8:11], 0
 buffer_load_dwordx4 v6, s[24:27], s54 offen lds
 s_mov_b32 s94, 131072
 v_mfma_f32_16x16x32_bf16 v[60:63], v[88:91], a[12:15], 0
 buffer_store_dwordx4 v[224:227], v102, s[28:31], s94 offen sc1
 s_waitcnt lgkmcnt(4)
 v_mfma_f32_16x16x32_bf16 v[64:67], v[92:95], a[0:3], 0
 ds_read_b64_tr_b16 v[88:89], v12 offset:40960
 v_mfma_f32_16x16x32_bf16 v[68:71], v[92:95], a[4:7], 0
 ds_read_b64_tr_b16 v[90:91], v12 offset:45056
 v_mfma_f32_16x16x32_bf16 v[72:75], v[92:95], a[8:11], 0
 buffer_load_dwordx4 v7, s[24:27], s54 offen offset:1024 lds
 v_cvt_pk_bf16_f32 v228, v176, v177
 v_mfma_f32_16x16x32_bf16 v[76:79], v[92:95], a[12:15], 0
 v_cvt_pk_bf16_f32 v229, v178, v179
 s_waitcnt lgkmcnt(4)
 v_mfma_f32_16x16x32_bf16 v[16:19], v[80:83], a[16:19], v[16:19]
 ds_read_b64_tr_b16 v[92:93], v13 offset:40960
 v_mfma_f32_16x16x32_bf16 v[20:23], v[80:83], a[20:23], v[20:23]
 ds_read_b64_tr_b16 v[94:95], v13 offset:45056
 v_mfma_f32_16x16x32_bf16 v[24:27], v[80:83], a[24:27], v[24:27]
 s_add_u32 m0, s53, 49152
 v_cvt_pk_bf16_f32 v230, v192, v193
 v_mfma_f32_16x16x32_bf16 v[28:31], v[80:83], a[28:31], v[28:31]
 v_cvt_pk_bf16_f32 v231, v194, v195
 s_waitcnt lgkmcnt(4)
 v_mfma_f32_16x16x32_bf16 v[32:35], v[84:87], a[16:19], v[32:35]
 ds_read_b64_tr_b16 v[80:81], v10 offset:16384
 v_mfma_f32_16x16x32_bf16 v[36:39], v[84:87], a[20:23], v[36:39]
 ds_read_b64_tr_b16 v[82:83], v10 offset:20480
 v_mfma_f32_16x16x32_bf16 v[40:43], v[84:87], a[24:27], v[40:43]
 s_add_u32 s54, s55, 0
 s_mov_b32 s94, 147456
 v_mfma_f32_16x16x32_bf16 v[44:47], v[84:87], a[28:31], v[44:47]
 buffer_store_dwordx4 v[228:231], v102, s[28:31], s94 offen sc1
 s_waitcnt lgkmcnt(4)
 v_mfma_f32_16x16x32_bf16 v[48:51], v[88:91], a[16:19], v[48:51]
 ds_read_b64_tr_b16 v[84:85], v11 offset:16384
 v_mfma_f32_16x16x32_bf16 v[52:55], v[88:91], a[20:23], v[52:55]
 ds_read_b64_tr_b16 v[86:87], v11 offset:20480
 v_mfma_f32_16x16x32_bf16 v[56:59], v[88:91], a[24:27], v[56:59]
 buffer_load_dwordx4 v8, s[24:27], s54 offen lds
 v_cvt_pk_bf16_f32 v232, v148, v149
 v_mfma_f32_16x16x32_bf16 v[60:63], v[88:91], a[28:31], v[60:63]
 v_cvt_pk_bf16_f32 v233, v150, v151
 s_waitcnt lgkmcnt(4)
 v_mfma_f32_16x16x32_bf16 v[64:67], v[92:95], a[16:19], v[64:67]
 ds_read_b64_tr_b16 v[88:89], v12 offset:16384
 v_mfma_f32_16x16x32_bf16 v[68:71], v[92:95], a[20:23], v[68:71]
 ds_read_b64_tr_b16 v[90:91], v12 offset:20480
 v_mfma_f32_16x16x32_bf16 v[72:75], v[92:95], a[24:27], v[72:75]
 buffer_load_dwordx4 v9, s[24:27], s54 offen offset:1024 lds
 v_cvt_pk_bf16_f32 v234, v164, v165
 v_mfma_f32_16x16x32_bf16 v[76:79], v[92:95], a[28:31], v[76:79]
 v_cvt_pk_bf16_f32 v235, v166, v167
 s_waitcnt lgkmcnt(4)
 v_mfma_f32_16x16x32_bf16 v[16:19], v[80:83], a[32:35], v[16:19]
 ds_read_b64_tr_b16 v[92:93], v13 offset:16384
 v_mfma_f32_16x16x32_bf16 v[20:23], v[80:83], a[36:39], v[20:23]
 ds_read_b64_tr_b16 v[94:95], v13 offset:20480
 v_mfma_f32_16x16x32_bf16 v[24:27], v[80:83], a[40:43], v[24:27]
 s_add_u32 m0, s53, 90112
 s_mov_b32 s94, 425984
 v_mfma_f32_16x16x32_bf16 v[28:31], v[80:83], a[44:47], v[28:31]
 buffer_store_dwordx4 v[232:235], v102, s[28:31], s94 offen sc1
 s_waitcnt vmcnt(13)
 s_barrier
 s_waitcnt lgkmcnt(4)
 v_mfma_f32_16x16x32_bf16 v[32:35], v[84:87], a[32:35], v[32:35]
 v_add_u32 v10, 0x10000, v10
 ds_read_b64_tr_b16 v[80:81], v10 offset:0
 v_mfma_f32_16x16x32_bf16 v[36:39], v[84:87], a[36:39], v[36:39]
 ds_read_b64_tr_b16 v[82:83], v10 offset:4096
 v_mfma_f32_16x16x32_bf16 v[40:43], v[84:87], a[40:43], v[40:43]
 s_add_u32 s54, s55, 73728
 v_cvt_pk_bf16_f32 v236, v180, v181
 v_mfma_f32_16x16x32_bf16 v[44:47], v[84:87], a[44:47], v[44:47]
 v_cvt_pk_bf16_f32 v237, v182, v183
 s_waitcnt lgkmcnt(4)
 v_mfma_f32_16x16x32_bf16 v[48:51], v[88:91], a[32:35], v[48:51]
 v_add_u32 v11, 0x10000, v11
 ds_read_b64_tr_b16 v[84:85], v11 offset:0
 v_mfma_f32_16x16x32_bf16 v[52:55], v[88:91], a[36:39], v[52:55]
 ds_read_b64_tr_b16 v[86:87], v11 offset:4096
 v_mfma_f32_16x16x32_bf16 v[56:59], v[88:91], a[40:43], v[56:59]
 buffer_load_dwordx4 v8, s[24:27], s54 offen lds
 v_cvt_pk_bf16_f32 v238, v196, v197
 v_mfma_f32_16x16x32_bf16 v[60:63], v[88:91], a[44:47], v[60:63]
 v_cvt_pk_bf16_f32 v239, v198, v199
 s_waitcnt lgkmcnt(4)
 v_mfma_f32_16x16x32_bf16 v[64:67], v[92:95], a[32:35], v[64:67]
 v_add_u32 v12, 0x10000, v12
 ds_read_b64_tr_b16 v[88:89], v12 offset:0
 v_mfma_f32_16x16x32_bf16 v[68:71], v[92:95], a[36:39], v[68:71]
 ds_read_b64_tr_b16 v[90:91], v12 offset:4096
 v_mfma_f32_16x16x32_bf16 v[72:75], v[92:95], a[40:43], v[72:75]
 buffer_load_dwordx4 v9, s[24:27], s54 offen offset:1024 lds
 s_mov_b32 s94, 442368
 v_mfma_f32_16x16x32_bf16 v[76:79], v[92:95], a[44:47], v[76:79]
 buffer_store_dwordx4 v[236:239], v102, s[28:31], s94 offen sc1
 s_waitcnt lgkmcnt(4)
 v_mfma_f32_16x16x32_bf16 v[16:19], v[80:83], a[48:51], v[16:19]
 v_add_u32 v13, 0x10000, v13
 ds_read_b64_tr_b16 v[92:93], v13 offset:0
 v_mfma_f32_16x16x32_bf16 v[20:23], v[80:83], a[52:55], v[20:23]
 ds_read_b64_tr_b16 v[94:95], v13 offset:4096
 v_mfma_f32_16x16x32_bf16 v[24:27], v[80:83], a[56:59], v[24:27]
 s_add_u32 m0, s53, 0
 v_cvt_pk_bf16_f32 v224, v152, v153
 v_mfma_f32_16x16x32_bf16 v[28:31], v[80:83], a[60:63], v[28:31]
 s_waitcnt lgkmcnt(4)
 v_mfma_f32_16x16x32_bf16 v[32:35], v[84:87], a[48:51], v[32:35]
 ds_read_b64_tr_b16 v[80:81], v10 offset:8192
 v_mfma_f32_16x16x32_bf16 v[36:39], v[84:87], a[52:55], v[36:39]
 ds_read_b64_tr_b16 v[82:83], v10 offset:12288
 v_mfma_f32_16x16x32_bf16 v[40:43], v[84:87], a[56:59], v[40:43]
 s_add_u32 s54, s55, 147456
 v_cvt_pk_bf16_f32 v225, v154, v155
 v_mfma_f32_16x16x32_bf16 v[44:47], v[84:87], a[60:63], v[44:47]
 s_waitcnt lgkmcnt(4)
 v_mfma_f32_16x16x32_bf16 v[48:51], v[88:91], a[48:51], v[48:51]
 ds_read_b64_tr_b16 v[84:85], v11 offset:8192
 v_mfma_f32_16x16x32_bf16 v[52:55], v[88:91], a[52:55], v[52:55]
 ds_read_b64_tr_b16 v[86:87], v11 offset:12288
 v_mfma_f32_16x16x32_bf16 v[56:59], v[88:91], a[56:59], v[56:59]
 buffer_load_dwordx4 v8, s[24:27], s54 offen lds
 v_cvt_pk_bf16_f32 v226, v168, v169
 v_mfma_f32_16x16x32_bf16 v[60:63], v[88:91], a[60:63], v[60:63]
 s_waitcnt lgkmcnt(4)
 v_mfma_f32_16x16x32_bf16 v[64:67], v[92:95], a[48:51], v[64:67]
 ds_read_b64_tr_b16 v[88:89], v12 offset:8192
 v_mfma_f32_16x16x32_bf16 v[68:71], v[92:95], a[52:55], v[68:71]
 ds_read_b64_tr_b16 v[90:91], v12 offset:12288
 v_mfma_f32_16x16x32_bf16 v[72:75], v[92:95], a[56:59], v[72:75]
 buffer_load_dwordx4 v9, s[24:27], s54 offen offset:1024 lds
 v_cvt_pk_bf16_f32 v227, v170, v171
 v_mfma_f32_16x16x32_bf16 v[76:79], v[92:95], a[60:63], v[76:79]
 s_waitcnt lgkmcnt(4)
 v_mfma_f32_16x16x32_bf16 v[16:19], v[80:83], a[64:67], v[16:19]
 ds_read_b64_tr_b16 v[92:93], v13 offset:8192
 v_mfma_f32_16x16x32_bf16 v[20:23], v[80:83], a[68:71], v[20:23]
 ds_read_b64_tr_b16 v[94:95], v13 offset:12288
 v_mfma_f32_16x16x32_bf16 v[24:27], v[80:83], a[72:75], v[24:27]
 s_add_u32 m0, s53, 8192
 s_mov_b32 s94, 720896
 v_mfma_f32_16x16x32_bf16 v[28:31], v[80:83], a[76:79], v[28:31]
 s_waitcnt lgkmcnt(4)
 v_mfma_f32_16x16x32_bf16 v[32:35], v[84:87], a[64:67], v[32:35]
 v_add_u32 v10, 0xffff0000, v10
 ds_read_b64_tr_b16 v[80:81], v10 offset:24576
 v_mfma_f32_16x16x32_bf16 v[36:39], v[84:87], a[68:71], v[36:39]
 ds_read_b64_tr_b16 v[82:83], v10 offset:28672
 v_mfma_f32_16x16x32_bf16 v[40:43], v[84:87], a[72:75], v[40:43]
 s_add_u32 s54, s55, 221184
 buffer_store_dwordx4 v[224:227], v102, s[28:31], s94 offen sc1
 v_mfma_f32_16x16x32_bf16 v[44:47], v[84:87], a[76:79], v[44:47]
 s_waitcnt lgkmcnt(4)
 v_mfma_f32_16x16x32_bf16 v[48:51], v[88:91], a[64:67], v[48:51]
 v_add_u32 v11, 0xffff0000, v11
 ds_read_b64_tr_b16 v[84:85], v11 offset:24576
 v_mfma_f32_16x16x32_bf16 v[52:55], v[88:91], a[68:71], v[52:55]
 ds_read_b64_tr_b16 v[86:87], v11 offset:28672
 v_mfma_f32_16x16x32_bf16 v[56:59], v[88:91], a[72:75], v[56:59]
 buffer_load_dwordx4 v8, s[24:27], s54 offen lds
 v_cvt_pk_bf16_f32 v228, v184, v185
 v_mfma_f32_16x16x32_bf16 v[60:63], v[88:91], a[76:79], v[60:63]
 s_waitcnt lgkmcnt(4)
 v_mfma_f32_16x16x32_bf16 v[64:67], v[92:95], a[64:67], v[64:67]
 v_add_u32 v12, 0xffff0000, v12
 ds_read_b64_tr_b16 v[88:89], v12 offset:24576
 v_mfma_f32_16x16x32_bf16 v[68:71], v[92:95], a[68:71], v[68:71]
 ds_read_b64_tr_b16 v[90:91], v12 offset:28672
 v_mfma_f32_16x16x32_bf16 v[72:75], v[92:95], a[72:75], v[72:75]
 buffer_load_dwordx4 v9, s[24:27], s54 offen offset:1024 lds
 v_cvt_pk_bf16_f32 v229, v186, v187
 v_mfma_f32_16x16x32_bf16 v[76:79], v[92:95], a[76:79], v[76:79]
 s_waitcnt lgkmcnt(4)
 v_mfma_f32_16x16x32_bf16 v[16:19], v[80:83], a[80:83], v[16:19]
 v_add_u32 v13, 0xffff0000, v13
 ds_read_b64_tr_b16 v[92:93], v13 offset:24576
 v_mfma_f32_16x16x32_bf16 v[20:23], v[80:83], a[84:87], v[20:23]
 ds_read_b64_tr_b16 v[94:95], v13 offset:28672
 v_mfma_f32_16x16x32_bf16 v[24:27], v[80:83], a[88:91], v[24:27]
 s_add_u32 m0, s53, 40960
 v_cvt_pk_bf16_f32 v230, v200, v201
 v_mfma_f32_16x16x32_bf16 v[28:31], v[80:83], a[92:95], v[28:31]
 s_waitcnt vmcnt(12)
 s_barrier
 s_waitcnt lgkmcnt(4)
 v_mfma_f32_16x16x32_bf16 v[32:35], v[84:87], a[80:83], v[32:35]
 ds_read_b64_tr_b16 v[80:81], v10 offset:57344
 v_mfma_f32_16x16x32_bf16 v[36:39], v[84:87], a[84:87], v[36:39]
 ds_read_b64_tr_b16 v[82:83], v10 offset:61440
 v_mfma_f32_16x16x32_bf16 v[40:43], v[84:87], a[88:91], v[40:43]
 s_add_u32 s54, s56, 0
 v_cvt_pk_bf16_f32 v231, v202, v203
 v_mfma_f32_16x16x32_bf16 v[44:47], v[84:87], a[92:95], v[44:47]
 s_waitcnt lgkmcnt(4)
 v_mfma_f32_16x16x32_bf16 v[48:51], v[88:91], a[80:83], v[48:51]
 ds_read_b64_tr_b16 v[84:85], v11 offset:57344
 v_mfma_f32_16x16x32_bf16 v[52:55], v[88:91], a[84:87], v[52:55]
 ds_read_b64_tr_b16 v[86:87], v11 offset:61440
 v_mfma_f32_16x16x32_bf16 v[56:59], v[88:91], a[88:91], v[56:59]
 buffer_load_dwordx4 v8, s[24:27], s54 offen lds
 s_mov_b32 s94, 737280
 v_mfma_f32_16x16x32_bf16 v[60:63], v[88:91], a[92:95], v[60:63]
 s_waitcnt lgkmcnt(4)
 v_mfma_f32_16x16x32_bf16 v[64:67], v[92:95], a[80:83], v[64:67]
 ds_read_b64_tr_b16 v[88:89], v12 offset:57344
 v_mfma_f32_16x16x32_bf16 v[68:71], v[92:95], a[84:87], v[68:71]
 ds_read_b64_tr_b16 v[90:91], v12 offset:61440
 v_mfma_f32_16x16x32_bf16 v[72:75], v[92:95], a[88:91], v[72:75]
 buffer_load_dwordx4 v9, s[24:27], s54 offen offset:1024 lds
 buffer_store_dwordx4 v[228:231], v102, s[28:31], s94 offen sc1
 v_mfma_f32_16x16x32_bf16 v[76:79], v[92:95], a[92:95], v[76:79]
 s_waitcnt lgkmcnt(4)
 v_mfma_f32_16x16x32_bf16 v[16:19], v[80:83], a[96:99], v[16:19]
 ds_read_b64_tr_b16 v[92:93], v13 offset:57344
 v_mfma_f32_16x16x32_bf16 v[20:23], v[80:83], a[100:103], v[20:23]
 ds_read_b64_tr_b16 v[94:95], v13 offset:61440
 v_mfma_f32_16x16x32_bf16 v[24:27], v[80:83], a[104:107], v[24:27]
 v_cvt_pk_bf16_f32 v232, v156, v157
 v_mfma_f32_16x16x32_bf16 v[28:31], v[80:83], a[108:111], v[28:31]
 s_waitcnt lgkmcnt(4)
 v_mfma_f32_16x16x32_bf16 v[32:35], v[84:87], a[96:99], v[32:35]
 v_add_u32 v10, 0x10000, v10
 ds_read_b64_tr_b16 v[80:81], v10 offset:16384
 v_mfma_f32_16x16x32_bf16 v[36:39], v[84:87], a[100:103], v[36:39]
 ds_read_b64_tr_b16 v[82:83], v10 offset:20480
 v_mfma_f32_16x16x32_bf16 v[40:43], v[84:87], a[104:107], v[40:43]
 v_cvt_pk_bf16_f32 v233, v158, v159
 v_mfma_f32_16x16x32_bf16 v[44:47], v[84:87], a[108:111], v[44:47]
 s_waitcnt lgkmcnt(4)
 v_mfma_f32_16x16x32_bf16 v[48:51], v[88:91], a[96:99], v[48:51]
 v_add_u32 v11, 0x10000, v11
 ds_read_b64_tr_b16 v[84:85], v11 offset:16384
 v_mfma_f32_16x16x32_bf16 v[52:55], v[88:91], a[100:103], v[52:55]
 ds_read_b64_tr_b16 v[86:87], v11 offset:20480
 v_mfma_f32_16x16x32_bf16 v[56:59], v[88:91], a[104:107], v[56:59]
 v_cvt_pk_bf16_f32 v234, v172, v173
 v_mfma_f32_16x16x32_bf16 v[60:63], v[88:91], a[108:111], v[60:63]
 s_waitcnt lgkmcnt(4)
 v_mfma_f32_16x16x32_bf16 v[64:67], v[92:95], a[96:99], v[64:67]
 v_add_u32 v12, 0x10000, v12
 ds_read_b64_tr_b16 v[88:89], v12 offset:16384
 v_mfma_f32_16x16x32_bf16 v[68:71], v[92:95], a[100:103], v[68:71]
 ds_read_b64_tr_b16 v[90:91], v12 offset:20480
 v_mfma_f32_16x16x32_bf16 v[72:75], v[92:95], a[104:107], v[72:75]
 v_cvt_pk_bf16_f32 v235, v174, v175
 v_mfma_f32_16x16x32_bf16 v[76:79], v[92:95], a[108:111], v[76:79]
 s_waitcnt lgkmcnt(4)
 v_mfma_f32_16x16x32_bf16 v[16:19], v[80:83], a[112:115], v[16:19]
 v_add_u32 v13, 0x10000, v13
 ds_read_b64_tr_b16 v[92:93], v13 offset:16384
 v_mfma_f32_16x16x32_bf16 v[20:23], v[80:83], a[116:119], v[20:23]
 ds_read_b64_tr_b16 v[94:95], v13 offset:20480
 v_mfma_f32_16x16x32_bf16 v[24:27], v[80:83], a[120:123], v[24:27]
 s_mov_b32 s94, 1015808
 v_mfma_f32_16x16x32_bf16 v[28:31], v[80:83], a[124:127], v[28:31]
 s_waitcnt lgkmcnt(4)
 v_mfma_f32_16x16x32_bf16 v[32:35], v[84:87], a[112:115], v[32:35]
 v_add_u32 v10, 0xffff0000, v10
 ds_read_b64_tr_b16 v[80:81], v10 offset:32768
 v_mfma_f32_16x16x32_bf16 v[36:39], v[84:87], a[116:119], v[36:39]
 ds_read_b64_tr_b16 v[82:83], v10 offset:36864
 v_mfma_f32_16x16x32_bf16 v[40:43], v[84:87], a[120:123], v[40:43]
 buffer_store_dwordx4 v[232:235], v102, s[28:31], s94 offen sc1
 v_mfma_f32_16x16x32_bf16 v[44:47], v[84:87], a[124:127], v[44:47]
 s_waitcnt lgkmcnt(4)
 v_mfma_f32_16x16x32_bf16 v[48:51], v[88:91], a[112:115], v[48:51]
 v_add_u32 v11, 0xffff0000, v11
 ds_read_b64_tr_b16 v[84:85], v11 offset:32768
 v_mfma_f32_16x16x32_bf16 v[52:55], v[88:91], a[116:119], v[52:55]
 ds_read_b64_tr_b16 v[86:87], v11 offset:36864
 v_mfma_f32_16x16x32_bf16 v[56:59], v[88:91], a[120:123], v[56:59]
 v_cvt_pk_bf16_f32 v236, v188, v189
 v_mfma_f32_16x16x32_bf16 v[60:63], v[88:91], a[124:127], v[60:63]
 s_waitcnt lgkmcnt(4)
 v_mfma_f32_16x16x32_bf16 v[64:67], v[92:95], a[112:115], v[64:67]
 v_add_u32 v12, 0xffff0000, v12
 ds_read_b64_tr_b16 v[88:89], v12 offset:32768
 v_mfma_f32_16x16x32_bf16 v[68:71], v[92:95], a[116:119], v[68:71]
 ds_read_b64_tr_b16 v[90:91], v12 offset:36864
 v_mfma_f32_16x16x32_bf16 v[72:75], v[92:95], a[120:123], v[72:75]
 v_cvt_pk_bf16_f32 v237, v190, v191
 v_mfma_f32_16x16x32_bf16 v[76:79], v[92:95], a[124:127], v[76:79]
 s_waitcnt lgkmcnt(4)
 v_mfma_f32_16x16x32_bf16 v[16:19], v[80:83], a[128:131], v[16:19]
 v_add_u32 v13, 0xffff0000, v13
 ds_read_b64_tr_b16 v[92:93], v13 offset:32768
 v_mfma_f32_16x16x32_bf16 v[20:23], v[80:83], a[132:135], v[20:23]
 ds_read_b64_tr_b16 v[94:95], v13 offset:36864
 v_mfma_f32_16x16x32_bf16 v[24:27], v[80:83], a[136:139], v[24:27]
 v_cvt_pk_bf16_f32 v238, v204, v205
 v_mfma_f32_16x16x32_bf16 v[28:31], v[80:83], a[140:143], v[28:31]
 s_waitcnt vmcnt(7)
 s_barrier
 s_waitcnt lgkmcnt(4)
 v_mfma_f32_16x16x32_bf16 v[32:35], v[84:87], a[128:131], v[32:35]
 ds_read_b64_tr_b16 v[80:81], v14 offset:49152
 v_mfma_f32_16x16x32_bf16 v[36:39], v[84:87], a[132:135], v[36:39]
 ds_read_b64_tr_b16 v[82:83], v14 offset:51200
 v_mfma_f32_16x16x32_bf16 v[40:43], v[84:87], a[136:139], v[40:43]
 v_cvt_pk_bf16_f32 v239, v206, v207
 v_mfma_f32_16x16x32_bf16 v[44:47], v[84:87], a[140:143], v[44:47]
 s_waitcnt lgkmcnt(4)
 v_mfma_f32_16x16x32_bf16 v[48:51], v[88:91], a[128:131], v[48:51]
 ds_read_b64_tr_b16 v[84:85], v15 offset:49152
 v_mfma_f32_16x16x32_bf16 v[52:55], v[88:91], a[132:135], v[52:55]
 ds_read_b64_tr_b16 v[86:87], v15 offset:51200
 v_mfma_f32_16x16x32_bf16 v[56:59], v[88:91], a[136:139], v[56:59]
 s_mov_b32 s94, 1032192
 v_mfma_f32_16x16x32_bf16 v[60:63], v[88:91], a[140:143], v[60:63]
 s_waitcnt lgkmcnt(4)
 v_mfma_f32_16x16x32_bf16 v[64:67], v[92:95], a[128:131], v[64:67]
 ds_read_b64_tr_b16 v[88:89], v14 offset:53248
 v_mfma_f32_16x16x32_bf16 v[68:71], v[92:95], a[132:135], v[68:71]
 ds_read_b64_tr_b16 v[90:91], v14 offset:55296
 v_mfma_f32_16x16x32_bf16 v[72:75], v[92:95], a[136:139], v[72:75]
 buffer_store_dwordx4 v[236:239], v102, s[28:31], s94 offen sc1
 v_mfma_f32_16x16x32_bf16 v[76:79], v[92:95], a[140:143], v[76:79]
 s_waitcnt lgkmcnt(4)
 v_mfma_f32_16x16x32_bf16 v[144:147], v[80:83], a[0:3], 0
 ds_read_b64_tr_b16 v[92:93], v15 offset:53248
 v_mfma_f32_16x16x32_bf16 v[148:151], v[80:83], a[4:7], 0
 ds_read_b64_tr_b16 v[94:95], v15 offset:55296
 v_mfma_f32_16x16x32_bf16 v[152:155], v[80:83], a[8:11], 0
 v_cvt_pk_bf16_f32 v224, v16, v17
 v_cvt_pk_bf16_f32 v225, v18, v19
 v_mfma_f32_16x16x32_bf16 v[156:159], v[80:83], a[12:15], 0
 v_cvt_pk_bf16_f32 v226, v32, v33
 s_waitcnt lgkmcnt(4)
 v_mfma_f32_16x16x32_bf16 v[160:163], v[84:87], a[0:3], 0
 v_add_u32 v14, 0x10000, v14
 ds_read_b64_tr_b16 v[80:81], v14 offset:24576
 v_mfma_f32_16x16x32_bf16 v[164:167], v[84:87], a[4:7], 0
 ds_read_b64_tr_b16 v[82:83], v14 offset:26624
 v_mfma_f32_16x16x32_bf16 v[168:171], v[84:87], a[8:11], 0
 v_cvt_pk_bf16_f32 v227, v34, v35
 s_mov_b32 s94, 196608
 v_mfma_f32_16x16x32_bf16 v[172:175], v[84:87], a[12:15], 0
 buffer_store_dwordx4 v[224:227], v102, s[28:31], s94 offen sc1
 s_waitcnt lgkmcnt(4)
 v_mfma_f32_16x16x32_bf16 v[144:147], v[88:91], a[16:19], v[144:147]
 v_add_u32 v15, 0x10000, v15
 ds_read_b64_tr_b16 v[84:85], v15 offset:24576
 v_mfma_f32_16x16x32_bf16 v[148:151], v[88:91], a[20:23], v[148:151]
 ds_read_b64_tr_b16 v[86:87], v15 offset:26624
 v_mfma_f32_16x16x32_bf16 v[152:155], v[88:91], a[24:27], v[152:155]
 v_cvt_pk_bf16_f32 v228, v48, v49
 v_cvt_pk_bf16_f32 v229, v50, v51
 v_mfma_f32_16x16x32_bf16 v[156:159], v[88:91], a[28:31], v[156:159]
 v_cvt_pk_bf16_f32 v230, v64, v65
 s_waitcnt lgkmcnt(4)
 v_mfma_f32_16x16x32_bf16 v[160:163], v[92:95], a[16:19], v[160:163]
 ds_read_b64_tr_b16 v[88:89], v14 offset:28672
 v_mfma_f32_16x16x32_bf16 v[164:167], v[92:95], a[20:23], v[164:167]
 ds_read_b64_tr_b16 v[90:91], v14 offset:30720
 v_mfma_f32_16x16x32_bf16 v[168:171], v[92:95], a[24:27], v[168:171]
 v_cvt_pk_bf16_f32 v231, v66, v67
 s_mov_b32 s94, 212992
 v_mfma_f32_16x16x32_bf16 v[172:175], v[92:95], a[28:31], v[172:175]
 buffer_store_dwordx4 v[228:231], v102, s[28:31], s94 offen sc1
 s_waitcnt lgkmcnt(4)
 v_mfma_f32_16x16x32_bf16 v[144:147], v[80:83], a[32:35], v[144:147]
 ds_read_b64_tr_b16 v[92:93], v15 offset:28672
 v_mfma_f32_16x16x32_bf16 v[148:151], v[80:83], a[36:39], v[148:151]
 ds_read_b64_tr_b16 v[94:95], v15 offset:30720
 v_mfma_f32_16x16x32_bf16 v[152:155], v[80:83], a[40:43], v[152:155]
 v_cvt_pk_bf16_f32 v232, v20, v21
 v_cvt_pk_bf16_f32 v233, v22, v23
 v_mfma_f32_16x16x32_bf16 v[156:159], v[80:83], a[44:47], v[156:159]
 v_cvt_pk_bf16_f32 v234, v36, v37
 s_waitcnt lgkmcnt(4)
 v_mfma_f32_16x16x32_bf16 v[160:163], v[84:87], a[32:35], v[160:163]
 v_add_u32 v14, 0xffff0000, v14
 ds_read_b64_tr_b16 v[80:81], v14 offset:0
 v_mfma_f32_16x16x32_bf16 v[164:167], v[84:87], a[36:39], v[164:167]
 ds_read_b64_tr_b16 v[82:83], v14 offset:2048
 v_mfma_f32_16x16x32_bf16 v[168:171], v[84:87], a[40:43], v[168:171]
 v_cvt_pk_bf16_f32 v235, v38, v39
 s_mov_b32 s94, 491520
 v_mfma_f32_16x16x32_bf16 v[172:175], v[84:87], a[44:47], v[172:175]
 buffer_store_dwordx4 v[232:235], v102, s[28:31], s94 offen sc1
 s_waitcnt lgkmcnt(4)
 v_mfma_f32_16x16x32_bf16 v[144:147], v[88:91], a[48:51], v[144:147]
 v_add_u32 v15, 0xffff0000, v15
 ds_read_b64_tr_b16 v[84:85], v15 offset:0
 v_mfma_f32_16x16x32_bf16 v[148:151], v[88:91], a[52:55], v[148:151]
 ds_read_b64_tr_b16 v[86:87], v15 offset:2048
 v_mfma_f32_16x16x32_bf16 v[152:155], v[88:91], a[56:59], v[152:155]
 v_cvt_pk_bf16_f32 v236, v52, v53
 v_cvt_pk_bf16_f32 v237, v54, v55
 v_mfma_f32_16x16x32_bf16 v[156:159], v[88:91], a[60:63], v[156:159]
 v_cvt_pk_bf16_f32 v238, v68, v69
 s_waitcnt lgkmcnt(4)
 v_mfma_f32_16x16x32_bf16 v[160:163], v[92:95], a[48:51], v[160:163]
 ds_read_b64_tr_b16 v[88:89], v14 offset:4096
 v_mfma_f32_16x16x32_bf16 v[164:167], v[92:95], a[52:55], v[164:167]
 ds_read_b64_tr_b16 v[90:91], v14 offset:6144
 v_mfma_f32_16x16x32_bf16 v[168:171], v[92:95], a[56:59], v[168:171]
 v_cvt_pk_bf16_f32 v239, v70, v71
 s_mov_b32 s94, 507904
 v_mfma_f32_16x16x32_bf16 v[172:175], v[92:95], a[60:63], v[172:175]
 buffer_store_dwordx4 v[236:239], v102, s[28:31], s94 offen sc1
 s_waitcnt lgkmcnt(4)
 v_mfma_f32_16x16x32_bf16 v[144:147], v[80:83], a[64:67], v[144:147]
 ds_read_b64_tr_b16 v[92:93], v15 offset:4096
 v_mfma_f32_16x16x32_bf16 v[148:151], v[80:83], a[68:71], v[148:151]
 ds_read_b64_tr_b16 v[94:95], v15 offset:6144
 v_mfma_f32_16x16x32_bf16 v[152:155], v[80:83], a[72:75], v[152:155]
 v_cvt_pk_bf16_f32 v224, v24, v25
 v_cvt_pk_bf16_f32 v225, v26, v27
 v_mfma_f32_16x16x32_bf16 v[156:159], v[80:83], a[76:79], v[156:159]
 v_cvt_pk_bf16_f32 v226, v40, v41
 s_waitcnt vmcnt(7)
 s_barrier
 s_waitcnt lgkmcnt(4)
 v_mfma_f32_16x16x32_bf16 v[160:163], v[84:87], a[64:67], v[160:163]
 ds_read_b64_tr_b16 v[80:81], v14 offset:8192
 v_mfma_f32_16x16x32_bf16 v[164:167], v[84:87], a[68:71], v[164:167]
 ds_read_b64_tr_b16 v[82:83], v14 offset:10240
 v_mfma_f32_16x16x32_bf16 v[168:171], v[84:87], a[72:75], v[168:171]
 v_cvt_pk_bf16_f32 v227, v42, v43
 s_mov_b32 s94, 786432
 v_mfma_f32_16x16x32_bf16 v[172:175], v[84:87], a[76:79], v[172:175]
 buffer_store_dwordx4 v[224:227], v102, s[28:31], s94 offen sc1
 s_waitcnt lgkmcnt(4)
 v_mfma_f32_16x16x32_bf16 v[144:147], v[88:91], a[80:83], v[144:147]
 ds_read_b64_tr_b16 v[84:85], v15 offset:8192
 v_mfma_f32_16x16x32_bf16 v[148:151], v[88:91], a[84:87], v[148:151]
 ds_read_b64_tr_b16 v[86:87], v15 offset:10240
 v_mfma_f32_16x16x32_bf16 v[152:155], v[88:91], a[88:91], v[152:155]
 v_cvt_pk_bf16_f32 v228, v56, v57
 v_cvt_pk_bf16_f32 v229, v58, v59
 v_mfma_f32_16x16x32_bf16 v[156:159], v[88:91], a[92:95], v[156:159]
 v_cvt_pk_bf16_f32 v230, v72, v73
 s_waitcnt lgkmcnt(4)
 v_mfma_f32_16x16x32_bf16 v[160:163], v[92:95], a[80:83], v[160:163]
 ds_read_b64_tr_b16 v[88:89], v14 offset:12288
 v_mfma_f32_16x16x32_bf16 v[164:167], v[92:95], a[84:87], v[164:167]
 ds_read_b64_tr_b16 v[90:91], v14 offset:14336
 v_mfma_f32_16x16x32_bf16 v[168:171], v[92:95], a[88:91], v[168:171]
 v_cvt_pk_bf16_f32 v231, v74, v75
 s_mov_b32 s94, 802816
 v_mfma_f32_16x16x32_bf16 v[172:175], v[92:95], a[92:95], v[172:175]
 buffer_store_dwordx4 v[228:231], v102, s[28:31], s94 offen sc1
 s_waitcnt lgkmcnt(4)
 v_mfma_f32_16x16x32_bf16 v[144:147], v[80:83], a[96:99], v[144:147]
 ds_read_b64_tr_b16 v[92:93], v15 offset:12288
 v_mfma_f32_16x16x32_bf16 v[148:151], v[80:83], a[100:103], v[148:151]
 ds_read_b64_tr_b16 v[94:95], v15 offset:14336
 v_mfma_f32_16x16x32_bf16 v[152:155], v[80:83], a[104:107], v[152:155]
 v_cvt_pk_bf16_f32 v232, v28, v29
 v_mfma_f32_16x16x32_bf16 v[156:159], v[80:83], a[108:111], v[156:159]
 v_cvt_pk_bf16_f32 v233, v30, v31
 s_waitcnt lgkmcnt(4)
 v_mfma_f32_16x16x32_bf16 v[160:163], v[84:87], a[96:99], v[160:163]
 ds_read_b64_tr_b16 v[80:81], v14 offset:40960
 v_mfma_f32_16x16x32_bf16 v[164:167], v[84:87], a[100:103], v[164:167]
 ds_read_b64_tr_b16 v[82:83], v14 offset:43008
 v_mfma_f32_16x16x32_bf16 v[168:171], v[84:87], a[104:107], v[168:171]
 v_cvt_pk_bf16_f32 v234, v44, v45
 v_mfma_f32_16x16x32_bf16 v[172:175], v[84:87], a[108:111], v[172:175]
 v_cvt_pk_bf16_f32 v235, v46, v47
 s_waitcnt lgkmcnt(4)
 v_mfma_f32_16x16x32_bf16 v[144:147], v[88:91], a[112:115], v[144:147]
 ds_read_b64_tr_b16 v[84:85], v15 offset:40960
 v_mfma_f32_16x16x32_bf16 v[148:151], v[88:91], a[116:119], v[148:151]
 ds_read_b64_tr_b16 v[86:87], v15 offset:43008
 v_mfma_f32_16x16x32_bf16 v[152:155], v[88:91], a[120:123], v[152:155]
 s_mov_b32 s94, 1081344
 v_mfma_f32_16x16x32_bf16 v[156:159], v[88:91], a[124:127], v[156:159]
 buffer_store_dwordx4 v[232:235], v102, s[28:31], s94 offen sc1
 s_waitcnt lgkmcnt(4)
 v_mfma_f32_16x16x32_bf16 v[160:163], v[92:95], a[112:115], v[160:163]
 v_mfma_f32_16x16x32_bf16 v[164:167], v[92:95], a[116:119], v[164:167]
 v_mfma_f32_16x16x32_bf16 v[168:171], v[92:95], a[120:123], v[168:171]
 v_cvt_pk_bf16_f32 v236, v60, v61
 v_mfma_f32_16x16x32_bf16 v[172:175], v[92:95], a[124:127], v[172:175]
 v_cvt_pk_bf16_f32 v237, v62, v63
 s_waitcnt lgkmcnt(2)
 v_mfma_f32_16x16x32_bf16 v[144:147], v[80:83], a[128:131], v[144:147]
 v_mfma_f32_16x16x32_bf16 v[148:151], v[80:83], a[132:135], v[148:151]
 v_mfma_f32_16x16x32_bf16 v[152:155], v[80:83], a[136:139], v[152:155]
 v_cvt_pk_bf16_f32 v238, v76, v77
 v_mfma_f32_16x16x32_bf16 v[156:159], v[80:83], a[140:143], v[156:159]
 v_cvt_pk_bf16_f32 v239, v78, v79
 s_waitcnt lgkmcnt(0)
 v_mfma_f32_16x16x32_bf16 v[160:163], v[84:87], a[128:131], v[160:163]
 v_mfma_f32_16x16x32_bf16 v[164:167], v[84:87], a[132:135], v[164:167]
 v_mfma_f32_16x16x32_bf16 v[168:171], v[84:87], a[136:139], v[168:171]
 s_mov_b32 s94, 1097728
 v_mfma_f32_16x16x32_bf16 v[172:175], v[84:87], a[140:143], v[172:175]
 buffer_store_dwordx4 v[236:239], v102, s[28:31], s94 offen sc1
 s_load_dwordx2 s[66:67], s[0:1], 56
 v_lshrrev_b32 v248, 4, v0
 v_lshrrev_b32 v249, 2, v0
 v_and_b32 v249, 3, v249
 v_lshl_add_u32 v249, v248, 2, v249
 v_lshlrev_b32 v249, 6, v249
 v_and_b32 v250, 3, v0
 v_lshl_add_u32 v249, v250, 3, v249
 v_and_b32 v248, 1, v248
 v_xor_b32 v250, 0, v248
 v_lshl_add_u32 v10, v250, 5, v249
 v_xor_b32 v250, 1, v248
 v_lshl_add_u32 v11, v250, 5, v249
 v_cvt_pk_bf16_f32 v224, v144, v145
 v_cvt_pk_bf16_f32 v225, v146, v147
 v_cvt_pk_bf16_f32 v226, v160, v161
 v_cvt_pk_bf16_f32 v227, v162, v163
 s_lshl_b32 s94, s50, 14
 v_subrev_u32 v102, s94, v102
 s_mov_b32 s94, 262144
 buffer_store_dwordx4 v[224:227], v102, s[28:31], s94 offen sc1
 v_cvt_pk_bf16_f32 v228, v148, v149
 v_cvt_pk_bf16_f32 v229, v150, v151
 v_cvt_pk_bf16_f32 v230, v164, v165
 v_cvt_pk_bf16_f32 v231, v166, v167
 s_mov_b32 s94, 557056
 buffer_store_dwordx4 v[228:231], v102, s[28:31], s94 offen sc1
 v_cvt_pk_bf16_f32 v232, v152, v153
 v_cvt_pk_bf16_f32 v233, v154, v155
 v_cvt_pk_bf16_f32 v234, v168, v169
 v_cvt_pk_bf16_f32 v235, v170, v171
 s_mov_b32 s94, 851968
 buffer_store_dwordx4 v[232:235], v102, s[28:31], s94 offen sc1
 v_cvt_pk_bf16_f32 v236, v156, v157
 v_cvt_pk_bf16_f32 v237, v158, v159
 v_cvt_pk_bf16_f32 v238, v172, v173
 v_cvt_pk_bf16_f32 v239, v174, v175
 s_mov_b32 s94, 1146880
 buffer_store_dwordx4 v[236:239], v102, s[28:31], s94 offen sc1
 s_waitcnt lgkmcnt(0)
 s_mov_b32 s68, s66
 s_and_b32 s69, s67, 0xffff
 s_mov_b32 s70, 2359296
 s_mov_b32 s71, 0x20000
 s_lshl_b32 s63, s52, 7
 s_add_u32 s63, s63, 52428800
 s_lshl_b32 s58, s51, 2
 s_add_u32 s57, s63, s58
 v_mov_b32 v202, s57
 v_mov_b32 v203, 0x7ff00000
 v_cmp_eq_u32 vcc, 0, v0
 s_nop 1
 v_cndmask_b32 v202, v203, v202, vcc
 s_cmp_eq_u32 s48, 2
 s_cselect_b64 s[86:87], -1, 0
 v_cndmask_b32 v202, v203, v202, s[86:87]
 v_mov_b32 v203, 1
 v_lshlrev_b32 v200, 2, v0
 v_add_u32 v200, s63, v200
 v_mov_b32 v201, 0x7ff00000
 v_cmp_gt_u32 vcc, 16, v0
 s_nop 1
 v_cndmask_b32 v200, v201, v200, vcc
 s_cmp_eq_u32 s48, 0
 s_cselect_b64 s[86:87], -1, 0
 v_cndmask_b32 v200, v201, v200, s[86:87]
 s_waitcnt vmcnt(0)
 s_barrier
 buffer_store_dword v203, v202, s[28:31], 0 offen sc1
 s_add_u32 m0, s53, 0
 s_mov_b32 s54, 0
 buffer_load_dwordx4 v2, s[4:7], s54 offen lds
 buffer_load_dwordx4 v3, s[4:7], s54 offen offset:1024 lds
 v_and_b32 v192, 15, v0
 v_lshrrev_b32 v193, 4, v0
 v_lshlrev_b32 v194, 4, v0
 s_and_b32 s62, s51, 1
 s_add_u32 m0, s53, 8192
 s_mov_b32 s54, 82944
 buffer_load_dwordx4 v2, s[4:7], s54 offen lds
 buffer_load_dwordx4 v3, s[4:7], s54 offen offset:1024 lds
 s_add_u32 s62, s62, 16
 s_lshr_b32 s59, s51, 2
 s_cmp_eq_u32 s59, s48
 s_cselect_b64 s[64:65], -1, 0
 s_add_u32 m0, s53, 16384
 s_mov_b32 s54, 165888
 buffer_load_dwordx4 v2, s[4:7], s54 offen lds
 buffer_load_dwordx4 v3, s[4:7], s54 offen offset:1024 lds
 s_mul_i32 s57, s60, 18
 s_add_u32 s57, s57, s51
 s_lshl_b32 s57, s57, 14
 v_add_u32 v144, s57, v194
 s_add_u32 m0, s53, 24576
 s_mov_b32 s54, 248832
 buffer_load_dwordx4 v2, s[4:7], s54 offen lds
 buffer_load_dwordx4 v3, s[4:7], s54 offen offset:1024 lds
 s_lshl_b32 s57, s60, 4
 v_add_u32 v195, s57, v192
 v_mul_u32_u24 v195, 0x480, v195
 v_lshl_add_u32 v195, v193, 3, v195
 s_add_u32 m0, s53, 32768
 s_mov_b32 s54, 331776
 buffer_load_dwordx4 v2, s[4:7], s54 offen lds
 buffer_load_dwordx4 v3, s[4:7], s54 offen offset:1024 lds
 s_lshl_b32 s57, s51, 6
 v_add_u32 v147, s57, v195
 s_mul_i32 s57, s61, 18
 s_add_u32 s57, s57, s51
 s_add_u32 m0, s53, 40960
 s_mov_b32 s54, 414720
 buffer_load_dwordx4 v2, s[4:7], s54 offen lds
 buffer_load_dwordx4 v3, s[4:7], s54 offen offset:1024 lds
 s_lshl_b32 s57, s57, 14
 v_add_u32 v145, s57, v194
 s_lshl_b32 s57, s61, 4
 v_add_u32 v195, s57, v192
 s_add_u32 m0, s53, 49152
 s_mov_b32 s54, 497664
 buffer_load_dwordx4 v2, s[4:7], s54 offen lds
 buffer_load_dwordx4 v3, s[4:7], s54 offen offset:1024 lds
 v_mul_u32_u24 v195, 0x480, v195
 v_lshl_add_u32 v195, v193, 3, v195
 s_lshl_b32 s57, s51, 6
 v_add_u32 v148, s57, v195
 s_add_u32 m0, s53, 57344
 s_mov_b32 s54, 580608
 buffer_load_dwordx4 v2, s[4:7], s54 offen lds
 buffer_load_dwordx4 v3, s[4:7], s54 offen offset:1024 lds
 s_mul_i32 s57, s60, 18
 s_add_u32 s57, s57, s62
 s_lshl_b32 s57, s57, 14
 v_add_u32 v146, s57, v194
 s_add_u32 m0, s53, 65536
 s_mov_b32 s54, 0
 buffer_load_dwordx4 v4, s[4:7], s54 offen lds
 buffer_load_dwordx4 v5, s[4:7], s54 offen offset:1024 lds
 s_lshl_b32 s57, s60, 4
 v_add_u32 v195, s57, v192
 v_mul_u32_u24 v195, 0x480, v195
 v_lshl_add_u32 v195, v193, 3, v195
 s_mov_b32 s93, 0
 s_lshl_b32 s57, s62, 6
 v_add_u32 v149, s57, v195
 buffer_load_dwordx4 a[144:147], v240, s[28:31], s93 offen offset:0 sc1
 s_lshl_b32 s57, s52, 3
 s_lshr_b32 s58, s51, 1
 buffer_load_dwordx4 a[216:219], v241, s[28:31], s93 offen offset:0 sc1
 s_add_u32 s57, s57, s58
 s_mul_i32 s57, s57, 18
 buffer_load_dwordx4 a[148:151], v240, s[28:31], s93 offen offset:1024 sc1
 s_add_u32 s57, s57, s62
 s_lshl_b32 s57, s57, 14
 buffer_load_dwordx4 a[220:223], v241, s[28:31], s93 offen offset:1024 sc1
 s_lshl_b32 s58, s48, 12
 s_add_u32 s57, s57, s58
 buffer_load_dword v111, v200, s[28:31], 0 offen sc1
 buffer_load_dwordx4 a[152:155], v240, s[28:31], s93 offen offset:2048 sc1
 v_lshlrev_b32 v195, 4, v0
 v_add_u32 v146, s57, v195
 buffer_load_dwordx4 a[224:227], v241, s[28:31], s93 offen offset:2048 sc1
 v_mov_b32 v195, 0x7ff00000
 v_cndmask_b32 v149, v195, v149, s[64:65]
 buffer_load_dwordx4 a[156:159], v240, s[28:31], s93 offen offset:3072 sc1
 v_lshrrev_b32 v196, 2, v192
 v_and_b32 v197, 3, v192
 buffer_load_dwordx4 a[228:231], v241, s[28:31], s93 offen offset:3072 sc1
 v_mov_b32 v150, 0
 v_mov_b32 v151, 0
 s_mov_b32 s93, 4096
 v_mov_b32 v154, 0
 v_mov_b32 v155, 0
 buffer_load_dwordx4 a[160:163], v240, s[28:31], s93 offen offset:0 sc1
 v_mov_b32 v198, 0x3f80
 v_mov_b32 v199, 0x3f800000
 buffer_load_dwordx4 a[232:235], v241, s[28:31], s93 offen offset:0 sc1
 v_and_b32 v194, 1, v197
 v_cmp_eq_u32 vcc, 1, v194
 s_nop 1
 v_cndmask_b32 v198, v198, v199, vcc
 buffer_load_dwordx4 a[164:167], v240, s[28:31], s93 offen offset:1024 sc1
 v_cmp_eq_u32 vcc, v193, v196
 s_nop 1
 v_cndmask_b32 v198, 0, v198, vcc
 buffer_load_dwordx4 a[236:239], v241, s[28:31], s93 offen offset:1024 sc1
 v_cmp_gt_u32 vcc, 2, v197
 s_nop 1
 v_cndmask_b32 v152, 0, v198, vcc
 v_cndmask_b32 v153, v198, 0, vcc
 s_waitcnt vmcnt(8)
 v_cmp_eq_u32 vcc, 1, v111
 s_nop 1
 s_and_b32 s57, vcc_lo, 0xffff
 s_cmp_eq_u32 s57, 0xffff
 s_cbranch_scc1 L1_dok
 s_cmp_lg_u32 s48, 0
 s_cbranch_scc1 L1_dok
 s_mov_b32 s95, 0
L1_dspin:
 s_add_u32 s95, s95, 1
 s_cmp_ge_u32 s95, 0x80000
 s_cbranch_scc1 L1_dok
 buffer_load_dword v111, v200, s[28:31], 0 offen sc1
 s_waitcnt vmcnt(0)
 v_cmp_eq_u32 vcc, 1, v111
 s_nop 1
 s_and_b32 s57, vcc_lo, 0xffff
 s_cmp_eq_u32 s57, 0xffff
 s_cbranch_scc1 L1_dok
 s_sleep 1
 s_branch L1_dspin
L1_dok:
 s_barrier
 s_lshr_b32 s59, s51, 2
 s_cmp_eq_u32 s59, s48
 s_cbranch_scc1 L1_own
 s_mov_b32 s94, 0
 buffer_load_dwordx4 a[128:131], v146, s[28:31], s94 offen offset:0 sc1
 buffer_load_dwordx4 a[132:135], v146, s[28:31], s94 offen offset:1024 sc1
 buffer_load_dwordx4 a[136:139], v146, s[28:31], s94 offen offset:2048 sc1
 buffer_load_dwordx4 a[140:143], v146, s[28:31], s94 offen offset:3072 sc1
 buffer_load_dwordx2 v[156:157], v147, s[8:11], 0 offen offset:0
 buffer_load_dwordx2 v[158:159], v147, s[8:11], 0 offen offset:32
 s_mov_b32 s94, 0
 buffer_load_dwordx4 a[0:3], v144, s[28:31], s94 offen offset:0 sc1
 buffer_load_dwordx4 a[4:7], v144, s[28:31], s94 offen offset:1024 sc1
 buffer_load_dwordx4 a[8:11], v144, s[28:31], s94 offen offset:2048 sc1
 buffer_load_dwordx4 a[12:15], v144, s[28:31], s94 offen offset:3072 sc1
 s_mov_b32 s94, 4096
 buffer_load_dwordx4 a[16:19], v144, s[28:31], s94 offen offset:0 sc1
 buffer_load_dwordx4 a[20:23], v144, s[28:31], s94 offen offset:1024 sc1
 ds_read_b64_tr_b16 v[40:41], v10 offset:0
 ds_read_b64_tr_b16 v[42:43], v10 offset:1024
 ds_read_b64_tr_b16 v[44:45], v11 offset:0
 ds_read_b64_tr_b16 v[46:47], v11 offset:1024
 ds_read_b64_tr_b16 v[48:49], v10 offset:2048
 ds_read_b64_tr_b16 v[50:51], v10 offset:3072
 ds_read_b64_tr_b16 v[52:53], v11 offset:2048
 ds_read_b64_tr_b16 v[54:55], v11 offset:3072
 ds_read_b64_tr_b16 v[56:57], v10 offset:8192
 ds_read_b64_tr_b16 v[58:59], v10 offset:9216
 ds_read_b64_tr_b16 v[60:61], v11 offset:8192
 ds_read_b64_tr_b16 v[62:63], v11 offset:9216
 s_waitcnt lgkmcnt(10)
 v_mfma_f32_16x16x32_bf16 v[16:19], v[40:43], a[144:147], 0
 ds_read_b64_tr_b16 v[64:65], v10 offset:10240
 ds_read_b64_tr_b16 v[66:67], v10 offset:11264
 v_mfma_f32_16x16x32_bf16 v[20:23], v[40:43], a[216:219], 0
 buffer_load_dwordx4 a[168:171], v240, s[28:31], s93 offen offset:2048 sc1
 s_waitcnt lgkmcnt(10)
 v_mfma_f32_16x16x32_bf16 v[24:27], v[44:47], a[144:147], 0
 ds_read_b64_tr_b16 v[68:69], v11 offset:10240
 ds_read_b64_tr_b16 v[70:71], v11 offset:11264
 v_mfma_f32_16x16x32_bf16 v[28:31], v[44:47], a[216:219], 0
 buffer_load_dwordx4 a[240:243], v241, s[28:31], s93 offen offset:2048 sc1
 s_waitcnt lgkmcnt(10)
 v_mfma_f32_16x16x32_bf16 v[16:19], v[48:51], a[148:151], v[16:19]
 ds_read_b64_tr_b16 v[40:41], v10 offset:16384
 ds_read_b64_tr_b16 v[42:43], v10 offset:17408
 v_mfma_f32_16x16x32_bf16 v[20:23], v[48:51], a[220:223], v[20:23]
 buffer_load_dwordx4 a[172:175], v240, s[28:31], s93 offen offset:3072 sc1
 s_waitcnt lgkmcnt(10)
 v_mfma_f32_16x16x32_bf16 v[24:27], v[52:55], a[148:151], v[24:27]
 ds_read_b64_tr_b16 v[44:45], v11 offset:16384
 ds_read_b64_tr_b16 v[46:47], v11 offset:17408
 v_mfma_f32_16x16x32_bf16 v[28:31], v[52:55], a[220:223], v[28:31]
 buffer_load_dwordx4 a[244:247], v241, s[28:31], s93 offen offset:3072 sc1
 s_waitcnt vmcnt(22)
 s_waitcnt lgkmcnt(10)
 v_mfma_f32_16x16x32_bf16 v[16:19], v[56:59], a[152:155], v[16:19]
 ds_read_b64_tr_b16 v[48:49], v10 offset:18432
 ds_read_b64_tr_b16 v[50:51], v10 offset:19456
 v_mfma_f32_16x16x32_bf16 v[20:23], v[56:59], a[224:227], v[20:23]
 s_mov_b32 s93, 8192
 s_waitcnt lgkmcnt(10)
 v_mfma_f32_16x16x32_bf16 v[24:27], v[60:63], a[152:155], v[24:27]
 ds_read_b64_tr_b16 v[52:53], v11 offset:18432
 ds_read_b64_tr_b16 v[54:55], v11 offset:19456
 v_mfma_f32_16x16x32_bf16 v[28:31], v[60:63], a[224:227], v[28:31]
 buffer_load_dwordx4 a[176:179], v240, s[28:31], s93 offen offset:0 sc1
 s_waitcnt vmcnt(21)
 s_waitcnt lgkmcnt(10)
 v_mfma_f32_16x16x32_bf16 v[16:19], v[64:67], a[156:159], v[16:19]
 ds_read_b64_tr_b16 v[56:57], v10 offset:24576
 ds_read_b64_tr_b16 v[58:59], v10 offset:25600
 v_mfma_f32_16x16x32_bf16 v[20:23], v[64:67], a[228:231], v[20:23]
 buffer_load_dwordx4 a[248:251], v241, s[28:31], s93 offen offset:0 sc1
 s_waitcnt lgkmcnt(10)
 v_mfma_f32_16x16x32_bf16 v[24:27], v[68:71], a[156:159], v[24:27]
 ds_read_b64_tr_b16 v[60:61], v11 offset:24576
 ds_read_b64_tr_b16 v[62:63], v11 offset:25600
 v_mfma_f32_16x16x32_bf16 v[28:31], v[68:71], a[228:231], v[28:31]
 buffer_load_dwordx4 a[180:183], v240, s[28:31], s93 offen offset:1024 sc1
 s_waitcnt vmcnt(21)
 s_waitcnt lgkmcnt(10)
 v_mfma_f32_16x16x32_bf16 v[16:19], v[40:43], a[160:163], v[16:19]
 ds_read_b64_tr_b16 v[64:65], v10 offset:26624
 ds_read_b64_tr_b16 v[66:67], v10 offset:27648
 v_mfma_f32_16x16x32_bf16 v[20:23], v[40:43], a[232:235], v[20:23]
 buffer_load_dwordx4 a[252:255], v241, s[28:31], s93 offen offset:1024 sc1
 s_waitcnt lgkmcnt(10)
 v_mfma_f32_16x16x32_bf16 v[24:27], v[44:47], a[160:163], v[24:27]
 ds_read_b64_tr_b16 v[68:69], v11 offset:26624
 ds_read_b64_tr_b16 v[70:71], v11 offset:27648
 v_mfma_f32_16x16x32_bf16 v[28:31], v[44:47], a[232:235], v[28:31]
 buffer_load_dwordx4 a[184:187], v240, s[28:31], s93 offen offset:2048 sc1
 s_waitcnt vmcnt(21)
 s_waitcnt lgkmcnt(10)
 v_mfma_f32_16x16x32_bf16 v[16:19], v[48:51], a[164:167], v[16:19]
 ds_read_b64_tr_b16 v[40:41], v10 offset:32768
 ds_read_b64_tr_b16 v[42:43], v10 offset:33792
 v_mfma_f32_16x16x32_bf16 v[20:23], v[48:51], a[236:239], v[20:23]
 buffer_load_dwordx4 v[112:115], v241, s[28:31], s93 offen offset:2048 sc1
 s_waitcnt lgkmcnt(10)
 v_mfma_f32_16x16x32_bf16 v[24:27], v[52:55], a[164:167], v[24:27]
 ds_read_b64_tr_b16 v[44:45], v11 offset:32768
 ds_read_b64_tr_b16 v[46:47], v11 offset:33792
 v_mfma_f32_16x16x32_bf16 v[28:31], v[52:55], a[236:239], v[28:31]
 buffer_load_dwordx4 a[188:191], v240, s[28:31], s93 offen offset:3072 sc1
 s_waitcnt vmcnt(9)
 s_waitcnt lgkmcnt(10)
 v_mfma_f32_16x16x32_bf16 v[16:19], v[56:59], a[168:171], v[16:19]
 ds_read_b64_tr_b16 v[48:49], v10 offset:34816
 ds_read_b64_tr_b16 v[50:51], v10 offset:35840
 v_mfma_f32_16x16x32_bf16 v[20:23], v[56:59], a[240:243], v[20:23]
 buffer_load_dwordx4 v[116:119], v241, s[28:31], s93 offen offset:3072 sc1
 s_waitcnt lgkmcnt(10)
 v_mfma_f32_16x16x32_bf16 v[24:27], v[60:63], a[168:171], v[24:27]
 ds_read_b64_tr_b16 v[52:53], v11 offset:34816
 ds_read_b64_tr_b16 v[54:55], v11 offset:35840
 v_mfma_f32_16x16x32_bf16 v[28:31], v[60:63], a[240:243], v[28:31]
 s_mov_b32 s93, 12288
 s_waitcnt vmcnt(8)
 s_waitcnt lgkmcnt(10)
 v_mfma_f32_16x16x32_bf16 v[16:19], v[64:67], a[172:175], v[16:19]
 ds_read_b64_tr_b16 v[56:57], v10 offset:40960
 ds_read_b64_tr_b16 v[58:59], v10 offset:41984
 v_mfma_f32_16x16x32_bf16 v[20:23], v[64:67], a[244:247], v[20:23]
 buffer_load_dwordx4 a[192:195], v240, s[28:31], s93 offen offset:0 sc1
 s_waitcnt lgkmcnt(10)
 v_mfma_f32_16x16x32_bf16 v[24:27], v[68:71], a[172:175], v[24:27]
 ds_read_b64_tr_b16 v[60:61], v11 offset:40960
 ds_read_b64_tr_b16 v[62:63], v11 offset:41984
 v_mfma_f32_16x16x32_bf16 v[28:31], v[68:71], a[244:247], v[28:31]
 buffer_load_dwordx4 v[120:123], v241, s[28:31], s93 offen offset:0 sc1
 s_waitcnt vmcnt(8)
 s_waitcnt lgkmcnt(10)
 v_mfma_f32_16x16x32_bf16 v[16:19], v[40:43], a[176:179], v[16:19]
 ds_read_b64_tr_b16 v[64:65], v10 offset:43008
 ds_read_b64_tr_b16 v[66:67], v10 offset:44032
 v_mfma_f32_16x16x32_bf16 v[20:23], v[40:43], a[248:251], v[20:23]
 buffer_load_dwordx4 a[196:199], v240, s[28:31], s93 offen offset:1024 sc1
 s_waitcnt lgkmcnt(10)
 v_mfma_f32_16x16x32_bf16 v[24:27], v[44:47], a[176:179], v[24:27]
 ds_read_b64_tr_b16 v[68:69], v11 offset:43008
 ds_read_b64_tr_b16 v[70:71], v11 offset:44032
 v_mfma_f32_16x16x32_bf16 v[28:31], v[44:47], a[248:251], v[28:31]
 buffer_load_dwordx4 v[124:127], v241, s[28:31], s93 offen offset:1024 sc1
 s_waitcnt vmcnt(8)
 s_waitcnt lgkmcnt(10)
 v_mfma_f32_16x16x32_bf16 v[16:19], v[48:51], a[180:183], v[16:19]
 ds_read_b64_tr_b16 v[40:41], v10 offset:49152
 ds_read_b64_tr_b16 v[42:43], v10 offset:50176
 v_mfma_f32_16x16x32_bf16 v[20:23], v[48:51], a[252:255], v[20:23]
 buffer_load_dwordx4 a[200:203], v240, s[28:31], s93 offen offset:2048 sc1
 s_waitcnt lgkmcnt(10)
 v_mfma_f32_16x16x32_bf16 v[24:27], v[52:55], a[180:183], v[24:27]
 ds_read_b64_tr_b16 v[44:45], v11 offset:49152
 ds_read_b64_tr_b16 v[46:47], v11 offset:50176
 v_mfma_f32_16x16x32_bf16 v[28:31], v[52:55], a[252:255], v[28:31]
 buffer_load_dwordx4 v[128:131], v241, s[28:31], s93 offen offset:2048 sc1
 s_waitcnt vmcnt(8)
 s_waitcnt lgkmcnt(10)
 v_mfma_f32_16x16x32_bf16 v[16:19], v[56:59], a[184:187], v[16:19]
 ds_read_b64_tr_b16 v[48:49], v10 offset:51200
 ds_read_b64_tr_b16 v[50:51], v10 offset:52224
 v_mfma_f32_16x16x32_bf16 v[20:23], v[56:59], v[112:115], v[20:23]
 buffer_load_dwordx4 a[204:207], v240, s[28:31], s93 offen offset:3072 sc1
 s_waitcnt lgkmcnt(10)
 v_mfma_f32_16x16x32_bf16 v[24:27], v[60:63], a[184:187], v[24:27]
 ds_read_b64_tr_b16 v[52:53], v11 offset:51200
 ds_read_b64_tr_b16 v[54:55], v11 offset:52224
 v_mfma_f32_16x16x32_bf16 v[28:31], v[60:63], v[112:115], v[28:31]
 buffer_load_dwordx4 v[132:135], v241, s[28:31], s93 offen offset:3072 sc1
 s_waitcnt vmcnt(8)
 s_waitcnt lgkmcnt(10)
 v_mfma_f32_16x16x32_bf16 v[16:19], v[64:67], a[188:191], v[16:19]
 ds_read_b64_tr_b16 v[56:57], v10 offset:57344
 ds_read_b64_tr_b16 v[58:59], v10 offset:58368
 v_mfma_f32_16x16x32_bf16 v[20:23], v[64:67], v[116:119], v[20:23]
 s_mov_b32 s93, 16384
 s_waitcnt lgkmcnt(10)
 v_mfma_f32_16x16x32_bf16 v[24:27], v[68:71], a[188:191], v[24:27]
 ds_read_b64_tr_b16 v[60:61], v11 offset:57344
 ds_read_b64_tr_b16 v[62:63], v11 offset:58368
 v_mfma_f32_16x16x32_bf16 v[28:31], v[68:71], v[116:119], v[28:31]
 buffer_load_dwordx4 a[208:211], v240, s[28:31], s93 offen offset:0 sc1
 s_waitcnt vmcnt(7)
 s_waitcnt lgkmcnt(10)
 v_mfma_f32_16x16x32_bf16 v[16:19], v[40:43], a[192:195], v[16:19]
 ds_read_b64_tr_b16 v[64:65], v10 offset:59392
 ds_read_b64_tr_b16 v[66:67], v10 offset:60416
 v_mfma_f32_16x16x32_bf16 v[20:23], v[40:43], v[120:123], v[20:23]
 buffer_load_dwordx4 v[136:139], v241, s[28:31], s93 offen offset:0 sc1
 s_waitcnt lgkmcnt(10)
 v_mfma_f32_16x16x32_bf16 v[24:27], v[44:47], a[192:195], v[24:27]
 ds_read_b64_tr_b16 v[68:69], v11 offset:59392
 ds_read_b64_tr_b16 v[70:71], v11 offset:60416
 v_mfma_f32_16x16x32_bf16 v[28:31], v[44:47], v[120:123], v[28:31]
 buffer_load_dwordx4 a[212:215], v240, s[28:31], s93 offen offset:1024 sc1
 s_waitcnt vmcnt(7)
 s_waitcnt lgkmcnt(10)
 v_mfma_f32_16x16x32_bf16 v[16:19], v[48:51], a[196:199], v[16:19]
 v_add_u32 v10, 0x10000, v10
 ds_read_b64_tr_b16 v[40:41], v10 offset:0
 ds_read_b64_tr_b16 v[42:43], v10 offset:1024
 v_mfma_f32_16x16x32_bf16 v[20:23], v[48:51], v[124:127], v[20:23]
 buffer_load_dwordx4 v[140:143], v241, s[28:31], s93 offen offset:1024 sc1
 s_waitcnt lgkmcnt(10)
 v_mfma_f32_16x16x32_bf16 v[24:27], v[52:55], a[196:199], v[24:27]
 v_add_u32 v11, 0x10000, v11
 ds_read_b64_tr_b16 v[44:45], v11 offset:0
 ds_read_b64_tr_b16 v[46:47], v11 offset:1024
 v_mfma_f32_16x16x32_bf16 v[28:31], v[52:55], v[124:127], v[28:31]
 buffer_load_dwordx4 a[24:27], v144, s[28:31], s94 offen offset:2048 sc1
 s_waitcnt vmcnt(7)
 s_waitcnt lgkmcnt(10)
 v_mfma_f32_16x16x32_bf16 v[16:19], v[56:59], a[200:203], v[16:19]
 ds_read_b64_tr_b16 v[48:49], v10 offset:2048
 ds_read_b64_tr_b16 v[50:51], v10 offset:3072
 v_mfma_f32_16x16x32_bf16 v[20:23], v[56:59], v[128:131], v[20:23]
 buffer_load_dwordx4 a[28:31], v144, s[28:31], s94 offen offset:3072 sc1
 s_waitcnt lgkmcnt(10)
 v_mfma_f32_16x16x32_bf16 v[24:27], v[60:63], a[200:203], v[24:27]
 ds_read_b64_tr_b16 v[52:53], v11 offset:2048
 ds_read_b64_tr_b16 v[54:55], v11 offset:3072
 v_mfma_f32_16x16x32_bf16 v[28:31], v[60:63], v[128:131], v[28:31]
 s_mov_b32 s94, 8192
 buffer_load_dwordx4 a[32:35], v144, s[28:31], s94 offen offset:0 sc1
 s_waitcnt vmcnt(7)
 s_waitcnt lgkmcnt(10)
 v_mfma_f32_16x16x32_bf16 v[16:19], v[64:67], a[204:207], v[16:19]
 v_mfma_f32_16x16x32_bf16 v[20:23], v[64:67], v[132:135], v[20:23]
 buffer_load_dwordx4 a[36:39], v144, s[28:31], s94 offen offset:1024 sc1
 s_waitcnt lgkmcnt(8)
 v_mfma_f32_16x16x32_bf16 v[24:27], v[68:71], a[204:207], v[24:27]
 v_mfma_f32_16x16x32_bf16 v[28:31], v[68:71], v[132:135], v[28:31]
 buffer_load_dwordx4 a[40:43], v144, s[28:31], s94 offen offset:2048 sc1
 s_waitcnt vmcnt(7)
 s_waitcnt lgkmcnt(6)
 v_mfma_f32_16x16x32_bf16 v[16:19], v[40:43], a[208:211], v[16:19]
 v_mfma_f32_16x16x32_bf16 v[20:23], v[40:43], v[136:139], v[20:23]
 buffer_load_dwordx4 a[44:47], v144, s[28:31], s94 offen offset:3072 sc1
 s_waitcnt lgkmcnt(4)
 v_mfma_f32_16x16x32_bf16 v[24:27], v[44:47], a[208:211], v[24:27]
 v_mfma_f32_16x16x32_bf16 v[28:31], v[44:47], v[136:139], v[28:31]
 s_mov_b32 s94, 12288
 buffer_load_dwordx4 a[48:51], v144, s[28:31], s94 offen offset:0 sc1
 s_waitcnt vmcnt(7)
 s_waitcnt lgkmcnt(2)
 v_mfma_f32_16x16x32_bf16 v[16:19], v[48:51], a[212:215], v[16:19]
 v_mfma_f32_16x16x32_bf16 v[20:23], v[48:51], v[140:143], v[20:23]
 buffer_load_dwordx4 a[52:55], v144, s[28:31], s94 offen offset:1024 sc1
 s_waitcnt lgkmcnt(0)
 v_mfma_f32_16x16x32_bf16 v[24:27], v[52:55], a[212:215], v[24:27]
 v_mfma_f32_16x16x32_bf16 v[28:31], v[52:55], v[140:143], v[28:31]
 buffer_load_dwordx4 a[56:59], v144, s[28:31], s94 offen offset:2048 sc1
 buffer_load_dwordx4 a[60:63], v144, s[28:31], s94 offen offset:3072 sc1
 buffer_load_dwordx2 v[160:161], v148, s[8:11], 0 offen offset:0
 buffer_load_dwordx2 v[162:163], v148, s[8:11], 0 offen offset:32
 s_mov_b32 s94, 0
 buffer_load_dwordx4 a[64:67], v145, s[28:31], s94 offen offset:0 sc1
 buffer_load_dwordx4 a[68:71], v145, s[28:31], s94 offen offset:1024 sc1
 buffer_load_dwordx4 a[72:75], v145, s[28:31], s94 offen offset:2048 sc1
 buffer_load_dwordx4 a[76:79], v145, s[28:31], s94 offen offset:3072 sc1
 s_mov_b32 s94, 4096
 buffer_load_dwordx4 a[80:83], v145, s[28:31], s94 offen offset:0 sc1
 buffer_load_dwordx4 a[84:87], v145, s[28:31], s94 offen offset:1024 sc1
 buffer_load_dwordx4 a[88:91], v145, s[28:31], s94 offen offset:2048 sc1
 buffer_load_dwordx4 a[92:95], v145, s[28:31], s94 offen offset:3072 sc1
 s_mov_b32 s94, 8192
 buffer_load_dwordx4 a[96:99], v145, s[28:31], s94 offen offset:0 sc1
 buffer_load_dwordx4 a[100:103], v145, s[28:31], s94 offen offset:1024 sc1
 buffer_load_dwordx4 a[104:107], v145, s[28:31], s94 offen offset:2048 sc1
 buffer_load_dwordx4 a[108:111], v145, s[28:31], s94 offen offset:3072 sc1
 s_mov_b32 s94, 12288
 buffer_load_dwordx4 a[112:115], v145, s[28:31], s94 offen offset:0 sc1
 buffer_load_dwordx4 a[116:119], v145, s[28:31], s94 offen offset:1024 sc1
 buffer_load_dwordx4 a[120:123], v145, s[28:31], s94 offen offset:2048 sc1
 buffer_load_dwordx4 a[124:127], v145, s[28:31], s94 offen offset:3072 sc1
 s_mov_b32 s57, 0xbfb8aa3b
 v_mfma_f32_16x16x32_bf16 v[184:187], v[152:155], a[128:131], 0
 v_mfma_f32_16x16x32_bf16 v[188:191], v[150:153], a[128:131], 0
 v_mfma_f32_16x16x32_bf16 v[184:187], v[152:155], a[132:135], v[184:187]
 v_mfma_f32_16x16x32_bf16 v[188:191], v[150:153], a[132:135], v[188:191]
 v_mfma_f32_16x16x32_bf16 v[184:187], v[152:155], a[136:139], v[184:187]
 v_mfma_f32_16x16x32_bf16 v[188:191], v[150:153], a[136:139], v[188:191]
 v_mfma_f32_16x16x32_bf16 v[184:187], v[152:155], a[140:143], v[184:187]
 v_mfma_f32_16x16x32_bf16 v[188:191], v[150:153], a[140:143], v[188:191]
 s_lshl_b32 s58, s48, 11
 s_add_u32 s58, s58, 81920
 v_lshlrev_b32 v208, 4, v0
 v_add_u32 v209, s58, v208
 s_nop 2
 ds_write_b128 v209, v[184:187]
 ds_write_b128 v209, v[188:191] offset:1024
 v_mfma_f32_16x16x32_bf16 v[168:171], v[152:155], a[0:3], 0
 v_mfma_f32_16x16x32_bf16 v[172:175], v[150:153], a[0:3], 0
 v_mfma_f32_16x16x32_bf16 v[168:171], v[152:155], a[4:7], v[168:171]
 v_mfma_f32_16x16x32_bf16 v[172:175], v[150:153], a[4:7], v[172:175]
 v_mfma_f32_16x16x32_bf16 v[168:171], v[152:155], a[8:11], v[168:171]
 v_mfma_f32_16x16x32_bf16 v[172:175], v[150:153], a[8:11], v[172:175]
 v_mfma_f32_16x16x32_bf16 v[168:171], v[152:155], a[12:15], v[168:171]
 v_mfma_f32_16x16x32_bf16 v[172:175], v[150:153], a[12:15], v[172:175]
 v_mfma_f32_16x16x32_bf16 v[168:171], v[152:155], a[16:19], v[168:171]
 v_mfma_f32_16x16x32_bf16 v[172:175], v[150:153], a[16:19], v[172:175]
 v_mfma_f32_16x16x32_bf16 v[168:171], v[152:155], a[20:23], v[168:171]
 v_mfma_f32_16x16x32_bf16 v[172:175], v[150:153], a[20:23], v[172:175]
 s_waitcnt vmcnt(27)
 v_mfma_f32_16x16x32_bf16 v[168:171], v[152:155], a[24:27], v[168:171]
 v_mfma_f32_16x16x32_bf16 v[172:175], v[150:153], a[24:27], v[172:175]
 s_waitcnt vmcnt(26)
 v_mfma_f32_16x16x32_bf16 v[168:171], v[152:155], a[28:31], v[168:171]
 v_mfma_f32_16x16x32_bf16 v[172:175], v[150:153], a[28:31], v[172:175]
 s_waitcnt vmcnt(25)
 v_mfma_f32_16x16x32_bf16 v[168:171], v[152:155], a[32:35], v[168:171]
 v_mfma_f32_16x16x32_bf16 v[172:175], v[150:153], a[32:35], v[172:175]
 s_waitcnt vmcnt(24)
 v_mfma_f32_16x16x32_bf16 v[168:171], v[152:155], a[36:39], v[168:171]
 v_mfma_f32_16x16x32_bf16 v[172:175], v[150:153], a[36:39], v[172:175]
 s_waitcnt vmcnt(23)
 v_mfma_f32_16x16x32_bf16 v[168:171], v[152:155], a[40:43], v[168:171]
 v_mfma_f32_16x16x32_bf16 v[172:175], v[150:153], a[40:43], v[172:175]
 s_waitcnt vmcnt(22)
 v_mfma_f32_16x16x32_bf16 v[168:171], v[152:155], a[44:47], v[168:171]
 v_mfma_f32_16x16x32_bf16 v[172:175], v[150:153], a[44:47], v[172:175]
 s_waitcnt vmcnt(21)
 v_mfma_f32_16x16x32_bf16 v[168:171], v[152:155], a[48:51], v[168:171]
 v_mfma_f32_16x16x32_bf16 v[172:175], v[150:153], a[48:51], v[172:175]
 s_waitcnt vmcnt(20)
 v_mfma_f32_16x16x32_bf16 v[168:171], v[152:155], a[52:55], v[168:171]
 v_mfma_f32_16x16x32_bf16 v[172:175], v[150:153], a[52:55], v[172:175]
 s_waitcnt vmcnt(19)
 v_mfma_f32_16x16x32_bf16 v[168:171], v[152:155], a[56:59], v[168:171]
 v_mfma_f32_16x16x32_bf16 v[172:175], v[150:153], a[56:59], v[172:175]
 s_waitcnt vmcnt(18)
 v_mfma_f32_16x16x32_bf16 v[168:171], v[152:155], a[60:63], v[168:171]
 v_mfma_f32_16x16x32_bf16 v[172:175], v[150:153], a[60:63], v[172:175]
 s_nop 6
 v_mul_f32 v192, s57, v168
 v_mul_f32 v193, s57, v169
 v_mul_f32 v194, s57, v170
 v_mul_f32 v195, s57, v171
 v_mul_f32 v200, s57, v172
 v_mul_f32 v201, s57, v173
 v_mul_f32 v202, s57, v174
 v_mul_f32 v203, s57, v175
 v_exp_f32 v192, v192
 v_exp_f32 v193, v193
 v_exp_f32 v194, v194
 v_exp_f32 v195, v195
 v_exp_f32 v200, v200
 v_exp_f32 v201, v201
 v_exp_f32 v202, v202
 v_exp_f32 v203, v203
 v_add_f32 v192, 1.0, v192
 v_add_f32 v193, 1.0, v193
 v_add_f32 v194, 1.0, v194
 v_add_f32 v195, 1.0, v195
 v_add_f32 v200, 1.0, v200
 v_add_f32 v201, 1.0, v201
 v_add_f32 v202, 1.0, v202
 v_add_f32 v203, 1.0, v203
 v_rcp_f32 v192, v192
 v_rcp_f32 v193, v193
 v_rcp_f32 v194, v194
 v_rcp_f32 v195, v195
 v_rcp_f32 v200, v200
 v_rcp_f32 v201, v201
 v_rcp_f32 v202, v202
 v_rcp_f32 v203, v203
 v_mul_f32 v168, v168, v192
 v_mul_f32 v169, v169, v193
 v_mul_f32 v170, v170, v194
 v_mul_f32 v171, v171, v195
 v_lshlrev_b32 v196, 16, v156
 v_and_b32 v197, s81, v156
 v_lshlrev_b32 v198, 16, v157
 v_and_b32 v199, s81, v157
 v_mul_f32 v172, v172, v200
 v_mul_f32 v173, v173, v201
 v_mul_f32 v174, v174, v202
 v_mul_f32 v175, v175, v203
 v_lshlrev_b32 v204, 16, v158
 v_and_b32 v205, s81, v158
 v_lshlrev_b32 v206, 16, v159
 v_and_b32 v207, s81, v159
 v_fmac_f32 v196, v16, v168
 v_fmac_f32 v197, v17, v169
 v_fmac_f32 v198, v18, v170
 v_fmac_f32 v199, v19, v171
 v_cvt_pk_bf16_f32 v156, v196, v197
 v_cvt_pk_bf16_f32 v157, v198, v199
 buffer_store_dwordx2 v[156:157], v147, s[68:71], 0 offen offset:0
 v_fmac_f32 v204, v24, v172
 v_fmac_f32 v205, v25, v173
 v_fmac_f32 v206, v26, v174
 v_fmac_f32 v207, v27, v175
 v_cvt_pk_bf16_f32 v158, v204, v205
 v_cvt_pk_bf16_f32 v159, v206, v207
 buffer_store_dwordx2 v[158:159], v147, s[68:71], 0 offen offset:32
 s_waitcnt lgkmcnt(0)
 s_barrier
 s_waitcnt vmcnt(17)
 v_mfma_f32_16x16x32_bf16 v[176:179], v[152:155], a[64:67], 0
 v_mfma_f32_16x16x32_bf16 v[180:183], v[150:153], a[64:67], 0
 s_waitcnt vmcnt(16)
 v_mfma_f32_16x16x32_bf16 v[176:179], v[152:155], a[68:71], v[176:179]
 v_mfma_f32_16x16x32_bf16 v[180:183], v[150:153], a[68:71], v[180:183]
 s_waitcnt vmcnt(15)
 v_mfma_f32_16x16x32_bf16 v[176:179], v[152:155], a[72:75], v[176:179]
 v_mfma_f32_16x16x32_bf16 v[180:183], v[150:153], a[72:75], v[180:183]
 s_waitcnt vmcnt(14)
 v_mfma_f32_16x16x32_bf16 v[176:179], v[152:155], a[76:79], v[176:179]
 v_mfma_f32_16x16x32_bf16 v[180:183], v[150:153], a[76:79], v[180:183]
 s_waitcnt vmcnt(13)
 v_mfma_f32_16x16x32_bf16 v[176:179], v[152:155], a[80:83], v[176:179]
 v_mfma_f32_16x16x32_bf16 v[180:183], v[150:153], a[80:83], v[180:183]
 s_waitcnt vmcnt(12)
 v_mfma_f32_16x16x32_bf16 v[176:179], v[152:155], a[84:87], v[176:179]
 v_mfma_f32_16x16x32_bf16 v[180:183], v[150:153], a[84:87], v[180:183]
 s_waitcnt vmcnt(11)
 v_mfma_f32_16x16x32_bf16 v[176:179], v[152:155], a[88:91], v[176:179]
 v_mfma_f32_16x16x32_bf16 v[180:183], v[150:153], a[88:91], v[180:183]
 s_waitcnt vmcnt(10)
 v_mfma_f32_16x16x32_bf16 v[176:179], v[152:155], a[92:95], v[176:179]
 v_mfma_f32_16x16x32_bf16 v[180:183], v[150:153], a[92:95], v[180:183]
 s_waitcnt vmcnt(9)
 v_mfma_f32_16x16x32_bf16 v[176:179], v[152:155], a[96:99], v[176:179]
 v_mfma_f32_16x16x32_bf16 v[180:183], v[150:153], a[96:99], v[180:183]
 s_waitcnt vmcnt(8)
 v_mfma_f32_16x16x32_bf16 v[176:179], v[152:155], a[100:103], v[176:179]
 v_mfma_f32_16x16x32_bf16 v[180:183], v[150:153], a[100:103], v[180:183]
 s_waitcnt vmcnt(7)
 v_mfma_f32_16x16x32_bf16 v[176:179], v[152:155], a[104:107], v[176:179]
 v_mfma_f32_16x16x32_bf16 v[180:183], v[150:153], a[104:107], v[180:183]
 s_waitcnt vmcnt(6)
 v_mfma_f32_16x16x32_bf16 v[176:179], v[152:155], a[108:111], v[176:179]
 v_mfma_f32_16x16x32_bf16 v[180:183], v[150:153], a[108:111], v[180:183]
 s_waitcnt vmcnt(5)
 v_mfma_f32_16x16x32_bf16 v[176:179], v[152:155], a[112:115], v[176:179]
 v_mfma_f32_16x16x32_bf16 v[180:183], v[150:153], a[112:115], v[180:183]
 s_waitcnt vmcnt(4)
 v_mfma_f32_16x16x32_bf16 v[176:179], v[152:155], a[116:119], v[176:179]
 v_mfma_f32_16x16x32_bf16 v[180:183], v[150:153], a[116:119], v[180:183]
 s_waitcnt vmcnt(3)
 v_mfma_f32_16x16x32_bf16 v[176:179], v[152:155], a[120:123], v[176:179]
 v_mfma_f32_16x16x32_bf16 v[180:183], v[150:153], a[120:123], v[180:183]
 s_waitcnt vmcnt(2)
 v_mfma_f32_16x16x32_bf16 v[176:179], v[152:155], a[124:127], v[176:179]
 v_mfma_f32_16x16x32_bf16 v[180:183], v[150:153], a[124:127], v[180:183]
 s_nop 6
 v_mul_f32 v192, s57, v176
 v_mul_f32 v193, s57, v177
 v_mul_f32 v194, s57, v178
 v_mul_f32 v195, s57, v179
 v_mul_f32 v200, s57, v180
 v_mul_f32 v201, s57, v181
 v_mul_f32 v202, s57, v182
 v_mul_f32 v203, s57, v183
 v_exp_f32 v192, v192
 v_exp_f32 v193, v193
 v_exp_f32 v194, v194
 v_exp_f32 v195, v195
 v_exp_f32 v200, v200
 v_exp_f32 v201, v201
 v_exp_f32 v202, v202
 v_exp_f32 v203, v203
 v_add_f32 v192, 1.0, v192
 v_add_f32 v193, 1.0, v193
 v_add_f32 v194, 1.0, v194
 v_add_f32 v195, 1.0, v195
 v_add_f32 v200, 1.0, v200
 v_add_f32 v201, 1.0, v201
 v_add_f32 v202, 1.0, v202
 v_add_f32 v203, 1.0, v203
 v_rcp_f32 v192, v192
 v_rcp_f32 v193, v193
 v_rcp_f32 v194, v194
 v_rcp_f32 v195, v195
 v_rcp_f32 v200, v200
 v_rcp_f32 v201, v201
 v_rcp_f32 v202, v202
 v_rcp_f32 v203, v203
 v_mul_f32 v176, v176, v192
 v_mul_f32 v177, v177, v193
 v_mul_f32 v178, v178, v194
 v_mul_f32 v179, v179, v195
 v_lshlrev_b32 v196, 16, v160
 v_and_b32 v197, s81, v160
 v_lshlrev_b32 v198, 16, v161
 v_and_b32 v199, s81, v161
 v_mul_f32 v180, v180, v200
 v_mul_f32 v181, v181, v201
 v_mul_f32 v182, v182, v202
 v_mul_f32 v183, v183, v203
 v_lshlrev_b32 v204, 16, v162
 v_and_b32 v205, s81, v162
 v_lshlrev_b32 v206, 16, v163
 v_and_b32 v207, s81, v163
 v_fmac_f32 v196, v20, v176
 v_fmac_f32 v197, v21, v177
 v_fmac_f32 v198, v22, v178
 v_fmac_f32 v199, v23, v179
 v_cvt_pk_bf16_f32 v160, v196, v197
 v_cvt_pk_bf16_f32 v161, v198, v199
 buffer_store_dwordx2 v[160:161], v148, s[68:71], 0 offen offset:0
 v_fmac_f32 v204, v28, v180
 v_fmac_f32 v205, v29, v181
 v_fmac_f32 v206, v30, v182
 v_fmac_f32 v207, v31, v183
 v_cvt_pk_bf16_f32 v162, v204, v205
 v_cvt_pk_bf16_f32 v163, v206, v207
 buffer_store_dwordx2 v[162:163], v148, s[68:71], 0 offen offset:32
 s_waitcnt vmcnt(0) lgkmcnt(0)
 s_endpgm
L1_own:
 s_mov_b32 s94, 0
 buffer_load_dwordx4 a[128:131], v146, s[28:31], s94 offen offset:0 sc1
 buffer_load_dwordx4 a[132:135], v146, s[28:31], s94 offen offset:1024 sc1
 buffer_load_dwordx4 a[136:139], v146, s[28:31], s94 offen offset:2048 sc1
 buffer_load_dwordx4 a[140:143], v146, s[28:31], s94 offen offset:3072 sc1
 buffer_load_dwordx2 v[164:165], v149, s[8:11], 0 offen offset:0
 buffer_load_dwordx2 v[166:167], v149, s[8:11], 0 offen offset:32
 buffer_load_dwordx2 v[156:157], v147, s[8:11], 0 offen offset:0
 buffer_load_dwordx2 v[158:159], v147, s[8:11], 0 offen offset:32
 s_mov_b32 s94, 0
 buffer_load_dwordx4 a[0:3], v144, s[28:31], s94 offen offset:0 sc1
 buffer_load_dwordx4 a[4:7], v144, s[28:31], s94 offen offset:1024 sc1
 buffer_load_dwordx4 a[8:11], v144, s[28:31], s94 offen offset:2048 sc1
 buffer_load_dwordx4 a[12:15], v144, s[28:31], s94 offen offset:3072 sc1
 ds_read_b64_tr_b16 v[40:41], v10 offset:0
 ds_read_b64_tr_b16 v[42:43], v10 offset:1024
 ds_read_b64_tr_b16 v[44:45], v10 offset:4096
 ds_read_b64_tr_b16 v[46:47], v10 offset:5120
 ds_read_b64_tr_b16 v[48:49], v11 offset:0
 ds_read_b64_tr_b16 v[50:51], v11 offset:1024
 ds_read_b64_tr_b16 v[52:53], v11 offset:4096
 ds_read_b64_tr_b16 v[54:55], v11 offset:5120
 ds_read_b64_tr_b16 v[56:57], v10 offset:2048
 ds_read_b64_tr_b16 v[58:59], v10 offset:3072
 ds_read_b64_tr_b16 v[60:61], v10 offset:6144
 ds_read_b64_tr_b16 v[62:63], v10 offset:7168
 s_waitcnt lgkmcnt(10)
 v_mfma_f32_16x16x32_bf16 v[16:19], v[40:43], a[144:147], 0
 ds_read_b64_tr_b16 v[64:65], v11 offset:2048
 ds_read_b64_tr_b16 v[66:67], v11 offset:3072
 v_mfma_f32_16x16x32_bf16 v[20:23], v[40:43], a[216:219], 0
 buffer_load_dwordx4 a[168:171], v240, s[28:31], s93 offen offset:2048 sc1
 s_waitcnt lgkmcnt(10)
 v_mfma_f32_16x16x32_bf16 v[32:35], v[44:47], a[144:147], 0
 ds_read_b64_tr_b16 v[68:69], v11 offset:6144
 ds_read_b64_tr_b16 v[70:71], v11 offset:7168
 buffer_load_dwordx4 a[240:243], v241, s[28:31], s93 offen offset:2048 sc1
 s_waitcnt lgkmcnt(10)
 v_mfma_f32_16x16x32_bf16 v[24:27], v[48:51], a[144:147], 0
 ds_read_b64_tr_b16 v[40:41], v10 offset:8192
 ds_read_b64_tr_b16 v[42:43], v10 offset:9216
 v_mfma_f32_16x16x32_bf16 v[28:31], v[48:51], a[216:219], 0
 buffer_load_dwordx4 a[172:175], v240, s[28:31], s93 offen offset:3072 sc1
 s_waitcnt lgkmcnt(10)
 v_mfma_f32_16x16x32_bf16 v[36:39], v[52:55], a[144:147], 0
 ds_read_b64_tr_b16 v[44:45], v10 offset:12288
 ds_read_b64_tr_b16 v[46:47], v10 offset:13312
 buffer_load_dwordx4 a[244:247], v241, s[28:31], s93 offen offset:3072 sc1
 s_waitcnt lgkmcnt(10)
 v_mfma_f32_16x16x32_bf16 v[16:19], v[56:59], a[148:151], v[16:19]
 ds_read_b64_tr_b16 v[48:49], v11 offset:8192
 ds_read_b64_tr_b16 v[50:51], v11 offset:9216
 v_mfma_f32_16x16x32_bf16 v[20:23], v[56:59], a[220:223], v[20:23]
 s_mov_b32 s93, 8192
 s_waitcnt lgkmcnt(10)
 v_mfma_f32_16x16x32_bf16 v[32:35], v[60:63], a[148:151], v[32:35]
 ds_read_b64_tr_b16 v[52:53], v11 offset:12288
 ds_read_b64_tr_b16 v[54:55], v11 offset:13312
 buffer_load_dwordx4 a[176:179], v240, s[28:31], s93 offen offset:0 sc1
 s_waitcnt lgkmcnt(10)
 v_mfma_f32_16x16x32_bf16 v[24:27], v[64:67], a[148:151], v[24:27]
 ds_read_b64_tr_b16 v[56:57], v10 offset:10240
 ds_read_b64_tr_b16 v[58:59], v10 offset:11264
 v_mfma_f32_16x16x32_bf16 v[28:31], v[64:67], a[220:223], v[28:31]
 buffer_load_dwordx4 a[248:251], v241, s[28:31], s93 offen offset:0 sc1
 s_waitcnt lgkmcnt(10)
 v_mfma_f32_16x16x32_bf16 v[36:39], v[68:71], a[148:151], v[36:39]
 ds_read_b64_tr_b16 v[60:61], v10 offset:14336
 ds_read_b64_tr_b16 v[62:63], v10 offset:15360
 buffer_load_dwordx4 a[180:183], v240, s[28:31], s93 offen offset:1024 sc1
 s_waitcnt vmcnt(25)
 s_waitcnt lgkmcnt(10)
 v_mfma_f32_16x16x32_bf16 v[16:19], v[40:43], a[152:155], v[16:19]
 ds_read_b64_tr_b16 v[64:65], v11 offset:10240
 ds_read_b64_tr_b16 v[66:67], v11 offset:11264
 v_mfma_f32_16x16x32_bf16 v[20:23], v[40:43], a[224:227], v[20:23]
 buffer_load_dwordx4 a[252:255], v241, s[28:31], s93 offen offset:1024 sc1
 s_waitcnt lgkmcnt(10)
 v_mfma_f32_16x16x32_bf16 v[32:35], v[44:47], a[152:155], v[32:35]
 ds_read_b64_tr_b16 v[68:69], v11 offset:14336
 ds_read_b64_tr_b16 v[70:71], v11 offset:15360
 buffer_load_dwordx4 a[184:187], v240, s[28:31], s93 offen offset:2048 sc1
 s_waitcnt lgkmcnt(10)
 v_mfma_f32_16x16x32_bf16 v[24:27], v[48:51], a[152:155], v[24:27]
 ds_read_b64_tr_b16 v[40:41], v10 offset:16384
 ds_read_b64_tr_b16 v[42:43], v10 offset:17408
 v_mfma_f32_16x16x32_bf16 v[28:31], v[48:51], a[224:227], v[28:31]
 buffer_load_dwordx4 v[112:115], v241, s[28:31], s93 offen offset:2048 sc1
 s_waitcnt lgkmcnt(10)
 v_mfma_f32_16x16x32_bf16 v[36:39], v[52:55], a[152:155], v[36:39]
 ds_read_b64_tr_b16 v[44:45], v10 offset:20480
 ds_read_b64_tr_b16 v[46:47], v10 offset:21504
 buffer_load_dwordx4 a[188:191], v240, s[28:31], s93 offen offset:3072 sc1
 s_waitcnt vmcnt(27)
 s_waitcnt lgkmcnt(10)
 v_mfma_f32_16x16x32_bf16 v[16:19], v[56:59], a[156:159], v[16:19]
 ds_read_b64_tr_b16 v[48:49], v11 offset:16384
 ds_read_b64_tr_b16 v[50:51], v11 offset:17408
 v_mfma_f32_16x16x32_bf16 v[20:23], v[56:59], a[228:231], v[20:23]
 buffer_load_dwordx4 v[116:119], v241, s[28:31], s93 offen offset:3072 sc1
 s_waitcnt lgkmcnt(10)
 v_mfma_f32_16x16x32_bf16 v[32:35], v[60:63], a[156:159], v[32:35]
 ds_read_b64_tr_b16 v[52:53], v11 offset:20480
 ds_read_b64_tr_b16 v[54:55], v11 offset:21504
 s_mov_b32 s93, 12288
 s_waitcnt lgkmcnt(10)
 v_mfma_f32_16x16x32_bf16 v[24:27], v[64:67], a[156:159], v[24:27]
 ds_read_b64_tr_b16 v[56:57], v10 offset:18432
 ds_read_b64_tr_b16 v[58:59], v10 offset:19456
 v_mfma_f32_16x16x32_bf16 v[28:31], v[64:67], a[228:231], v[28:31]
 buffer_load_dwordx4 a[192:195], v240, s[28:31], s93 offen offset:0 sc1
 s_waitcnt lgkmcnt(10)
 v_mfma_f32_16x16x32_bf16 v[36:39], v[68:71], a[156:159], v[36:39]
 ds_read_b64_tr_b16 v[60:61], v10 offset:22528
 ds_read_b64_tr_b16 v[62:63], v10 offset:23552
 buffer_load_dwordx4 v[120:123], v241, s[28:31], s93 offen offset:0 sc1
 s_waitcnt vmcnt(28)
 s_waitcnt lgkmcnt(10)
 v_mfma_f32_16x16x32_bf16 v[16:19], v[40:43], a[160:163], v[16:19]
 ds_read_b64_tr_b16 v[64:65], v11 offset:18432
 ds_read_b64_tr_b16 v[66:67], v11 offset:19456
 v_mfma_f32_16x16x32_bf16 v[20:23], v[40:43], a[232:235], v[20:23]
 buffer_load_dwordx4 a[196:199], v240, s[28:31], s93 offen offset:1024 sc1
 s_waitcnt lgkmcnt(10)
 v_mfma_f32_16x16x32_bf16 v[32:35], v[44:47], a[160:163], v[32:35]
 ds_read_b64_tr_b16 v[68:69], v11 offset:22528
 ds_read_b64_tr_b16 v[70:71], v11 offset:23552
 buffer_load_dwordx4 v[124:127], v241, s[28:31], s93 offen offset:1024 sc1
 s_waitcnt lgkmcnt(10)
 v_mfma_f32_16x16x32_bf16 v[24:27], v[48:51], a[160:163], v[24:27]
 ds_read_b64_tr_b16 v[40:41], v10 offset:24576
 ds_read_b64_tr_b16 v[42:43], v10 offset:25600
 v_mfma_f32_16x16x32_bf16 v[28:31], v[48:51], a[232:235], v[28:31]
 buffer_load_dwordx4 a[200:203], v240, s[28:31], s93 offen offset:2048 sc1
 s_waitcnt lgkmcnt(10)
 v_mfma_f32_16x16x32_bf16 v[36:39], v[52:55], a[160:163], v[36:39]
 ds_read_b64_tr_b16 v[44:45], v10 offset:28672
 ds_read_b64_tr_b16 v[46:47], v10 offset:29696
 buffer_load_dwordx4 v[128:131], v241, s[28:31], s93 offen offset:2048 sc1
 s_waitcnt vmcnt(30)
 s_waitcnt lgkmcnt(10)
 v_mfma_f32_16x16x32_bf16 v[16:19], v[56:59], a[164:167], v[16:19]
 ds_read_b64_tr_b16 v[48:49], v11 offset:24576
 ds_read_b64_tr_b16 v[50:51], v11 offset:25600
 v_mfma_f32_16x16x32_bf16 v[20:23], v[56:59], a[236:239], v[20:23]
 buffer_load_dwordx4 a[204:207], v240, s[28:31], s93 offen offset:3072 sc1
 s_waitcnt lgkmcnt(10)
 v_mfma_f32_16x16x32_bf16 v[32:35], v[60:63], a[164:167], v[32:35]
 ds_read_b64_tr_b16 v[52:53], v11 offset:28672
 ds_read_b64_tr_b16 v[54:55], v11 offset:29696
 buffer_load_dwordx4 v[132:135], v241, s[28:31], s93 offen offset:3072 sc1
 s_waitcnt lgkmcnt(10)
 v_mfma_f32_16x16x32_bf16 v[24:27], v[64:67], a[164:167], v[24:27]
 ds_read_b64_tr_b16 v[56:57], v10 offset:26624
 ds_read_b64_tr_b16 v[58:59], v10 offset:27648
 v_mfma_f32_16x16x32_bf16 v[28:31], v[64:67], a[236:239], v[28:31]
 s_mov_b32 s93, 16384
 s_waitcnt lgkmcnt(10)
 v_mfma_f32_16x16x32_bf16 v[36:39], v[68:71], a[164:167], v[36:39]
 ds_read_b64_tr_b16 v[60:61], v10 offset:30720
 ds_read_b64_tr_b16 v[62:63], v10 offset:31744
 buffer_load_dwordx4 a[208:211], v240, s[28:31], s93 offen offset:0 sc1
 s_waitcnt vmcnt(19)
 s_waitcnt lgkmcnt(10)
 v_mfma_f32_16x16x32_bf16 v[16:19], v[40:43], a[168:171], v[16:19]
 ds_read_b64_tr_b16 v[64:65], v11 offset:26624
 ds_read_b64_tr_b16 v[66:67], v11 offset:27648
 v_mfma_f32_16x16x32_bf16 v[20:23], v[40:43], a[240:243], v[20:23]
 buffer_load_dwordx4 v[136:139], v241, s[28:31], s93 offen offset:0 sc1
 s_waitcnt lgkmcnt(10)
 v_mfma_f32_16x16x32_bf16 v[32:35], v[44:47], a[168:171], v[32:35]
 ds_read_b64_tr_b16 v[68:69], v11 offset:30720
 ds_read_b64_tr_b16 v[70:71], v11 offset:31744
 buffer_load_dwordx4 a[212:215], v240, s[28:31], s93 offen offset:1024 sc1
 s_waitcnt lgkmcnt(10)
 v_mfma_f32_16x16x32_bf16 v[24:27], v[48:51], a[168:171], v[24:27]
 ds_read_b64_tr_b16 v[40:41], v10 offset:32768
 ds_read_b64_tr_b16 v[42:43], v10 offset:33792
 v_mfma_f32_16x16x32_bf16 v[28:31], v[48:51], a[240:243], v[28:31]
 buffer_load_dwordx4 v[140:143], v241, s[28:31], s93 offen offset:1024 sc1
 s_waitcnt lgkmcnt(10)
 v_mfma_f32_16x16x32_bf16 v[36:39], v[52:55], a[168:171], v[36:39]
 ds_read_b64_tr_b16 v[44:45], v10 offset:36864
 ds_read_b64_tr_b16 v[46:47], v10 offset:37888
 s_mov_b32 s94, 4096
 buffer_load_dwordx4 a[16:19], v144, s[28:31], s94 offen offset:0 sc1
 s_waitcnt vmcnt(21)
 s_waitcnt lgkmcnt(10)
 v_mfma_f32_16x16x32_bf16 v[16:19], v[56:59], a[172:175], v[16:19]
 ds_read_b64_tr_b16 v[48:49], v11 offset:32768
 ds_read_b64_tr_b16 v[50:51], v11 offset:33792
 v_mfma_f32_16x16x32_bf16 v[20:23], v[56:59], a[244:247], v[20:23]
 buffer_load_dwordx4 a[20:23], v144, s[28:31], s94 offen offset:1024 sc1
 s_waitcnt lgkmcnt(10)
 v_mfma_f32_16x16x32_bf16 v[32:35], v[60:63], a[172:175], v[32:35]
 ds_read_b64_tr_b16 v[52:53], v11 offset:36864
 ds_read_b64_tr_b16 v[54:55], v11 offset:37888
 buffer_load_dwordx4 a[24:27], v144, s[28:31], s94 offen offset:2048 sc1
 s_waitcnt lgkmcnt(10)
 v_mfma_f32_16x16x32_bf16 v[24:27], v[64:67], a[172:175], v[24:27]
 ds_read_b64_tr_b16 v[56:57], v10 offset:34816
 ds_read_b64_tr_b16 v[58:59], v10 offset:35840
 v_mfma_f32_16x16x32_bf16 v[28:31], v[64:67], a[244:247], v[28:31]
 buffer_load_dwordx4 a[28:31], v144, s[28:31], s94 offen offset:3072 sc1
 s_waitcnt lgkmcnt(10)
 v_mfma_f32_16x16x32_bf16 v[36:39], v[68:71], a[172:175], v[36:39]
 ds_read_b64_tr_b16 v[60:61], v10 offset:38912
 ds_read_b64_tr_b16 v[62:63], v10 offset:39936
 s_mov_b32 s94, 8192
 buffer_load_dwordx4 a[32:35], v144, s[28:31], s94 offen offset:0 sc1
 s_waitcnt vmcnt(23)
 s_waitcnt lgkmcnt(10)
 v_mfma_f32_16x16x32_bf16 v[16:19], v[40:43], a[176:179], v[16:19]
 ds_read_b64_tr_b16 v[64:65], v11 offset:34816
 ds_read_b64_tr_b16 v[66:67], v11 offset:35840
 v_mfma_f32_16x16x32_bf16 v[20:23], v[40:43], a[248:251], v[20:23]
 buffer_load_dwordx4 a[36:39], v144, s[28:31], s94 offen offset:1024 sc1
 s_waitcnt lgkmcnt(10)
 v_mfma_f32_16x16x32_bf16 v[32:35], v[44:47], a[176:179], v[32:35]
 ds_read_b64_tr_b16 v[68:69], v11 offset:38912
 ds_read_b64_tr_b16 v[70:71], v11 offset:39936
 buffer_load_dwordx4 a[40:43], v144, s[28:31], s94 offen offset:2048 sc1
 s_waitcnt lgkmcnt(10)
 v_mfma_f32_16x16x32_bf16 v[24:27], v[48:51], a[176:179], v[24:27]
 ds_read_b64_tr_b16 v[40:41], v10 offset:40960
 ds_read_b64_tr_b16 v[42:43], v10 offset:41984
 v_mfma_f32_16x16x32_bf16 v[28:31], v[48:51], a[248:251], v[28:31]
 buffer_load_dwordx4 a[44:47], v144, s[28:31], s94 offen offset:3072 sc1
 s_waitcnt lgkmcnt(10)
 v_mfma_f32_16x16x32_bf16 v[36:39], v[52:55], a[176:179], v[36:39]
 ds_read_b64_tr_b16 v[44:45], v10 offset:45056
 ds_read_b64_tr_b16 v[46:47], v10 offset:46080
 s_mov_b32 s94, 12288
 buffer_load_dwordx4 a[48:51], v144, s[28:31], s94 offen offset:0 sc1
 s_waitcnt vmcnt(25)
 s_waitcnt lgkmcnt(10)
 v_mfma_f32_16x16x32_bf16 v[16:19], v[56:59], a[180:183], v[16:19]
 ds_read_b64_tr_b16 v[48:49], v11 offset:40960
 ds_read_b64_tr_b16 v[50:51], v11 offset:41984
 v_mfma_f32_16x16x32_bf16 v[20:23], v[56:59], a[252:255], v[20:23]
 buffer_load_dwordx4 a[52:55], v144, s[28:31], s94 offen offset:1024 sc1
 s_waitcnt lgkmcnt(10)
 v_mfma_f32_16x16x32_bf16 v[32:35], v[60:63], a[180:183], v[32:35]
 ds_read_b64_tr_b16 v[52:53], v11 offset:45056
 ds_read_b64_tr_b16 v[54:55], v11 offset:46080
 buffer_load_dwordx4 a[56:59], v144, s[28:31], s94 offen offset:2048 sc1
 s_waitcnt lgkmcnt(10)
 v_mfma_f32_16x16x32_bf16 v[24:27], v[64:67], a[180:183], v[24:27]
 ds_read_b64_tr_b16 v[56:57], v10 offset:43008
 ds_read_b64_tr_b16 v[58:59], v10 offset:44032
 v_mfma_f32_16x16x32_bf16 v[28:31], v[64:67], a[252:255], v[28:31]
 buffer_load_dwordx4 a[60:63], v144, s[28:31], s94 offen offset:3072 sc1
 s_waitcnt lgkmcnt(10)
 v_mfma_f32_16x16x32_bf16 v[36:39], v[68:71], a[180:183], v[36:39]
 ds_read_b64_tr_b16 v[60:61], v10 offset:47104
 ds_read_b64_tr_b16 v[62:63], v10 offset:48128
 buffer_load_dwordx2 v[160:161], v148, s[8:11], 0 offen offset:0
 s_waitcnt vmcnt(27)
 s_waitcnt lgkmcnt(10)
 v_mfma_f32_16x16x32_bf16 v[16:19], v[40:43], a[184:187], v[16:19]
 ds_read_b64_tr_b16 v[64:65], v11 offset:43008
 ds_read_b64_tr_b16 v[66:67], v11 offset:44032
 v_mfma_f32_16x16x32_bf16 v[20:23], v[40:43], v[112:115], v[20:23]
 buffer_load_dwordx2 v[162:163], v148, s[8:11], 0 offen offset:32
 s_waitcnt lgkmcnt(10)
 v_mfma_f32_16x16x32_bf16 v[32:35], v[44:47], a[184:187], v[32:35]
 ds_read_b64_tr_b16 v[68:69], v11 offset:47104
 ds_read_b64_tr_b16 v[70:71], v11 offset:48128
 s_mov_b32 s94, 0
 buffer_load_dwordx4 a[64:67], v145, s[28:31], s94 offen offset:0 sc1
 s_waitcnt lgkmcnt(10)
 v_mfma_f32_16x16x32_bf16 v[24:27], v[48:51], a[184:187], v[24:27]
 ds_read_b64_tr_b16 v[40:41], v10 offset:49152
 ds_read_b64_tr_b16 v[42:43], v10 offset:50176
 v_mfma_f32_16x16x32_bf16 v[28:31], v[48:51], v[112:115], v[28:31]
 buffer_load_dwordx4 a[68:71], v145, s[28:31], s94 offen offset:1024 sc1
 s_waitcnt lgkmcnt(10)
 v_mfma_f32_16x16x32_bf16 v[36:39], v[52:55], a[184:187], v[36:39]
 ds_read_b64_tr_b16 v[44:45], v10 offset:53248
 ds_read_b64_tr_b16 v[46:47], v10 offset:54272
 buffer_load_dwordx4 a[72:75], v145, s[28:31], s94 offen offset:2048 sc1
 s_waitcnt vmcnt(29)
 s_waitcnt lgkmcnt(10)
 v_mfma_f32_16x16x32_bf16 v[16:19], v[56:59], a[188:191], v[16:19]
 ds_read_b64_tr_b16 v[48:49], v11 offset:49152
 ds_read_b64_tr_b16 v[50:51], v11 offset:50176
 v_mfma_f32_16x16x32_bf16 v[20:23], v[56:59], v[116:119], v[20:23]
 buffer_load_dwordx4 a[76:79], v145, s[28:31], s94 offen offset:3072 sc1
 s_waitcnt lgkmcnt(10)
 v_mfma_f32_16x16x32_bf16 v[32:35], v[60:63], a[188:191], v[32:35]
 ds_read_b64_tr_b16 v[52:53], v11 offset:53248
 ds_read_b64_tr_b16 v[54:55], v11 offset:54272
 s_mov_b32 s94, 4096
 buffer_load_dwordx4 a[80:83], v145, s[28:31], s94 offen offset:0 sc1
 s_waitcnt lgkmcnt(10)
 v_mfma_f32_16x16x32_bf16 v[24:27], v[64:67], a[188:191], v[24:27]
 ds_read_b64_tr_b16 v[56:57], v10 offset:51200
 ds_read_b64_tr_b16 v[58:59], v10 offset:52224
 v_mfma_f32_16x16x32_bf16 v[28:31], v[64:67], v[116:119], v[28:31]
 buffer_load_dwordx4 a[84:87], v145, s[28:31], s94 offen offset:1024 sc1
 s_waitcnt lgkmcnt(10)
 v_mfma_f32_16x16x32_bf16 v[36:39], v[68:71], a[188:191], v[36:39]
 ds_read_b64_tr_b16 v[60:61], v10 offset:55296
 ds_read_b64_tr_b16 v[62:63], v10 offset:56320
 buffer_load_dwordx4 a[88:91], v145, s[28:31], s94 offen offset:2048 sc1
 s_waitcnt vmcnt(31)
 s_waitcnt lgkmcnt(10)
 v_mfma_f32_16x16x32_bf16 v[16:19], v[40:43], a[192:195], v[16:19]
 ds_read_b64_tr_b16 v[64:65], v11 offset:51200
 ds_read_b64_tr_b16 v[66:67], v11 offset:52224
 v_mfma_f32_16x16x32_bf16 v[20:23], v[40:43], v[120:123], v[20:23]
 buffer_load_dwordx4 a[92:95], v145, s[28:31], s94 offen offset:3072 sc1
 s_waitcnt lgkmcnt(10)
 v_mfma_f32_16x16x32_bf16 v[32:35], v[44:47], a[192:195], v[32:35]
 ds_read_b64_tr_b16 v[68:69], v11 offset:55296
 ds_read_b64_tr_b16 v[70:71], v11 offset:56320
 s_mov_b32 s94, 8192
 buffer_load_dwordx4 a[96:99], v145, s[28:31], s94 offen offset:0 sc1
 s_waitcnt lgkmcnt(10)
 v_mfma_f32_16x16x32_bf16 v[24:27], v[48:51], a[192:195], v[24:27]
 ds_read_b64_tr_b16 v[40:41], v10 offset:57344
 ds_read_b64_tr_b16 v[42:43], v10 offset:58368
 v_mfma_f32_16x16x32_bf16 v[28:31], v[48:51], v[120:123], v[28:31]
 buffer_load_dwordx4 a[100:103], v145, s[28:31], s94 offen offset:1024 sc1
 s_waitcnt lgkmcnt(10)
 v_mfma_f32_16x16x32_bf16 v[36:39], v[52:55], a[192:195], v[36:39]
 ds_read_b64_tr_b16 v[44:45], v10 offset:61440
 ds_read_b64_tr_b16 v[46:47], v10 offset:62464
 buffer_load_dwordx4 a[104:107], v145, s[28:31], s94 offen offset:2048 sc1
 s_waitcnt vmcnt(33)
 s_waitcnt lgkmcnt(10)
 v_mfma_f32_16x16x32_bf16 v[16:19], v[56:59], a[196:199], v[16:19]
 ds_read_b64_tr_b16 v[48:49], v11 offset:57344
 ds_read_b64_tr_b16 v[50:51], v11 offset:58368
 v_mfma_f32_16x16x32_bf16 v[20:23], v[56:59], v[124:127], v[20:23]
 buffer_load_dwordx4 a[108:111], v145, s[28:31], s94 offen offset:3072 sc1
 s_waitcnt lgkmcnt(10)
 v_mfma_f32_16x16x32_bf16 v[32:35], v[60:63], a[196:199], v[32:35]
 ds_read_b64_tr_b16 v[52:53], v11 offset:61440
 ds_read_b64_tr_b16 v[54:55], v11 offset:62464
 s_mov_b32 s94, 12288
 buffer_load_dwordx4 a[112:115], v145, s[28:31], s94 offen offset:0 sc1
 s_waitcnt lgkmcnt(10)
 v_mfma_f32_16x16x32_bf16 v[24:27], v[64:67], a[196:199], v[24:27]
 ds_read_b64_tr_b16 v[56:57], v10 offset:59392
 ds_read_b64_tr_b16 v[58:59], v10 offset:60416
 v_mfma_f32_16x16x32_bf16 v[28:31], v[64:67], v[124:127], v[28:31]
 buffer_load_dwordx4 a[116:119], v145, s[28:31], s94 offen offset:1024 sc1
 s_waitcnt lgkmcnt(10)
 v_mfma_f32_16x16x32_bf16 v[36:39], v[68:71], a[196:199], v[36:39]
 ds_read_b64_tr_b16 v[60:61], v10 offset:63488
 ds_read_b64_tr_b16 v[62:63], v10 offset:64512
 buffer_load_dwordx4 a[120:123], v145, s[28:31], s94 offen offset:2048 sc1
 s_waitcnt vmcnt(35)
 s_waitcnt lgkmcnt(10)
 v_mfma_f32_16x16x32_bf16 v[16:19], v[40:43], a[200:203], v[16:19]
 ds_read_b64_tr_b16 v[64:65], v11 offset:59392
 ds_read_b64_tr_b16 v[66:67], v11 offset:60416
 v_mfma_f32_16x16x32_bf16 v[20:23], v[40:43], v[128:131], v[20:23]
 buffer_load_dwordx4 a[124:127], v145, s[28:31], s94 offen offset:3072 sc1
 s_waitcnt lgkmcnt(10)
 v_mfma_f32_16x16x32_bf16 v[32:35], v[44:47], a[200:203], v[32:35]
 ds_read_b64_tr_b16 v[68:69], v11 offset:63488
 ds_read_b64_tr_b16 v[70:71], v11 offset:64512
 s_waitcnt lgkmcnt(10)
 v_mfma_f32_16x16x32_bf16 v[24:27], v[48:51], a[200:203], v[24:27]
 v_add_u32 v10, 0x10000, v10
 ds_read_b64_tr_b16 v[40:41], v10 offset:0
 ds_read_b64_tr_b16 v[42:43], v10 offset:1024
 v_mfma_f32_16x16x32_bf16 v[28:31], v[48:51], v[128:131], v[28:31]
 s_waitcnt lgkmcnt(10)
 v_mfma_f32_16x16x32_bf16 v[36:39], v[52:55], a[200:203], v[36:39]
 ds_read_b64_tr_b16 v[44:45], v10 offset:4096
 ds_read_b64_tr_b16 v[46:47], v10 offset:5120
 s_waitcnt vmcnt(34)
 s_waitcnt lgkmcnt(10)
 v_mfma_f32_16x16x32_bf16 v[16:19], v[56:59], a[204:207], v[16:19]
 v_add_u32 v11, 0x10000, v11
 ds_read_b64_tr_b16 v[48:49], v11 offset:0
 ds_read_b64_tr_b16 v[50:51], v11 offset:1024
 v_mfma_f32_16x16x32_bf16 v[20:23], v[56:59], v[132:135], v[20:23]
 s_waitcnt lgkmcnt(10)
 v_mfma_f32_16x16x32_bf16 v[32:35], v[60:63], a[204:207], v[32:35]
 ds_read_b64_tr_b16 v[52:53], v11 offset:4096
 ds_read_b64_tr_b16 v[54:55], v11 offset:5120
 s_waitcnt lgkmcnt(10)
 v_mfma_f32_16x16x32_bf16 v[24:27], v[64:67], a[204:207], v[24:27]
 ds_read_b64_tr_b16 v[56:57], v10 offset:2048
 ds_read_b64_tr_b16 v[58:59], v10 offset:3072
 v_mfma_f32_16x16x32_bf16 v[28:31], v[64:67], v[132:135], v[28:31]
 s_waitcnt lgkmcnt(10)
 v_mfma_f32_16x16x32_bf16 v[36:39], v[68:71], a[204:207], v[36:39]
 ds_read_b64_tr_b16 v[60:61], v10 offset:6144
 ds_read_b64_tr_b16 v[62:63], v10 offset:7168
 s_waitcnt vmcnt(32)
 s_waitcnt lgkmcnt(10)
 v_mfma_f32_16x16x32_bf16 v[16:19], v[40:43], a[208:211], v[16:19]
 ds_read_b64_tr_b16 v[64:65], v11 offset:2048
 ds_read_b64_tr_b16 v[66:67], v11 offset:3072
 v_mfma_f32_16x16x32_bf16 v[20:23], v[40:43], v[136:139], v[20:23]
 s_waitcnt lgkmcnt(10)
 v_mfma_f32_16x16x32_bf16 v[32:35], v[44:47], a[208:211], v[32:35]
 ds_read_b64_tr_b16 v[68:69], v11 offset:6144
 ds_read_b64_tr_b16 v[70:71], v11 offset:7168
 s_waitcnt lgkmcnt(10)
 v_mfma_f32_16x16x32_bf16 v[24:27], v[48:51], a[208:211], v[24:27]
 v_mfma_f32_16x16x32_bf16 v[28:31], v[48:51], v[136:139], v[28:31]
 s_waitcnt lgkmcnt(8)
 v_mfma_f32_16x16x32_bf16 v[36:39], v[52:55], a[208:211], v[36:39]
 s_waitcnt vmcnt(30)
 s_waitcnt lgkmcnt(6)
 v_mfma_f32_16x16x32_bf16 v[16:19], v[56:59], a[212:215], v[16:19]
 v_mfma_f32_16x16x32_bf16 v[20:23], v[56:59], v[140:143], v[20:23]
 s_waitcnt lgkmcnt(4)
 v_mfma_f32_16x16x32_bf16 v[32:35], v[60:63], a[212:215], v[32:35]
 s_waitcnt lgkmcnt(2)
 v_mfma_f32_16x16x32_bf16 v[24:27], v[64:67], a[212:215], v[24:27]
 v_mfma_f32_16x16x32_bf16 v[28:31], v[64:67], v[140:143], v[28:31]
 s_waitcnt lgkmcnt(0)
 v_mfma_f32_16x16x32_bf16 v[36:39], v[68:71], a[212:215], v[36:39]
 s_mov_b32 s57, 0xbfb8aa3b
 v_mfma_f32_16x16x32_bf16 v[184:187], v[152:155], a[128:131], 0
 v_mfma_f32_16x16x32_bf16 v[188:191], v[150:153], a[128:131], 0
 v_mfma_f32_16x16x32_bf16 v[184:187], v[152:155], a[132:135], v[184:187]
 v_mfma_f32_16x16x32_bf16 v[188:191], v[150:153], a[132:135], v[188:191]
 v_mfma_f32_16x16x32_bf16 v[184:187], v[152:155], a[136:139], v[184:187]
 v_mfma_f32_16x16x32_bf16 v[188:191], v[150:153], a[136:139], v[188:191]
 v_mfma_f32_16x16x32_bf16 v[184:187], v[152:155], a[140:143], v[184:187]
 v_mfma_f32_16x16x32_bf16 v[188:191], v[150:153], a[140:143], v[188:191]
 s_lshl_b32 s58, s48, 11
 s_add_u32 s58, s58, 81920
 v_lshlrev_b32 v208, 4, v0
 v_add_u32 v209, s58, v208
 s_nop 2
 ds_write_b128 v209, v[184:187]
 ds_write_b128 v209, v[188:191] offset:1024
 v_mfma_f32_16x16x32_bf16 v[168:171], v[152:155], a[0:3], 0
 v_mfma_f32_16x16x32_bf16 v[172:175], v[150:153], a[0:3], 0
 v_mfma_f32_16x16x32_bf16 v[168:171], v[152:155], a[4:7], v[168:171]
 v_mfma_f32_16x16x32_bf16 v[172:175], v[150:153], a[4:7], v[172:175]
 v_mfma_f32_16x16x32_bf16 v[168:171], v[152:155], a[8:11], v[168:171]
 v_mfma_f32_16x16x32_bf16 v[172:175], v[150:153], a[8:11], v[172:175]
 v_mfma_f32_16x16x32_bf16 v[168:171], v[152:155], a[12:15], v[168:171]
 v_mfma_f32_16x16x32_bf16 v[172:175], v[150:153], a[12:15], v[172:175]
 s_waitcnt vmcnt(29)
 v_mfma_f32_16x16x32_bf16 v[168:171], v[152:155], a[16:19], v[168:171]
 v_mfma_f32_16x16x32_bf16 v[172:175], v[150:153], a[16:19], v[172:175]
 s_waitcnt vmcnt(28)
 v_mfma_f32_16x16x32_bf16 v[168:171], v[152:155], a[20:23], v[168:171]
 v_mfma_f32_16x16x32_bf16 v[172:175], v[150:153], a[20:23], v[172:175]
 s_waitcnt vmcnt(27)
 v_mfma_f32_16x16x32_bf16 v[168:171], v[152:155], a[24:27], v[168:171]
 v_mfma_f32_16x16x32_bf16 v[172:175], v[150:153], a[24:27], v[172:175]
 s_waitcnt vmcnt(26)
 v_mfma_f32_16x16x32_bf16 v[168:171], v[152:155], a[28:31], v[168:171]
 v_mfma_f32_16x16x32_bf16 v[172:175], v[150:153], a[28:31], v[172:175]
 s_waitcnt vmcnt(25)
 v_mfma_f32_16x16x32_bf16 v[168:171], v[152:155], a[32:35], v[168:171]
 v_mfma_f32_16x16x32_bf16 v[172:175], v[150:153], a[32:35], v[172:175]
 s_waitcnt vmcnt(24)
 v_mfma_f32_16x16x32_bf16 v[168:171], v[152:155], a[36:39], v[168:171]
 v_mfma_f32_16x16x32_bf16 v[172:175], v[150:153], a[36:39], v[172:175]
 s_waitcnt vmcnt(23)
 v_mfma_f32_16x16x32_bf16 v[168:171], v[152:155], a[40:43], v[168:171]
 v_mfma_f32_16x16x32_bf16 v[172:175], v[150:153], a[40:43], v[172:175]
 s_waitcnt vmcnt(22)
 v_mfma_f32_16x16x32_bf16 v[168:171], v[152:155], a[44:47], v[168:171]
 v_mfma_f32_16x16x32_bf16 v[172:175], v[150:153], a[44:47], v[172:175]
 s_waitcnt vmcnt(21)
 v_mfma_f32_16x16x32_bf16 v[168:171], v[152:155], a[48:51], v[168:171]
 v_mfma_f32_16x16x32_bf16 v[172:175], v[150:153], a[48:51], v[172:175]
 s_waitcnt vmcnt(20)
 v_mfma_f32_16x16x32_bf16 v[168:171], v[152:155], a[52:55], v[168:171]
 v_mfma_f32_16x16x32_bf16 v[172:175], v[150:153], a[52:55], v[172:175]
 s_waitcnt vmcnt(19)
 v_mfma_f32_16x16x32_bf16 v[168:171], v[152:155], a[56:59], v[168:171]
 v_mfma_f32_16x16x32_bf16 v[172:175], v[150:153], a[56:59], v[172:175]
 s_waitcnt vmcnt(18)
 v_mfma_f32_16x16x32_bf16 v[168:171], v[152:155], a[60:63], v[168:171]
 v_mfma_f32_16x16x32_bf16 v[172:175], v[150:153], a[60:63], v[172:175]
 s_nop 6
 v_mul_f32 v192, s57, v168
 v_mul_f32 v193, s57, v169
 v_mul_f32 v194, s57, v170
 v_mul_f32 v195, s57, v171
 v_mul_f32 v200, s57, v172
 v_mul_f32 v201, s57, v173
 v_mul_f32 v202, s57, v174
 v_mul_f32 v203, s57, v175
 v_exp_f32 v192, v192
 v_exp_f32 v193, v193
 v_exp_f32 v194, v194
 v_exp_f32 v195, v195
 v_exp_f32 v200, v200
 v_exp_f32 v201, v201
 v_exp_f32 v202, v202
 v_exp_f32 v203, v203
 v_add_f32 v192, 1.0, v192
 v_add_f32 v193, 1.0, v193
 v_add_f32 v194, 1.0, v194
 v_add_f32 v195, 1.0, v195
 v_add_f32 v200, 1.0, v200
 v_add_f32 v201, 1.0, v201
 v_add_f32 v202, 1.0, v202
 v_add_f32 v203, 1.0, v203
 v_rcp_f32 v192, v192
 v_rcp_f32 v193, v193
 v_rcp_f32 v194, v194
 v_rcp_f32 v195, v195
 v_rcp_f32 v200, v200
 v_rcp_f32 v201, v201
 v_rcp_f32 v202, v202
 v_rcp_f32 v203, v203
 v_mul_f32 v168, v168, v192
 v_mul_f32 v169, v169, v193
 v_mul_f32 v170, v170, v194
 v_mul_f32 v171, v171, v195
 v_lshlrev_b32 v196, 16, v156
 v_and_b32 v197, s81, v156
 v_lshlrev_b32 v198, 16, v157
 v_and_b32 v199, s81, v157
 v_mul_f32 v172, v172, v200
 v_mul_f32 v173, v173, v201
 v_mul_f32 v174, v174, v202
 v_mul_f32 v175, v175, v203
 v_lshlrev_b32 v204, 16, v158
 v_and_b32 v205, s81, v158
 v_lshlrev_b32 v206, 16, v159
 v_and_b32 v207, s81, v159
 v_fmac_f32 v196, v16, v168
 v_fmac_f32 v197, v17, v169
 v_fmac_f32 v198, v18, v170
 v_fmac_f32 v199, v19, v171
 v_cvt_pk_bf16_f32 v156, v196, v197
 v_cvt_pk_bf16_f32 v157, v198, v199
 buffer_store_dwordx2 v[156:157], v147, s[68:71], 0 offen offset:0
 v_fmac_f32 v204, v24, v172
 v_fmac_f32 v205, v25, v173
 v_fmac_f32 v206, v26, v174
 v_fmac_f32 v207, v27, v175
 v_cvt_pk_bf16_f32 v158, v204, v205
 v_cvt_pk_bf16_f32 v159, v206, v207
 buffer_store_dwordx2 v[158:159], v147, s[68:71], 0 offen offset:32
 s_waitcnt lgkmcnt(0)
 s_barrier
 v_add_u32 v208, 81920, v208
 ds_read_b128 v[212:215], v208 offset:0
 ds_read_b128 v[216:219], v208 offset:1024
 ds_read_b128 v[220:223], v208 offset:2048
 ds_read_b128 v[224:227], v208 offset:3072
 ds_read_b128 v[228:231], v208 offset:4096
 ds_read_b128 v[232:235], v208 offset:5120
 ds_read_b128 v[236:239], v208 offset:6144
 ds_read_b128 v[240:243], v208 offset:7168
 s_waitcnt vmcnt(17)
 v_mfma_f32_16x16x32_bf16 v[176:179], v[152:155], a[64:67], 0
 v_mfma_f32_16x16x32_bf16 v[180:183], v[150:153], a[64:67], 0
 s_waitcnt vmcnt(16)
 v_mfma_f32_16x16x32_bf16 v[176:179], v[152:155], a[68:71], v[176:179]
 v_mfma_f32_16x16x32_bf16 v[180:183], v[150:153], a[68:71], v[180:183]
 s_waitcnt vmcnt(15)
 v_mfma_f32_16x16x32_bf16 v[176:179], v[152:155], a[72:75], v[176:179]
 v_mfma_f32_16x16x32_bf16 v[180:183], v[150:153], a[72:75], v[180:183]
 s_waitcnt vmcnt(14)
 v_mfma_f32_16x16x32_bf16 v[176:179], v[152:155], a[76:79], v[176:179]
 v_mfma_f32_16x16x32_bf16 v[180:183], v[150:153], a[76:79], v[180:183]
 s_waitcnt vmcnt(13)
 v_mfma_f32_16x16x32_bf16 v[176:179], v[152:155], a[80:83], v[176:179]
 v_mfma_f32_16x16x32_bf16 v[180:183], v[150:153], a[80:83], v[180:183]
 s_waitcnt vmcnt(12)
 v_mfma_f32_16x16x32_bf16 v[176:179], v[152:155], a[84:87], v[176:179]
 v_mfma_f32_16x16x32_bf16 v[180:183], v[150:153], a[84:87], v[180:183]
 s_waitcnt vmcnt(11)
 v_mfma_f32_16x16x32_bf16 v[176:179], v[152:155], a[88:91], v[176:179]
 v_mfma_f32_16x16x32_bf16 v[180:183], v[150:153], a[88:91], v[180:183]
 s_waitcnt vmcnt(10)
 v_mfma_f32_16x16x32_bf16 v[176:179], v[152:155], a[92:95], v[176:179]
 v_mfma_f32_16x16x32_bf16 v[180:183], v[150:153], a[92:95], v[180:183]
 s_waitcnt vmcnt(9)
 v_mfma_f32_16x16x32_bf16 v[176:179], v[152:155], a[96:99], v[176:179]
 v_mfma_f32_16x16x32_bf16 v[180:183], v[150:153], a[96:99], v[180:183]
 s_waitcnt vmcnt(8)
 v_mfma_f32_16x16x32_bf16 v[176:179], v[152:155], a[100:103], v[176:179]
 v_mfma_f32_16x16x32_bf16 v[180:183], v[150:153], a[100:103], v[180:183]
 s_waitcnt vmcnt(7)
 v_mfma_f32_16x16x32_bf16 v[176:179], v[152:155], a[104:107], v[176:179]
 v_mfma_f32_16x16x32_bf16 v[180:183], v[150:153], a[104:107], v[180:183]
 s_waitcnt vmcnt(6)
 v_mfma_f32_16x16x32_bf16 v[176:179], v[152:155], a[108:111], v[176:179]
 v_mfma_f32_16x16x32_bf16 v[180:183], v[150:153], a[108:111], v[180:183]
 s_waitcnt vmcnt(5)
 v_mfma_f32_16x16x32_bf16 v[176:179], v[152:155], a[112:115], v[176:179]
 v_mfma_f32_16x16x32_bf16 v[180:183], v[150:153], a[112:115], v[180:183]
 s_waitcnt vmcnt(4)
 v_mfma_f32_16x16x32_bf16 v[176:179], v[152:155], a[116:119], v[176:179]
 v_mfma_f32_16x16x32_bf16 v[180:183], v[150:153], a[116:119], v[180:183]
 s_waitcnt vmcnt(3)
 v_mfma_f32_16x16x32_bf16 v[176:179], v[152:155], a[120:123], v[176:179]
 v_mfma_f32_16x16x32_bf16 v[180:183], v[150:153], a[120:123], v[180:183]
 s_waitcnt vmcnt(2)
 v_mfma_f32_16x16x32_bf16 v[176:179], v[152:155], a[124:127], v[176:179]
 v_mfma_f32_16x16x32_bf16 v[180:183], v[150:153], a[124:127], v[180:183]
 s_nop 6
 v_mul_f32 v192, s57, v176
 v_mul_f32 v193, s57, v177
 v_mul_f32 v194, s57, v178
 v_mul_f32 v195, s57, v179
 v_mul_f32 v200, s57, v180
 v_mul_f32 v201, s57, v181
 v_mul_f32 v202, s57, v182
 v_mul_f32 v203, s57, v183
 v_exp_f32 v192, v192
 v_exp_f32 v193, v193
 v_exp_f32 v194, v194
 v_exp_f32 v195, v195
 v_exp_f32 v200, v200
 v_exp_f32 v201, v201
 v_exp_f32 v202, v202
 v_exp_f32 v203, v203
 v_add_f32 v192, 1.0, v192
 v_add_f32 v193, 1.0, v193
 v_add_f32 v194, 1.0, v194
 v_add_f32 v195, 1.0, v195
 v_add_f32 v200, 1.0, v200
 v_add_f32 v201, 1.0, v201
 v_add_f32 v202, 1.0, v202
 v_add_f32 v203, 1.0, v203
 v_rcp_f32 v192, v192
 v_rcp_f32 v193, v193
 v_rcp_f32 v194, v194
 v_rcp_f32 v195, v195
 v_rcp_f32 v200, v200
 v_rcp_f32 v201, v201
 v_rcp_f32 v202, v202
 v_rcp_f32 v203, v203
 v_mul_f32 v176, v176, v192
 v_mul_f32 v177, v177, v193
 v_mul_f32 v178, v178, v194
 v_mul_f32 v179, v179, v195
 v_lshlrev_b32 v196, 16, v160
 v_and_b32 v197, s81, v160
 v_lshlrev_b32 v198, 16, v161
 v_and_b32 v199, s81, v161
 v_mul_f32 v180, v180, v200
 v_mul_f32 v181, v181, v201
 v_mul_f32 v182, v182, v202
 v_mul_f32 v183, v183, v203
 v_lshlrev_b32 v204, 16, v162
 v_and_b32 v205, s81, v162
 v_lshlrev_b32 v206, 16, v163
 v_and_b32 v207, s81, v163
 v_fmac_f32 v196, v20, v176
 v_fmac_f32 v197, v21, v177
 v_fmac_f32 v198, v22, v178
 v_fmac_f32 v199, v23, v179
 v_cvt_pk_bf16_f32 v160, v196, v197
 v_cvt_pk_bf16_f32 v161, v198, v199
 buffer_store_dwordx2 v[160:161], v148, s[68:71], 0 offen offset:0
 v_fmac_f32 v204, v28, v180
 v_fmac_f32 v205, v29, v181
 v_fmac_f32 v206, v30, v182
 v_fmac_f32 v207, v31, v183
 v_cvt_pk_bf16_f32 v162, v204, v205
 v_cvt_pk_bf16_f32 v163, v206, v207
 buffer_store_dwordx2 v[162:163], v148, s[68:71], 0 offen offset:32
 s_waitcnt lgkmcnt(0)
 v_add_f32 v212, v212, v220
 v_add_f32 v228, v228, v236
 v_add_f32 v213, v213, v221
 v_add_f32 v229, v229, v237
 v_add_f32 v214, v214, v222
 v_add_f32 v230, v230, v238
 v_add_f32 v215, v215, v223
 v_add_f32 v231, v231, v239
 v_add_f32 v216, v216, v224
 v_add_f32 v232, v232, v240
 v_add_f32 v217, v217, v225
 v_add_f32 v233, v233, v241
 v_add_f32 v218, v218, v226
 v_add_f32 v234, v234, v242
 v_add_f32 v219, v219, v227
 v_add_f32 v235, v235, v243
 v_add_f32 v184, v212, v228
 v_add_f32 v185, v213, v229
 v_add_f32 v186, v214, v230
 v_add_f32 v187, v215, v231
 v_add_f32 v188, v216, v232
 v_add_f32 v189, v217, v233
 v_add_f32 v190, v218, v234
 v_add_f32 v191, v219, v235
 v_mul_f32 v192, s57, v184
 v_mul_f32 v193, s57, v185
 v_mul_f32 v194, s57, v186
 v_mul_f32 v195, s57, v187
 v_mul_f32 v200, s57, v188
 v_mul_f32 v201, s57, v189
 v_mul_f32 v202, s57, v190
 v_mul_f32 v203, s57, v191
 v_exp_f32 v192, v192
 v_exp_f32 v193, v193
 v_exp_f32 v194, v194
 v_exp_f32 v195, v195
 v_exp_f32 v200, v200
 v_exp_f32 v201, v201
 v_exp_f32 v202, v202
 v_exp_f32 v203, v203
 v_add_f32 v192, 1.0, v192
 v_add_f32 v193, 1.0, v193
 v_add_f32 v194, 1.0, v194
 v_add_f32 v195, 1.0, v195
 v_add_f32 v200, 1.0, v200
 v_add_f32 v201, 1.0, v201
 v_add_f32 v202, 1.0, v202
 v_add_f32 v203, 1.0, v203
 v_rcp_f32 v192, v192
 v_rcp_f32 v193, v193
 v_rcp_f32 v194, v194
 v_rcp_f32 v195, v195
 v_rcp_f32 v200, v200
 v_rcp_f32 v201, v201
 v_rcp_f32 v202, v202
 v_rcp_f32 v203, v203
 v_mul_f32 v184, v184, v192
 v_mul_f32 v185, v185, v193
 v_mul_f32 v186, v186, v194
 v_mul_f32 v187, v187, v195
 v_lshlrev_b32 v196, 16, v164
 v_and_b32 v197, s81, v164
 v_lshlrev_b32 v198, 16, v165
 v_and_b32 v199, s81, v165
 v_mul_f32 v188, v188, v200
 v_mul_f32 v189, v189, v201
 v_mul_f32 v190, v190, v202
 v_mul_f32 v191, v191, v203
 v_lshlrev_b32 v204, 16, v166
 v_and_b32 v205, s81, v166
 v_lshlrev_b32 v206, 16, v167
 v_and_b32 v207, s81, v167
 v_fmac_f32 v196, v32, v184
 v_fmac_f32 v197, v33, v185
 v_fmac_f32 v198, v34, v186
 v_fmac_f32 v199, v35, v187
 v_cvt_pk_bf16_f32 v164, v196, v197
 v_cvt_pk_bf16_f32 v165, v198, v199
 buffer_store_dwordx2 v[164:165], v149, s[68:71], 0 offen offset:0
 v_fmac_f32 v204, v36, v188
 v_fmac_f32 v205, v37, v189
 v_fmac_f32 v206, v38, v190
 v_fmac_f32 v207, v39, v191
 v_cvt_pk_bf16_f32 v166, v204, v205
 v_cvt_pk_bf16_f32 v167, v206, v207
 buffer_store_dwordx2 v[166:167], v149, s[68:71], 0 offen offset:32
 s_waitcnt vmcnt(0) lgkmcnt(0)
L1_end_body:
 s_endpgm
L1_end:
 s_endpgm
L_codeend:
.section .rodata,"a"
.p2align 6
.amdhsa_kernel recurrent_scan__sliding_local_dilated__glu_gated_reglu__prompt_kernel
  .amdhsa_next_free_vgpr 512
  .amdhsa_next_free_sgpr 96
  .amdhsa_accum_offset 256
  .amdhsa_group_segment_fixed_size 0
  .amdhsa_kernarg_size 80
  .amdhsa_user_sgpr_count 2
  .amdhsa_user_sgpr_kernarg_segment_ptr 1
  .amdhsa_system_sgpr_workgroup_id_x 1
  .amdhsa_float_denorm_mode_32 3
.end_amdhsa_kernel
```
